```python
import torch

def _softmax(x, axis=-1):
    return torch.softmax(x, dim=axis)
def _gelu(x):
    return torch.nn.functional.gelu(x, approximate="tanh")
def _silu(x):
    return torch.nn.functional.silu(x)
def _sigmoid(x):
    return torch.sigmoid(x)
def _layernorm(x, axis=-1, eps=1e-5):
    m = x.mean(dim=axis, keepdim=True)
    v = x.var(dim=axis, keepdim=True, unbiased=False)
    return (x - m) / torch.sqrt(v + eps)
def _scatter_add(tgt, idx, src, axis=0):
    return tgt.clone().index_add_(axis, idx, src)
def _segment_sum(src, seg, n):
    out = torch.zeros((n,) + src.shape[1:], dtype=src.dtype)
    return out.index_add_(0, seg, src)
def _pad(x, pw):
    flat = tuple(v for pair in reversed(pw) for v in pair)
    return torch.nn.functional.pad(x, flat)

kernel_name = 'interleave_layers__spectral_fnet__dense_activation_relu__prompt'

def setup_inputs():

    _w = (lambda a: (lambda t: t.to(torch.bfloat16) if t.is_floating_point() else t)(torch.as_tensor(a)))
    def _A_setup():
        B, S, D = 1, 2048, 448
        ns = torch.arange(S)[:, None] * torch.arange(S)[None, :]
        nd = torch.arange(D)[:, None] * torch.arange(D)[None, :]
        Ws_re = torch.cos(-2.0 * torch.pi * ns / S).to(float)
        Ws_im = torch.sin(-2.0 * torch.pi * ns / S).to(float)
        Wd_re = torch.cos(-2.0 * torch.pi * nd / D).to(float)
        Wd_im = torch.sin(-2.0 * torch.pi * nd / D).to(float)
        return {
            "x": _w((lambda *s: torch.randn(*s, dtype=torch.bfloat16) * 0.05)(B, S, D)),
            "dft_seq_re": _w(Ws_re),
            "dft_seq_im": _w(Ws_im),
            "dft_hid_re": _w(Wd_re),
            "dft_hid_im": _w(Wd_im),
        }
    _A_in = _A_setup()

    def _B_setup():
        B, S, D, Dff = 1, 2048, 448, 1792
        return {
            "x": _w((lambda *s: torch.randn(*s, dtype=torch.bfloat16) * 0.05)(B, S, D)),
            "w1": _w((lambda *s: torch.randn(*s, dtype=torch.bfloat16) * 1.6)(D, Dff)),
            "w2": _w((lambda *s: torch.randn(*s, dtype=torch.bfloat16) * 1.6)(Dff, D)),
        }
    _B_in = _B_setup()

    return {
        "A_x": _A_in["x"],
        "A_dft_seq_re": _A_in["dft_seq_re"],
        "A_dft_seq_im": _A_in["dft_seq_im"],
        "A_dft_hid_re": _A_in["dft_hid_re"],
        "A_dft_hid_im": _A_in["dft_hid_im"],
        "B_x": _B_in["x"],
        "B_w1": _B_in["w1"],
        "B_w2": _B_in["w2"],
    }

def reference(A_x, A_dft_seq_re, A_dft_seq_im, A_dft_hid_re, A_dft_hid_im, B_x, B_w1, B_w2):
    def _A_ref(x, dft_seq_re, dft_seq_im, dft_hid_re, dft_hid_im):
        a = torch.einsum("bsd,ed->bse", x, dft_hid_re)
        b = torch.einsum("bsd,ed->bse", x, dft_hid_im)
        y = torch.einsum("ts,bse->bte", dft_seq_re, a) - torch.einsum("ts,bse->bte", dft_seq_im, b)
        return y

    def _B_ref(x, w1, w2):
        h = torch.einsum("bsd,df->bsf", x, w1)
        zero = torch.zeros_like(h)
        h = torch.maximum(h, zero)
        return torch.einsum("bsf,fd->bsd", h, w2)

    x = A_x
    x = x + _A_ref(_layernorm(x, axis=-1), A_dft_seq_re, A_dft_seq_im, A_dft_hid_re, A_dft_hid_im)
    x = x + _B_ref(_layernorm(x, axis=-1), B_w1, B_w2)
    x = x + _A_ref(_layernorm(x, axis=-1), A_dft_seq_re, A_dft_seq_im, A_dft_hid_re, A_dft_hid_im)
    x = x + _B_ref(_layernorm(x, axis=-1), B_w1, B_w2)
    return x
```

```asm
; @launch grid=(256,1,1) block=(256,1,1) lds=163840
.amdgcn_target "amdgcn-amd-amdhsa--gfx950"
.text
.globl interleave_layers__spectral_fnet__dense_activation_relu__prompt_kernel
.p2align 12
.p2align 8
.type interleave_layers__spectral_fnet__dense_activation_relu__prompt_kernel,@function
interleave_layers__spectral_fnet__dense_activation_relu__prompt_kernel:
    s_load_dwordx2 s[8:9], s[0:1], 0
    s_load_dwordx4 s[4:7], s[0:1], 48
    s_load_dwordx2 s[20:21], s[0:1], 64
    s_load_dwordx2 s[24:25], s[0:1], 80
    s_getpc_b64 s[46:47]
L_pc:
    v_lshrrev_b32 v1, 6, v0
    v_and_b32 v0, 63, v0
    s_bfe_u32 s3, s2, 0x50003
    v_readfirstlane_b32 s32, v1
    v_lshl_add_u32 v2, s3, 2, v1
    v_lshl_add_u32 v2, v0, 7, v2
    v_lshlrev_b32 v2, 7, v2
    v_min_u32 v2, L_end-L_pc, v2
    s_mov_b64 exec, 7
    global_load_dword v3, v2, s[46:47]
    s_mov_b64 exec, -1
    v_lshlrev_b32 v1, 4, v0
    s_sub_u32 s3, s2, 32
    s_cmp_ge_u32 s3, 224
    s_cbranch_scc1 L_helper
    s_lshr_b32 s42, s3, 3
    s_mul_i32 s41, s42, 37
    s_lshr_b32 s41, s41, 8
    s_mul_i32 s33, s41, 7
    s_sub_u32 s33, s42, s33
    s_and_b32 s34, s3, 7
    s_lshl_b32 s34, s34, 1
    s_lshr_b32 s42, s41, 1
    s_add_u32 s34, s34, s42
    s_sub_u32 s42, 32, s34
    s_cmp_eq_u32 s34, 0
    s_cselect_b32 s42, 16, s42
    s_bitcmp1_b32 s41, 0
    s_cselect_b32 s34, s42, s34
    s_mul_i32 s37, s32, 22528
    s_add_u32 s37, s37, 73728
    s_mov_b32 s10, 1835008
    s_mov_b32 s11, 0x20000
    v_lshrrev_b32 v252, 3, v0
    v_lshrrev_b32 v253, 4, v0
    v_xor_b32 v253, v253, v0
    v_and_b32 v253, 7, v253
    v_mul_u32_u24 v252, 57344, v252
    v_lshl_add_u32 v252, v253, 4, v252
    v_xor_b32 v253, 64, v252
    v_add_u32 v253, 457728, v253
    s_lshr_b32 s42, s32, 1
    s_lshl_b32 s42, s42, 5
    s_add_u32 s42, s42, s34
    s_and_b32 s43, s32, 1
    s_lshl_b32 s43, s43, 10
    s_add_u32 s42, s42, s43
    s_mul_i32 s3, s42, 896
    s_lshl_b32 s67, s33, 7
    s_add_u32 m0, s37, 8192
    s_add_u32 s48, s3, s67
    s_waitcnt lgkmcnt(0)
    buffer_load_dwordx4 v252, s[8:11], s48 offen lds
    buffer_load_dwordx4 v253, s[8:11], s48 offen offset:1024 lds
    s_add_u32 s48, s67, 384
    s_sub_u32 s68, s48, 896
    s_min_u32 s48, s48, s68
    s_add_u32 m0, s37, 10240
    s_add_u32 s48, s3, s48
    buffer_load_dwordx4 v252, s[8:11], s48 offen lds
    buffer_load_dwordx4 v253, s[8:11], s48 offen offset:1024 lds
    s_add_u32 s48, s67, 512
    s_sub_u32 s68, s48, 896
    s_min_u32 s48, s48, s68
    s_add_u32 m0, s37, 12288
    s_add_u32 s48, s3, s48
    buffer_load_dwordx4 v252, s[8:11], s48 offen lds
    s_mov_b32 s12, s4
    s_mov_b32 s13, s5
    s_mov_b32 s14, 1605632
    s_mov_b32 s15, 0x20000
    s_mov_b32 s26, 15073344
    s_mov_b32 s27, 0x20000
    s_sub_u32 s35, 64, s34
    s_cmp_eq_u32 s34, 0
    s_cselect_b32 s35, 32, s35
    v_and_b32 v72, 15, v0
    s_and_b32 s42, s32, 1
    s_lshl_b32 s43, s33, 5
    s_add_u32 s42, s42, s43
    v_lshl_add_u32 v72, v72, 1, s42
    v_mov_b32 v73, 224
    v_cmp_eq_u32 vcc, 0, v72
    buffer_load_dwordx4 v253, s[8:11], s48 offen offset:1024 lds
    v_lshrrev_b32 v75, 4, v0
    s_lshl_b32 s43, s43, 1
    v_lshl_add_u32 v75, v75, 3, s43
    v_cndmask_b32 v72, v72, v73, vcc
    v_cvt_f32_u32 v75, v75
    v_cvt_f32_u32 v72, v72
    s_cmp_ge_u32 s32, 2
    s_cselect_b32 s42, 0xc2e00000, 0
    v_fma_f32 v73, v75, v72, s42
    v_mul_f32 v72, 0x3b124925, v72
    v_mul_f32 v75, 0x3b124925, v73
    v_rndne_f32 v75, v75
    v_fmamk_f32 v73, v75, 0xc3e00000, v73
    v_mul_f32 v73, 0x3b124925, v73
    v_mul_f32 v74, 0x42000000, v72
    v_cos_f32 v74, v74
    s_add_u32 s48, s67, 128
    s_sub_u32 s68, s48, 896
    s_min_u32 s48, s48, s68
    s_add_u32 m0, s37, 14336
    s_add_u32 s48, s3, s48
    buffer_load_dwordx4 v252, s[8:11], s48 offen lds
    s_mul_i32 s42, s32, 7168
    s_add_u32 s42, s42, 0
    v_add_u32 v75, s42, v1
    v_add_f32 v74, v74, v74
    v_fmamk_f32 v76, v72, 0x00000000, v73
    v_fmamk_f32 v77, v72, 0x3f800000, v73
    v_fmamk_f32 v78, v72, 0x40000000, v73
    v_fmamk_f32 v79, v72, 0x40400000, v73
    v_fmamk_f32 v80, v72, 0x40800000, v73
    v_fmamk_f32 v81, v72, 0x40a00000, v73
    v_fmamk_f32 v82, v72, 0x40c00000, v73
    v_fmamk_f32 v83, v72, 0x40e00000, v73
    v_cos_f32 v76, v76
    v_cos_f32 v77, v77
    buffer_load_dwordx4 v253, s[8:11], s48 offen offset:1024 lds
    v_cos_f32 v78, v78
    v_cos_f32 v79, v79
    v_cos_f32 v80, v80
    v_cos_f32 v81, v81
    v_cos_f32 v82, v82
    v_cos_f32 v83, v83
    v_cvt_pk_bf16_f32 v92, v76, v77
    v_cvt_pk_bf16_f32 v93, v78, v79
    v_cvt_pk_bf16_f32 v94, v80, v81
    v_cvt_pk_bf16_f32 v95, v82, v83
    ds_write_b128 v75, v[92:95] offset:0
    v_fmamk_f32 v84, v72, 0x42000000, v73
    v_fmamk_f32 v85, v72, 0x42040000, v73
    v_fmamk_f32 v86, v72, 0x42080000, v73
    v_fmamk_f32 v87, v72, 0x420c0000, v73
    v_fmamk_f32 v88, v72, 0x42100000, v73
    v_fmamk_f32 v89, v72, 0x42140000, v73
    v_fmamk_f32 v90, v72, 0x42180000, v73
    v_fmamk_f32 v91, v72, 0x421c0000, v73
    v_cos_f32 v84, v84
    v_cos_f32 v85, v85
    v_cos_f32 v86, v86
    v_cos_f32 v87, v87
    v_cos_f32 v88, v88
    v_cos_f32 v89, v89
    v_cos_f32 v90, v90
    v_cos_f32 v91, v91
    v_cvt_pk_bf16_f32 v96, v84, v85
    v_cvt_pk_bf16_f32 v97, v86, v87
    v_cvt_pk_bf16_f32 v98, v88, v89
    v_cvt_pk_bf16_f32 v99, v90, v91
    ds_write_b128 v75, v[96:99] offset:1024
    v_pk_fma_f32 v[76:77], v[74:75], v[84:85], v[76:77] op_sel_hi:[0,1,1] neg_lo:[0,0,1] neg_hi:[0,0,1]
    v_pk_fma_f32 v[78:79], v[74:75], v[86:87], v[78:79] op_sel_hi:[0,1,1] neg_lo:[0,0,1] neg_hi:[0,0,1]
    v_pk_fma_f32 v[80:81], v[74:75], v[88:89], v[80:81] op_sel_hi:[0,1,1] neg_lo:[0,0,1] neg_hi:[0,0,1]
    v_pk_fma_f32 v[82:83], v[74:75], v[90:91], v[82:83] op_sel_hi:[0,1,1] neg_lo:[0,0,1] neg_hi:[0,0,1]
    v_cvt_pk_bf16_f32 v92, v76, v77
    v_cvt_pk_bf16_f32 v93, v78, v79
    v_cvt_pk_bf16_f32 v94, v80, v81
    v_cvt_pk_bf16_f32 v95, v82, v83
    ds_write_b128 v75, v[92:95] offset:2048
    v_pk_fma_f32 v[84:85], v[74:75], v[76:77], v[84:85] op_sel_hi:[0,1,1] neg_lo:[0,0,1] neg_hi:[0,0,1]
    v_pk_fma_f32 v[86:87], v[74:75], v[78:79], v[86:87] op_sel_hi:[0,1,1] neg_lo:[0,0,1] neg_hi:[0,0,1]
    v_pk_fma_f32 v[88:89], v[74:75], v[80:81], v[88:89] op_sel_hi:[0,1,1] neg_lo:[0,0,1] neg_hi:[0,0,1]
    v_pk_fma_f32 v[90:91], v[74:75], v[82:83], v[90:91] op_sel_hi:[0,1,1] neg_lo:[0,0,1] neg_hi:[0,0,1]
    v_cvt_pk_bf16_f32 v96, v84, v85
    v_cvt_pk_bf16_f32 v97, v86, v87
    v_cvt_pk_bf16_f32 v98, v88, v89
    v_cvt_pk_bf16_f32 v99, v90, v91
    ds_write_b128 v75, v[96:99] offset:3072
    v_pk_fma_f32 v[76:77], v[74:75], v[84:85], v[76:77] op_sel_hi:[0,1,1] neg_lo:[0,0,1] neg_hi:[0,0,1]
    v_pk_fma_f32 v[78:79], v[74:75], v[86:87], v[78:79] op_sel_hi:[0,1,1] neg_lo:[0,0,1] neg_hi:[0,0,1]
    v_pk_fma_f32 v[80:81], v[74:75], v[88:89], v[80:81] op_sel_hi:[0,1,1] neg_lo:[0,0,1] neg_hi:[0,0,1]
    v_pk_fma_f32 v[82:83], v[74:75], v[90:91], v[82:83] op_sel_hi:[0,1,1] neg_lo:[0,0,1] neg_hi:[0,0,1]
    v_cvt_pk_bf16_f32 v92, v76, v77
    v_cvt_pk_bf16_f32 v93, v78, v79
    v_cvt_pk_bf16_f32 v94, v80, v81
    v_cvt_pk_bf16_f32 v95, v82, v83
    ds_write_b128 v75, v[92:95] offset:4096
    v_pk_fma_f32 v[84:85], v[74:75], v[76:77], v[84:85] op_sel_hi:[0,1,1] neg_lo:[0,0,1] neg_hi:[0,0,1]
    v_pk_fma_f32 v[86:87], v[74:75], v[78:79], v[86:87] op_sel_hi:[0,1,1] neg_lo:[0,0,1] neg_hi:[0,0,1]
    v_pk_fma_f32 v[88:89], v[74:75], v[80:81], v[88:89] op_sel_hi:[0,1,1] neg_lo:[0,0,1] neg_hi:[0,0,1]
    v_pk_fma_f32 v[90:91], v[74:75], v[82:83], v[90:91] op_sel_hi:[0,1,1] neg_lo:[0,0,1] neg_hi:[0,0,1]
    v_cvt_pk_bf16_f32 v96, v84, v85
    v_cvt_pk_bf16_f32 v97, v86, v87
    v_cvt_pk_bf16_f32 v98, v88, v89
    v_cvt_pk_bf16_f32 v99, v90, v91
    ds_write_b128 v75, v[96:99] offset:5120
    v_pk_fma_f32 v[76:77], v[74:75], v[84:85], v[76:77] op_sel_hi:[0,1,1] neg_lo:[0,0,1] neg_hi:[0,0,1]
    v_pk_fma_f32 v[78:79], v[74:75], v[86:87], v[78:79] op_sel_hi:[0,1,1] neg_lo:[0,0,1] neg_hi:[0,0,1]
    v_pk_fma_f32 v[80:81], v[74:75], v[88:89], v[80:81] op_sel_hi:[0,1,1] neg_lo:[0,0,1] neg_hi:[0,0,1]
    v_pk_fma_f32 v[82:83], v[74:75], v[90:91], v[82:83] op_sel_hi:[0,1,1] neg_lo:[0,0,1] neg_hi:[0,0,1]
    v_cvt_pk_bf16_f32 v92, v76, v77
    v_cvt_pk_bf16_f32 v93, v78, v79
    v_cvt_pk_bf16_f32 v94, v80, v81
    v_cvt_pk_bf16_f32 v95, v82, v83
    ds_write_b128 v75, v[92:95] offset:6144
    s_add_u32 s48, s67, 640
    s_sub_u32 s68, s48, 896
    s_min_u32 s48, s48, s68
    s_add_u32 m0, s37, 16384
    s_add_u32 s48, s3, s48
    buffer_load_dwordx4 v252, s[8:11], s48 offen lds
    buffer_load_dwordx4 v253, s[8:11], s48 offen offset:1024 lds
    v_mov_b32 v136, 0x3f803f80
    v_mov_b32 v137, 0x3f803f80
    v_mov_b32 v138, 0x3f803f80
    v_mov_b32 v139, 0x3f803f80
    v_and_b32 v148, 15, v0
    v_lshrrev_b32 v149, 4, v0
    v_lshrrev_b32 v12, 1, v148
    v_xor_b32 v12, v12, v149
    v_lshlrev_b32 v148, 7, v148
    v_lshl_add_u32 v148, v12, 4, v148
    s_add_u32 s42, s37, 8192
    s_add_u32 s48, s67, 256
    s_sub_u32 s68, s48, 896
    s_min_u32 s48, s48, s68
    s_add_u32 m0, s37, 18432
    s_add_u32 s48, s3, s48
    buffer_load_dwordx4 v252, s[8:11], s48 offen lds
    buffer_load_dwordx4 v253, s[8:11], s48 offen offset:1024 lds
    v_add_u32 v12, s42, v148
    v_xor_b32 v13, 64, v12
    v_lshrrev_b32 v6, 3, v0
    v_lshrrev_b32 v7, 2, v0
    v_and_b32 v7, 4, v7
    v_xor_b32 v7, v7, v0
    v_and_b32 v7, 7, v7
    v_mul_u32_u24 v6, 3584, v6
    v_lshl_add_u32 v6, v7, 4, v6
    v_add_u32 v7, 27648, v6
    s_lshl_b32 s38, s33, 2
    s_add_u32 s38, s38, s32
    s_lshl_b32 s38, s38, 7
    s_mov_b64 exec, 0
    s_cmp_eq_u32 s32, 0
    s_cbranch_scc1 L_pad1
    s_cmp_eq_u32 s32, 1
    s_cbranch_scc1 L_pad2
    s_cmp_eq_u32 s32, 2
    s_cbranch_scc1 L_pad3
    s_branch L_pad4
L_helper:
    s_cmp_ge_u32 s2, 32
    s_cbranch_scc1 L_exit
    s_mov_b32 s14, 1605632
    s_mov_b32 s15, 0x20000
    s_mov_b32 s18, 1605632
    s_mov_b32 s19, 0x20000
    s_mov_b32 s26, 15073344
    s_mov_b32 s27, 0x20000
    v_lshrrev_b32 v6, 3, v0
    v_lshrrev_b32 v7, 2, v0
    v_and_b32 v7, 4, v7
    v_xor_b32 v7, v7, v0
    v_and_b32 v7, 7, v7
    v_mul_u32_u24 v6, 3584, v6
    v_lshl_add_u32 v6, v7, 4, v6
    v_add_u32 v7, 27648, v6
    s_mul_i32 s68, s32, 14336
    s_mul_i32 s67, s32, 57344
    s_lshl_b32 s42, s2, 7
    s_add_u32 s67, s67, s42
    s_mov_b32 s43, 15073280
    s_waitcnt lgkmcnt(0)
    s_mov_b32 s12, s4
    s_mov_b32 s13, s5
    s_mov_b32 s16, s6
    s_mov_b32 s17, s7
    buffer_load_dwordx4 v[140:143], off, s[24:27], s43 sc1
    s_cmp_ge_u32 s2, 28
    s_cbranch_scc1 L_hrest
    s_add_u32 m0, s68, 0
    s_nop 0
    buffer_load_dwordx4 v6, s[12:15], s67 offen lds
    buffer_load_dwordx4 v7, s[12:15], s67 offen offset:1024 lds
    s_add_u32 m0, s68, 2048
    s_add_u32 s67, s67, 229376
    buffer_load_dwordx4 v6, s[12:15], s67 offen lds
    buffer_load_dwordx4 v7, s[12:15], s67 offen offset:1024 lds
    s_add_u32 m0, s68, 4096
    s_add_u32 s67, s67, 229376
    buffer_load_dwordx4 v6, s[12:15], s67 offen lds
    buffer_load_dwordx4 v7, s[12:15], s67 offen offset:1024 lds
    s_add_u32 m0, s68, 6144
    s_add_u32 s67, s67, 229376
    buffer_load_dwordx4 v6, s[12:15], s67 offen lds
    buffer_load_dwordx4 v7, s[12:15], s67 offen offset:1024 lds
    s_add_u32 m0, s68, 8192
    s_add_u32 s67, s67, 229376
    buffer_load_dwordx4 v6, s[12:15], s67 offen lds
    buffer_load_dwordx4 v7, s[12:15], s67 offen offset:1024 lds
    s_add_u32 m0, s68, 10240
    s_add_u32 s67, s67, 229376
    buffer_load_dwordx4 v6, s[12:15], s67 offen lds
    buffer_load_dwordx4 v7, s[12:15], s67 offen offset:1024 lds
    s_add_u32 m0, s68, 12288
    s_add_u32 s67, s67, 229376
    buffer_load_dwordx4 v6, s[12:15], s67 offen lds
    buffer_load_dwordx4 v7, s[12:15], s67 offen offset:1024 lds
    s_branch L_helper2
L_ret0:
    s_mov_b64 exec, -1
    s_add_u32 s48, s67, 768
    s_sub_u32 s68, s48, 896
    s_min_u32 s48, s48, s68
    s_add_u32 m0, s37, 20480
    s_add_u32 s48, s3, s48
    buffer_load_dwordx4 v252, s[8:11], s48 offen lds
    buffer_load_dwordx4 v253, s[8:11], s48 offen offset:1024 lds
    s_mov_b32 s48, 15073280
    s_mov_b64 exec, 1
    buffer_load_dwordx4 v[248:251], off, s[24:27], s48 sc1
    s_mov_b64 exec, -1
    s_waitcnt lgkmcnt(0)
    s_barrier
    s_lshl_b32 s67, s32, 9
    s_add_u32 s67, s67, s35
    s_mul_i32 s67, s67, 896
    s_mul_i32 s68, s32, 7296
    s_add_u32 m0, s68, 29184
    s_mov_b32 exec_hi, 0x00ffffff
    buffer_load_dwordx4 v1, s[8:11], s67 offen lds
    s_mov_b32 exec_hi, -1
    s_add_u32 s67, s67, 57344
    s_add_u32 m0, s68, 30096
    s_mov_b32 exec_hi, 0x00ffffff
    buffer_load_dwordx4 v1, s[8:11], s67 offen lds
    s_mov_b32 exec_hi, -1
    ds_read_b128 v[108:111], v1 offset:7168
    ds_read_b128 v[116:119], v1 offset:21504
    ds_read_b128 v[104:107], v1 offset:0
    ds_read_b128 v[112:115], v1 offset:14336
    s_waitcnt vmcnt(15)
    ds_read_b128 v[16:19], v12 offset:0
    ds_read_b128 v[20:23], v13 offset:0
    s_waitcnt vmcnt(13)
    ds_read_b128 v[40:43], v12 offset:2048
    ds_read_b128 v[44:47], v13 offset:2048
    s_waitcnt lgkmcnt(0)
    v_mfma_f32_16x16x32_bf16 v[96:99], v[136:139], v[16:19], 0
    s_add_u32 s67, s67, 57344
    s_add_u32 m0, s68, 31008
    s_mov_b32 exec_hi, 0x00ffffff
    buffer_load_dwordx4 v1, s[8:11], s67 offen lds
    s_mov_b32 exec_hi, -1
    v_bfe_u32 v152, v0, 2, 2
    v_mfma_f32_16x16x32_bf16 v[100:103], v[16:19], v[16:19], 0
    v_bfe_u32 v153, v0, 3, 1
    v_bfe_u32 v154, v0, 4, 1
    v_mfma_f32_16x16x32_bf16 v[96:99], v[136:139], v[44:47], v[96:99]
    s_waitcnt vmcnt(12)
    ds_read_b128 v[48:51], v12 offset:4096
    v_and_b32 v155, 3, v0
    v_mfma_f32_16x16x32_bf16 v[100:103], v[44:47], v[44:47], v[100:103]
    ds_read_b128 v[52:55], v13 offset:4096
    s_add_u32 s67, s67, 57344
    s_add_u32 m0, s68, 31920
    s_mov_b32 exec_hi, 0x00ffffff
    buffer_load_dwordx4 v1, s[8:11], s67 offen lds
    s_mov_b32 exec_hi, -1
    v_lshlrev_b32 v152, 7, v152
    v_mfma_f32_16x16x32_bf16 v[164:167], v[104:107], v[136:139], 0
    v_mfma_f32_16x16x32_bf16 v[76:79], v[108:111], v[16:19], 0
    ds_read_b128 v[124:127], v1 offset:8192
    v_lshl_add_u32 v152, v153, 6, v152
    v_mfma_f32_16x16x32_bf16 v[88:91], v[116:119], v[16:19], 0
    ds_read_b128 v[132:135], v1 offset:22528
    v_lshl_add_u32 v152, v154, 5, v152
    v_mfma_f32_16x16x32_bf16 v[72:75], v[104:107], v[16:19], 0
    ds_read_b128 v[120:123], v1 offset:1024
    s_add_u32 s67, s67, 57344
    s_add_u32 m0, s68, 32832
    s_mov_b32 exec_hi, 0x00ffffff
    buffer_load_dwordx4 v1, s[8:11], s67 offen lds
    s_mov_b32 exec_hi, -1
    v_lshl_add_u32 v152, v155, 3, v152
    v_mfma_f32_16x16x32_bf16 v[84:87], v[112:115], v[16:19], 0
    ds_read_b128 v[128:131], v1 offset:15360
    v_add_u32 v152, s37, v152
    v_mfma_f32_16x16x32_bf16 v[80:83], v[108:111], v[44:47], 0
    v_lshrrev_b32 v153, 5, v0
    v_lshl_add_u32 v8, v153, 10, v152
    v_mfma_f32_16x16x32_bf16 v[92:95], v[116:119], v[44:47], 0
    s_add_u32 s67, s67, 57344
    s_add_u32 m0, s68, 33744
    s_mov_b32 exec_hi, 0x00ffffff
    buffer_load_dwordx4 v1, s[8:11], s67 offen lds
    s_mov_b32 exec_hi, -1
    v_xor_b32 v9, 64, v8
    v_mfma_f32_16x16x32_bf16 v[72:75], v[104:107], v[44:47], v[72:75]
    v_add_u32 v10, s37, v1
    s_mov_b32 s22, 1835008
    v_mfma_f32_16x16x32_bf16 v[84:87], v[112:115], v[44:47], v[84:87]
    s_mov_b32 s23, 0x20000
    s_mov_b32 s36, 200000
    s_waitcnt lgkmcnt(4)
    v_mfma_f32_16x16x32_bf16 v[96:99], v[136:139], v[20:23], v[96:99]
    s_add_u32 s67, s67, 57344
    s_add_u32 m0, s68, 34656
    s_mov_b32 exec_hi, 0x00ffffff
    buffer_load_dwordx4 v1, s[8:11], s67 offen lds
    s_mov_b32 exec_hi, -1
    s_mov_b32 s39, 0x3f80
    v_mfma_f32_16x16x32_bf16 v[100:103], v[20:23], v[20:23], v[100:103]
    s_mov_b32 s40, 0x3f800000
    s_mov_b32 s69, 0xffff0000
    v_mfma_f32_16x16x32_bf16 v[96:99], v[136:139], v[48:51], v[96:99]
    s_waitcnt vmcnt(14)
    ds_read_b128 v[24:27], v12 offset:6144
    s_mov_b32 s52, 0x100001
    v_mfma_f32_16x16x32_bf16 v[100:103], v[48:51], v[48:51], v[100:103]
    ds_read_b128 v[28:31], v13 offset:6144
    s_add_u32 s67, s67, 57344
    s_add_u32 m0, s68, 35568
    s_mov_b32 exec_hi, 0x00ffffff
    buffer_load_dwordx4 v1, s[8:11], s67 offen lds
    s_mov_b32 exec_hi, -1
    s_mov_b32 s53, 0x10000100
    s_waitcnt lgkmcnt(2)
    v_mfma_f32_16x16x32_bf16 v[164:167], v[120:123], v[136:139], v[164:167]
    v_mfma_f32_16x16x32_bf16 v[76:79], v[124:127], v[20:23], v[76:79]
    ds_read_b128 v[108:111], v1 offset:9216
    s_mov_b32 s54, 0x200002
    v_mfma_f32_16x16x32_bf16 v[88:91], v[132:135], v[20:23], v[88:91]
    ds_read_b128 v[116:119], v1 offset:23552
    s_add_u32 m0, s37, 0
    s_nop 0
    buffer_load_dwordx4 v6, s[12:15], s38 offen lds
    s_mov_b32 s55, 0x20000200
    v_mfma_f32_16x16x32_bf16 v[72:75], v[120:123], v[20:23], v[72:75]
    ds_read_b128 v[104:107], v1 offset:2048
    s_mov_b32 s56, 0x400004
    v_mfma_f32_16x16x32_bf16 v[84:87], v[128:131], v[20:23], v[84:87]
    ds_read_b128 v[112:115], v1 offset:16384
    s_mov_b32 s57, 0x40000400
    v_mfma_f32_16x16x32_bf16 v[80:83], v[124:127], v[48:51], v[80:83]
    s_mov_b32 s58, 0x800008
    s_mov_b32 s59, 0x80000800
    v_mfma_f32_16x16x32_bf16 v[92:95], v[132:135], v[48:51], v[92:95]
    v_and_b32 v148, 15, v0
    v_lshrrev_b32 v149, 4, v0
    v_mfma_f32_16x16x32_bf16 v[72:75], v[120:123], v[48:51], v[72:75]
    buffer_load_dwordx4 v7, s[12:15], s38 offen offset:1024 lds
    v_lshrrev_b32 v14, 2, v148
    v_mfma_f32_16x16x32_bf16 v[84:87], v[128:131], v[48:51], v[84:87]
    v_xor_b32 v14, v14, v149
    v_lshlrev_b32 v150, 5, v148
    s_waitcnt lgkmcnt(4)
    v_mfma_f32_16x16x32_bf16 v[96:99], v[136:139], v[24:27], v[96:99]
    v_lshl_add_u32 v150, v14, 3, v150
    s_lshl_b32 s42, s32, 9
    v_mfma_f32_16x16x32_bf16 v[100:103], v[24:27], v[24:27], v[100:103]
    s_add_u32 s42, s42, 65536
    v_add_u32 v150, s42, v150
    v_mfma_f32_16x16x32_bf16 v[96:99], v[136:139], v[52:55], v[96:99]
    s_waitcnt vmcnt(15)
    ds_read_b128 v[56:59], v12 offset:8192
    s_add_u32 m0, s37, 2048
    s_add_u32 s38, s38, 57344
    buffer_load_dwordx4 v6, s[12:15], s38 offen lds
    s_lshl_b32 s42, s32, 2
    v_mfma_f32_16x16x32_bf16 v[100:103], v[52:55], v[52:55], v[100:103]
    ds_read_b128 v[60:63], v13 offset:8192
    v_add_u32 v15, s42, v149
    s_waitcnt lgkmcnt(2)
    v_mfma_f32_16x16x32_bf16 v[164:167], v[104:107], v[136:139], v[164:167]
    v_mfma_f32_16x16x32_bf16 v[76:79], v[108:111], v[24:27], v[76:79]
    ds_read_b128 v[124:127], v1 offset:10240
    buffer_load_dwordx4 v7, s[12:15], s38 offen offset:1024 lds
    v_cmp_eq_u32 vcc, 0, v15
    v_mfma_f32_16x16x32_bf16 v[88:91], v[116:119], v[24:27], v[88:91]
    ds_read_b128 v[132:135], v1 offset:24576
    v_mul_u32_u24 v15, 114688, v15
    v_mfma_f32_16x16x32_bf16 v[72:75], v[104:107], v[24:27], v[72:75]
    ds_read_b128 v[120:123], v1 offset:3072
    v_lshl_add_u32 v15, v148, 4, v15
    v_mfma_f32_16x16x32_bf16 v[84:87], v[112:115], v[24:27], v[84:87]
    ds_read_b128 v[128:131], v1 offset:17408
    v_cndmask_b32 v151, -1.0, 0, vcc
    v_mfma_f32_16x16x32_bf16 v[80:83], v[108:111], v[52:55], v[80:83]
    s_add_u32 m0, s37, 4096
    s_add_u32 s38, s38, 57344
    buffer_load_dwordx4 v6, s[12:15], s38 offen lds
    s_and_b32 s46, s2, 7
    v_mfma_f32_16x16x32_bf16 v[92:95], v[116:119], v[52:55], v[92:95]
    s_lshl_b32 s46, s46, 2
    s_add_u32 s46, s46, s41
    v_mfma_f32_16x16x32_bf16 v[72:75], v[104:107], v[52:55], v[72:75]
    s_mul_i32 s46, s46, 7
    s_add_u32 s46, s46, s33
    v_mfma_f32_16x16x32_bf16 v[84:87], v[112:115], v[52:55], v[84:87]
    s_lshl_b32 s46, s46, 8
    s_add_u32 s46, s46, 0
    s_waitcnt lgkmcnt(4)
    v_mfma_f32_16x16x32_bf16 v[96:99], v[136:139], v[28:31], v[96:99]
    buffer_load_dwordx4 v7, s[12:15], s38 offen offset:1024 lds
    s_add_u32 s47, s46, 57344
    v_mfma_f32_16x16x32_bf16 v[100:103], v[28:31], v[28:31], v[100:103]
    v_xor_b32 v14, v0, v149
    v_lshlrev_b32 v14, 3, v14
    v_mfma_f32_16x16x32_bf16 v[96:99], v[136:139], v[56:59], v[96:99]
    s_waitcnt vmcnt(17)
L_pad1:
    s_cbranch_execz L_ret0
    ds_read_b128 v[32:35], v12 offset:10240
    v_add_u32 v14, 65536, v14
    v_mfma_f32_16x16x32_bf16 v[100:103], v[56:59], v[56:59], v[100:103]
    ds_read_b128 v[36:39], v13 offset:10240
    v_bfe_u32 v152, v0, 1, 3
    s_waitcnt lgkmcnt(2)
    v_mfma_f32_16x16x32_bf16 v[164:167], v[120:123], v[136:139], v[164:167]
    v_mfma_f32_16x16x32_bf16 v[76:79], v[124:127], v[28:31], v[76:79]
    ds_read_b128 v[108:111], v1 offset:11264
    s_add_u32 m0, s37, 6144
    s_add_u32 s38, s38, 57344
    buffer_load_dwordx4 v6, s[12:15], s38 offen lds
    s_lshl_b32 s42, s32, 3
    v_mfma_f32_16x16x32_bf16 v[88:91], v[132:135], v[28:31], v[88:91]
    ds_read_b128 v[116:119], v1 offset:25600
    v_add_u32 v152, s42, v152
    v_mfma_f32_16x16x32_bf16 v[72:75], v[120:123], v[28:31], v[72:75]
    ds_read_b128 v[104:107], v1 offset:4096
    v_and_b32 v154, 1, v0
    v_mfma_f32_16x16x32_bf16 v[84:87], v[128:131], v[28:31], v[84:87]
    ds_read_b128 v[112:115], v1 offset:18432
    buffer_load_dwordx4 v7, s[12:15], s38 offen offset:1024 lds
    v_cvt_f32_u32 v153, v154
    v_mfma_f32_16x16x32_bf16 v[80:83], v[124:127], v[56:59], v[80:83]
    v_cmp_eq_u32 vcc, 0, v152
    v_lshlrev_b32 v154, 5, v154
    v_mfma_f32_16x16x32_bf16 v[92:95], v[132:135], v[56:59], v[92:95]
    v_mul_f32 v153, 0xbe800000, v153
    v_cndmask_b32 v152, v152, v154, vcc
    v_mfma_f32_16x16x32_bf16 v[72:75], v[120:123], v[56:59], v[72:75]
    v_cndmask_b32 v153, v153, 0, vcc
    v_bfe_i32 v155, v152, 0, 1
    v_mfma_f32_16x16x32_bf16 v[84:87], v[128:131], v[56:59], v[84:87]
    s_add_u32 m0, s37, 8192
    s_add_u32 s38, s38, 57344
    buffer_load_dwordx4 v6, s[12:15], s38 offen lds
    v_cvt_f32_u32 v152, v152
    s_waitcnt lgkmcnt(4)
    v_mfma_f32_16x16x32_bf16 v[96:99], v[136:139], v[32:35], v[96:99]
    v_and_b32 v154, 48, v0
    v_cvt_f32_u32 v154, v154
    v_mfma_f32_16x16x32_bf16 v[100:103], v[32:35], v[32:35], v[100:103]
    v_and_b32 v155, 0x80008000, v155
    v_mul_f32 v152, 0x3c000000, v152
    v_mfma_f32_16x16x32_bf16 v[96:99], v[136:139], v[60:63], v[96:99]
    s_waitcnt vmcnt(18)
    ds_read_b128 v[64:67], v12 offset:12288
    buffer_load_dwordx4 v7, s[12:15], s38 offen offset:1024 lds
    v_fma_f32 v153, v154, v152, v153
    v_mfma_f32_16x16x32_bf16 v[100:103], v[60:63], v[60:63], v[100:103]
    ds_read_b128 v[68:71], v13 offset:12288
    v_fmamk_f32 v156, v152, 0x00000000, v153
    s_waitcnt lgkmcnt(2)
    v_mfma_f32_16x16x32_bf16 v[164:167], v[104:107], v[136:139], v[164:167]
    v_mfma_f32_16x16x32_bf16 v[76:79], v[108:111], v[32:35], v[76:79]
    ds_read_b128 v[124:127], v1 offset:12288
    v_fmamk_f32 v157, v152, 0x40800000, v153
    v_mfma_f32_16x16x32_bf16 v[88:91], v[116:119], v[32:35], v[88:91]
    ds_read_b128 v[132:135], v1 offset:26624
    s_add_u32 m0, s37, 10240
    s_add_u32 s38, s38, 57344
    buffer_load_dwordx4 v6, s[12:15], s38 offen lds
    v_fmamk_f32 v158, v152, 0x41000000, v153
    v_mfma_f32_16x16x32_bf16 v[72:75], v[104:107], v[32:35], v[72:75]
    ds_read_b128 v[120:123], v1 offset:5120
    v_fmamk_f32 v159, v152, 0x41400000, v153
    v_mfma_f32_16x16x32_bf16 v[84:87], v[112:115], v[32:35], v[84:87]
    ds_read_b128 v[128:131], v1 offset:19456
    v_fmamk_f32 v160, v152, 0x40000000, v153
    v_mfma_f32_16x16x32_bf16 v[80:83], v[108:111], v[60:63], v[80:83]
    v_fmamk_f32 v161, v152, 0x40c00000, v153
    v_fmamk_f32 v162, v152, 0x41200000, v153
    v_mfma_f32_16x16x32_bf16 v[92:95], v[116:119], v[60:63], v[92:95]
    buffer_load_dwordx4 v7, s[12:15], s38 offen offset:1024 lds
    v_fmamk_f32 v163, v152, 0x41600000, v153
    v_mfma_f32_16x16x32_bf16 v[72:75], v[104:107], v[60:63], v[72:75]
    v_cos_f32 v156, v156
    v_mfma_f32_16x16x32_bf16 v[84:87], v[112:115], v[60:63], v[84:87]
    v_cos_f32 v157, v157
    s_waitcnt lgkmcnt(4)
    v_mfma_f32_16x16x32_bf16 v[96:99], v[136:139], v[36:39], v[96:99]
    v_cos_f32 v158, v158
    v_mfma_f32_16x16x32_bf16 v[100:103], v[36:39], v[36:39], v[100:103]
    v_cos_f32 v159, v159
    v_mfma_f32_16x16x32_bf16 v[96:99], v[136:139], v[64:67], v[96:99]
    s_add_u32 m0, s37, 12288
    s_add_u32 s38, s38, 57344
    buffer_load_dwordx4 v6, s[12:15], s38 offen lds
    v_cos_f32 v160, v160
    v_mfma_f32_16x16x32_bf16 v[100:103], v[64:67], v[64:67], v[100:103]
    v_cos_f32 v161, v161
    s_waitcnt lgkmcnt(0)
    v_mfma_f32_16x16x32_bf16 v[164:167], v[120:123], v[136:139], v[164:167]
    v_mfma_f32_16x16x32_bf16 v[76:79], v[124:127], v[36:39], v[76:79]
    ds_read_b128 v[108:111], v1 offset:13312
    buffer_load_dwordx4 v7, s[12:15], s38 offen offset:1024 lds
    v_mfma_f32_16x16x32_bf16 v[88:91], v[132:135], v[36:39], v[88:91]
    ds_read_b128 v[116:119], v1 offset:27648
    v_cos_f32 v162, v162
    v_mfma_f32_16x16x32_bf16 v[72:75], v[120:123], v[36:39], v[72:75]
    ds_read_b128 v[104:107], v1 offset:6144
    v_mfma_f32_16x16x32_bf16 v[84:87], v[128:131], v[36:39], v[84:87]
    ds_read_b128 v[112:115], v1 offset:20480
    v_cos_f32 v163, v163
    v_mfma_f32_16x16x32_bf16 v[80:83], v[124:127], v[64:67], v[80:83]
    s_add_u32 m0, s37, 14336
    s_add_u32 s38, s38, 57344
    buffer_load_dwordx4 v6, s[12:15], s38 offen lds
    v_cvt_pk_f16_f32 v140, v156, v157
    s_waitcnt vmcnt(23)
    v_mfma_f32_16x16x32_bf16 v[92:95], v[132:135], v[64:67], v[92:95]
    v_cvt_pk_f16_f32 v141, v158, v159
    v_readfirstlane_b32 s28, v248
    v_mfma_f32_16x16x32_bf16 v[72:75], v[120:123], v[64:67], v[72:75]
    v_cvt_pk_f16_f32 v144, v160, v161
    v_readfirstlane_b32 s29, v249
    v_mfma_f32_16x16x32_bf16 v[84:87], v[128:131], v[64:67], v[84:87]
    v_cvt_pk_f16_f32 v145, v162, v163
    v_readfirstlane_b32 s30, v250
    v_mfma_f32_16x16x32_bf16 v[96:99], v[136:139], v[40:43], v[96:99]
    buffer_load_dwordx4 v7, s[12:15], s38 offen offset:1024 lds
    v_xor_b32 v142, v140, v155
    v_readfirstlane_b32 s31, v251
    v_mfma_f32_16x16x32_bf16 v[100:103], v[40:43], v[40:43], v[100:103]
    v_xor_b32 v143, v141, v155
    s_not_b32 s28, s28
    v_mfma_f32_16x16x32_bf16 v[96:99], v[136:139], v[68:71], v[96:99]
    v_xor_b32 v146, v144, v155
    s_not_b32 s29, s29
    v_mfma_f32_16x16x32_bf16 v[100:103], v[68:71], v[68:71], v[100:103]
    v_xor_b32 v147, v145, v155
    s_not_b32 s30, s30
    s_waitcnt lgkmcnt(0)
    v_mfma_f32_16x16x32_bf16 v[164:167], v[104:107], v[136:139], v[164:167]
    v_mfma_f32_16x16x32_bf16 v[76:79], v[108:111], v[40:43], v[76:79]
    s_add_u32 m0, s37, 16384
    s_add_u32 s38, s38, 57344
    buffer_load_dwordx4 v6, s[12:15], s38 offen lds
    v_mov_b32 v254, 0x10001
    s_not_b32 s31, s31
    v_mfma_f32_16x16x32_bf16 v[80:83], v[108:111], v[68:71], v[80:83]
    v_mfma_f32_16x16x32_bf16 v[88:91], v[116:119], v[40:43], v[88:91]
    v_mfma_f32_16x16x32_bf16 v[92:95], v[116:119], v[68:71], v[92:95]
    buffer_load_dwordx4 v7, s[12:15], s38 offen offset:1024 lds
    v_mfma_f32_16x16x32_bf16 v[72:75], v[104:107], v[40:43], v[72:75]
    v_cndmask_b32 v148, 0, v100, s[52:53]
    v_cndmask_b32 v148, v148, v101, s[54:55]
    v_mfma_f32_16x16x32_bf16 v[72:75], v[104:107], v[68:71], v[72:75]
    v_cndmask_b32 v148, v148, v102, s[56:57]
    v_cndmask_b32 v148, v148, v103, s[58:59]
    v_mfma_f32_16x16x32_bf16 v[84:87], v[112:115], v[40:43], v[84:87]
    v_mul_f32 v98, 0xbb924925, v96
    v_mul_f32 v96, 0x3b124925, v96
    v_mfma_f32_16x16x32_bf16 v[84:87], v[112:115], v[68:71], v[84:87]
    v_mov_b32 v149, v148
    v_mul_f32 v96, v96, v96
    s_nop 0
    v_permlane16_swap_b32 v148, v149
    v_add_f32 v148, v148, v149
    v_mov_b32 v149, v148
    s_nop 1
    v_permlane32_swap_b32 v148, v149
    v_add_f32 v148, v148, v149
    v_fmamk_f32 v148, v148, 0xbb124925, v96
    v_min_f32 v148, 0, v148
    v_sub_f32 v148, 0x3727c5ac, v148
    v_rsq_f32 v148, v148
    v_pk_add_f32 v[76:77], v[76:77], v[80:81] neg_lo:[0,1] neg_hi:[0,1]
    v_pk_add_f32 v[78:79], v[78:79], v[82:83] neg_lo:[0,1] neg_hi:[0,1]
    v_pk_mul_f32 v[76:77], v[76:77], v[148:149] op_sel_hi:[1,0]
    v_pk_mul_f32 v[78:79], v[78:79], v[148:149] op_sel_hi:[1,0]
    v_cvt_pk_f16_f32 v76, v76, v77
    s_add_u32 m0, s37, 18432
    s_add_u32 s38, s38, 57344
    buffer_load_dwordx4 v6, s[12:15], s38 offen lds
    buffer_load_dwordx4 v7, s[12:15], s38 offen offset:1024 lds
    v_cvt_pk_f16_f32 v77, v78, v79
    ds_write_b64 v150, v[76:77] offset:2048
    v_pk_add_f32 v[88:89], v[88:89], v[92:93] neg_lo:[0,1] neg_hi:[0,1]
    v_pk_add_f32 v[90:91], v[90:91], v[94:95] neg_lo:[0,1] neg_hi:[0,1]
    v_pk_mul_f32 v[88:89], v[88:89], v[148:149] op_sel_hi:[1,0]
    v_pk_mul_f32 v[90:91], v[90:91], v[148:149] op_sel_hi:[1,0]
    v_cvt_pk_f16_f32 v88, v88, v89
    v_cvt_pk_f16_f32 v89, v90, v91
    ds_write_b64 v150, v[88:89] offset:6144
    v_pk_fma_f32 v[72:73], v[164:165], v[98:99], v[72:73] op_sel_hi:[1,0,1]
    v_pk_fma_f32 v[74:75], v[166:167], v[98:99], v[74:75] op_sel_hi:[1,0,1]
    v_pk_mul_f32 v[72:73], v[72:73], v[148:149] op_sel_hi:[1,0]
    v_pk_mul_f32 v[74:75], v[74:75], v[148:149] op_sel_hi:[1,0]
    v_cvt_pk_f16_f32 v72, v72, v73
    v_cvt_pk_f16_f32 v73, v74, v75
    ds_write_b64 v150, v[72:73] offset:0
    s_add_u32 m0, s37, 20480
    s_add_u32 s38, s38, 57344
    buffer_load_dwordx4 v6, s[12:15], s38 offen lds
    buffer_load_dwordx4 v7, s[12:15], s38 offen offset:1024 lds
    v_pk_mul_f32 v[84:85], v[84:85], v[148:149] op_sel_hi:[1,0]
    v_pk_mul_f32 v[86:87], v[86:87], v[148:149] op_sel_hi:[1,0]
    v_cvt_pk_f16_f32 v84, v84, v85
    v_cvt_pk_f16_f32 v85, v86, v87
    ds_write_b64 v150, v[84:85] offset:4096
    s_waitcnt lgkmcnt(0)
    s_barrier
    ds_read_b64_tr_b16 v[72:73], v14 offset:0
    ds_read_b64_tr_b16 v[74:75], v14 offset:512
    ds_read_b64_tr_b16 v[88:89], v14 offset:4096
    ds_read_b64_tr_b16 v[90:91], v14 offset:4608
    ds_read_b64_tr_b16 v[76:77], v14 offset:1024
    ds_read_b64_tr_b16 v[78:79], v14 offset:1536
    ds_read_b64_tr_b16 v[92:93], v14 offset:5120
    ds_read_b64_tr_b16 v[94:95], v14 offset:5632
    ds_read_b64_tr_b16 v[80:81], v14 offset:2048
    ds_read_b64_tr_b16 v[82:83], v14 offset:2560
    ds_read_b64_tr_b16 v[96:97], v14 offset:6144
    ds_read_b64_tr_b16 v[98:99], v14 offset:6656
    ds_read_b64_tr_b16 v[84:85], v14 offset:3072
    ds_read_b64_tr_b16 v[86:87], v14 offset:3584
    ds_read_b64_tr_b16 v[100:101], v14 offset:7168
    ds_read_b64_tr_b16 v[102:103], v14 offset:7680
    v_cndmask_b32 v11, 0, v164, s[52:53]
    v_cndmask_b32 v11, v11, v165, s[54:55]
    v_cndmask_b32 v11, v11, v166, s[56:57]
    v_cndmask_b32 v11, v11, v167, s[58:59]
    s_waitcnt lgkmcnt(14)
    v_mfma_f32_16x16x32_f16 v[104:107], v[140:143], v[72:75], 0
    s_waitcnt lgkmcnt(12)
    v_mfma_f32_16x16x32_f16 v[112:115], v[140:143], v[88:91], 0
    s_waitcnt lgkmcnt(10)
    v_mfma_f32_16x16x32_f16 v[104:107], v[144:147], v[76:79], v[104:107]
    s_waitcnt lgkmcnt(8)
    v_mfma_f32_16x16x32_f16 v[112:115], v[144:147], v[92:95], v[112:115]
    s_waitcnt lgkmcnt(6)
    v_mfma_f32_16x16x32_f16 v[108:111], v[140:143], v[80:83], 0
    s_waitcnt lgkmcnt(4)
    v_mfma_f32_16x16x32_f16 v[116:119], v[140:143], v[96:99], 0
    s_waitcnt lgkmcnt(2)
    v_mfma_f32_16x16x32_f16 v[108:111], v[144:147], v[84:87], v[108:111]
    s_waitcnt lgkmcnt(0)
    v_mfma_f32_16x16x32_f16 v[116:119], v[144:147], v[100:103], v[116:119]
    s_barrier
    v_fma_f32 v120, v151, v113, v104
    v_fma_f32 v121, v151, v105, -v112
    v_fma_f32 v122, -v151, v104, v113
    v_fma_f32 v123, v151, v112, v105
    v_cvt_pk_f16_f32 v72, v120, v121
    v_cvt_pk_f16_f32 v73, v122, v123
    v_bfi_b32 v72, v254, s28, v72
    v_bfi_b32 v73, v254, s29, v73
    v_fma_f32 v128, -1.0, v115, v106
    v_fma_f32 v129, -1.0, v107, -v114
    v_fma_f32 v130, 1.0, v106, v115
    v_fma_f32 v131, -1.0, v114, v107
    v_cvt_pk_f16_f32 v76, v128, v129
    v_cvt_pk_f16_f32 v77, v130, v131
    v_bfi_b32 v76, v254, s28, v76
    v_bfi_b32 v77, v254, s29, v77
    v_fma_f32 v124, v151, v117, v108
    v_fma_f32 v125, v151, v109, -v116
    v_fma_f32 v126, -v151, v108, v117
    v_fma_f32 v127, v151, v116, v109
    v_cvt_pk_f16_f32 v74, v124, v125
    v_cvt_pk_f16_f32 v75, v126, v127
    v_bfi_b32 v74, v254, s30, v74
    v_bfi_b32 v75, v254, s31, v75
    buffer_store_dwordx4 v[72:75], v15, s[24:27], s46 offen sc1
    v_fma_f32 v132, -1.0, v119, v110
    v_fma_f32 v133, -1.0, v111, -v118
    v_fma_f32 v134, 1.0, v110, v119
    v_fma_f32 v135, -1.0, v118, v111
    v_cvt_pk_f16_f32 v78, v132, v133
    v_cvt_pk_f16_f32 v79, v134, v135
    v_bfi_b32 v78, v254, s30, v78
    v_bfi_b32 v79, v254, s31, v79
    buffer_store_dwordx4 v[76:79], v15, s[24:27], s47 offen sc1
    s_waitcnt vmcnt(22)
    ds_read_b64_tr_b16 a[0:1], v8 offset:0
    ds_read_b64_tr_b16 a[2:3], v8 offset:512
    ds_read_b64_tr_b16 a[4:5], v9 offset:0
    ds_read_b64_tr_b16 a[6:7], v9 offset:512
    s_waitcnt vmcnt(20)
    ds_read_b64_tr_b16 a[8:9], v8 offset:2048
    ds_read_b64_tr_b16 a[10:11], v8 offset:2560
    ds_read_b64_tr_b16 a[12:13], v9 offset:2048
    ds_read_b64_tr_b16 a[14:15], v9 offset:2560
    s_waitcnt vmcnt(18)
    ds_read_b64_tr_b16 a[16:17], v8 offset:4096
    ds_read_b64_tr_b16 a[18:19], v8 offset:4608
    ds_read_b64_tr_b16 a[20:21], v9 offset:4096
    ds_read_b64_tr_b16 a[22:23], v9 offset:4608
    s_waitcnt vmcnt(16)
    ds_read_b64_tr_b16 a[24:25], v8 offset:6144
    ds_read_b64_tr_b16 a[26:27], v8 offset:6656
    ds_read_b64_tr_b16 a[28:29], v9 offset:6144
    ds_read_b64_tr_b16 a[30:31], v9 offset:6656
    s_waitcnt lgkmcnt(12)
    s_add_u32 m0, s37, 0
    s_add_u32 s38, s38, 57344
    buffer_load_dwordx4 v6, s[12:15], s38 offen lds
    buffer_load_dwordx4 v7, s[12:15], s38 offen offset:1024 lds
    s_waitcnt vmcnt(16)
    ds_read_b64_tr_b16 a[32:33], v8 offset:8192
    ds_read_b64_tr_b16 a[34:35], v8 offset:8704
    ds_read_b64_tr_b16 a[36:37], v9 offset:8192
    ds_read_b64_tr_b16 a[38:39], v9 offset:8704
    s_waitcnt lgkmcnt(12)
    s_add_u32 m0, s37, 2048
    s_add_u32 s38, s38, 57344
    buffer_load_dwordx4 v6, s[12:15], s38 offen lds
    buffer_load_dwordx4 v7, s[12:15], s38 offen offset:1024 lds
    s_cmp_lt_u32 s32, 2
    s_cbranch_scc1 L_t0_0
    s_mov_b64 exec, 0
    s_cmp_eq_u32 s32, 2
    s_cbranch_scc1 L_pad5
    s_branch L_pad6
L_t0_0:
    v_and_b32 v88, 15, v0
    v_lshl_add_u32 v88, s32, 4, v88
    v_mul_u32_u24 v88, 912, v88
    v_and_b32 v89, 48, v0
    v_add_u32 v88, v88, v89
    s_mul_i32 s42, s33, 128
    v_add_u32 v89, s42, v88
    ds_write_b128 v89, v[16:19] offset:0
    ds_write_b128 v89, v[20:23] offset:64
    s_add_u32 s42, s42, 128
    s_sub_u32 s43, s42, 896
    s_min_u32 s42, s42, s43
    v_add_u32 v89, s42, v88
    ds_write_b128 v89, v[24:27] offset:0
    ds_write_b128 v89, v[28:31] offset:64
    s_add_u32 s42, s42, 128
    s_sub_u32 s43, s42, 896
    s_min_u32 s42, s42, s43
    v_add_u32 v89, s42, v88
    ds_write_b128 v89, v[32:35] offset:0
    ds_write_b128 v89, v[36:39] offset:64
    s_add_u32 s42, s42, 128
    s_sub_u32 s43, s42, 896
    s_min_u32 s42, s42, s43
    v_add_u32 v89, s42, v88
    ds_write_b128 v89, v[40:43] offset:0
    ds_write_b128 v89, v[44:47] offset:64
    s_add_u32 s42, s42, 128
    s_sub_u32 s43, s42, 896
    s_min_u32 s42, s42, s43
    v_add_u32 v89, s42, v88
    ds_write_b128 v89, v[48:51] offset:0
    ds_write_b128 v89, v[52:55] offset:64
    s_add_u32 s42, s42, 128
    s_sub_u32 s43, s42, 896
    s_min_u32 s42, s42, s43
    v_add_u32 v89, s42, v88
    ds_write_b128 v89, v[56:59] offset:0
    ds_write_b128 v89, v[60:63] offset:64
    s_add_u32 s42, s42, 128
    s_sub_u32 s43, s42, 896
    s_min_u32 s42, s42, s43
    v_add_u32 v89, s42, v88
    ds_write_b128 v89, v[64:67] offset:0
    ds_write_b128 v89, v[68:71] offset:64
L_ret1:
    s_mov_b64 exec, -1
    s_waitcnt vmcnt(16)
    ds_read_b64_tr_b16 a[40:41], v8 offset:10240
    ds_read_b64_tr_b16 a[42:43], v8 offset:10752
    ds_read_b64_tr_b16 a[44:45], v9 offset:10240
    ds_read_b64_tr_b16 a[46:47], v9 offset:10752
    s_waitcnt lgkmcnt(12)
    s_add_u32 m0, s37, 4096
    s_add_u32 s38, s38, 57344
    buffer_load_dwordx4 v6, s[12:15], s38 offen lds
    buffer_load_dwordx4 v7, s[12:15], s38 offen offset:1024 lds
    s_waitcnt vmcnt(16)
    ds_read_b64_tr_b16 a[48:49], v8 offset:12288
    ds_read_b64_tr_b16 a[50:51], v8 offset:12800
    ds_read_b64_tr_b16 a[52:53], v9 offset:12288
    ds_read_b64_tr_b16 a[54:55], v9 offset:12800
    s_mul_i32 s42, s34, 229376
    s_waitcnt lgkmcnt(12)
    s_add_u32 m0, s37, 6144
    s_add_u32 s38, s38, 57344
    buffer_load_dwordx4 v6, s[12:15], s38 offen lds
    buffer_load_dwordx4 v7, s[12:15], s38 offen offset:1024 lds
    s_waitcnt vmcnt(16)
    ds_read_b64_tr_b16 a[56:57], v8 offset:14336
    ds_read_b64_tr_b16 a[58:59], v8 offset:14848
    ds_read_b64_tr_b16 a[60:61], v9 offset:14336
    ds_read_b64_tr_b16 a[62:63], v9 offset:14848
    s_lshl_b32 s43, s32, 12
    s_add_u32 s42, s42, s43
    s_add_u32 s42, s42, 5505024
    s_mov_b32 s45, 1
    s_mov_b32 s43, s33
    s_lshl_b32 s44, s43, 14
    s_add_u32 s60, s42, s44
    s_add_u32 s43, s43, s45
    s_sub_u32 s44, s43, 7
    s_min_u32 s43, s43, s44
    s_lshl_b32 s44, s43, 14
    s_add_u32 s61, s42, s44
    s_add_u32 s43, s43, s45
    s_sub_u32 s44, s43, 7
    s_waitcnt lgkmcnt(12)
    s_add_u32 m0, s37, 8192
    s_add_u32 s38, s38, 57344
    buffer_load_dwordx4 v6, s[12:15], s38 offen lds
    buffer_load_dwordx4 v7, s[12:15], s38 offen offset:1024 lds
    s_waitcnt vmcnt(16)
    ds_read_b64_tr_b16 a[64:65], v8 offset:16384
    ds_read_b64_tr_b16 a[66:67], v8 offset:16896
    ds_read_b64_tr_b16 a[68:69], v9 offset:16384
    ds_read_b64_tr_b16 a[70:71], v9 offset:16896
    s_min_u32 s43, s43, s44
    s_lshl_b32 s44, s43, 14
    s_add_u32 s62, s42, s44
    s_add_u32 s43, s43, s45
    s_sub_u32 s44, s43, 7
    s_min_u32 s43, s43, s44
    s_lshl_b32 s44, s43, 14
    s_add_u32 s63, s42, s44
    s_add_u32 s43, s43, s45
    s_sub_u32 s44, s43, 7
    s_min_u32 s43, s43, s44
    s_lshl_b32 s44, s43, 14
    s_add_u32 s64, s42, s44
    s_add_u32 s43, s43, s45
    s_sub_u32 s44, s43, 7
    s_min_u32 s43, s43, s44
    s_lshl_b32 s44, s43, 14
    s_add_u32 s65, s42, s44
    s_add_u32 s43, s43, s45
    s_sub_u32 s44, s43, 7
    s_min_u32 s43, s43, s44
    s_lshl_b32 s44, s43, 14
    s_add_u32 s66, s42, s44
    v_bfe_u32 v88, v0, 2, 1
    v_bfe_u32 v89, v0, 3, 2
    v_and_b32 v90, 3, v0
    v_lshl_add_u32 v89, v88, 2, v89
    v_lshl_add_u32 v89, v89, 2, v90
    s_mul_i32 s44, s32, 448
    s_waitcnt lgkmcnt(12)
    s_add_u32 m0, s37, 10240
    s_add_u32 s38, s38, 57344
    buffer_load_dwordx4 v6, s[12:15], s38 offen lds
    buffer_load_dwordx4 v7, s[12:15], s38 offen offset:1024 lds
    s_waitcnt vmcnt(16)
    ds_read_b64_tr_b16 a[72:73], v8 offset:18432
    ds_read_b64_tr_b16 a[74:75], v8 offset:18944
    ds_read_b64_tr_b16 a[76:77], v9 offset:18432
    ds_read_b64_tr_b16 a[78:79], v9 offset:18944
    v_lshl_add_u32 v89, v89, 4, s44
    v_subrev_u32 v88, 1792, v89
    v_min_u32 v89, v88, v89
    v_lshrrev_b32 v90, 5, v0
    v_mul_u32_u24 v88, 1792, v90
    v_add_u32 v12, v88, v89
    v_add_u32 v252, 7168, v12
    s_mul_i32 s42, s34, 57344
    s_add_u32 s42, s42, 0
    s_add_u32 s43, s33, 0
    s_and_b32 s43, s43, 3
    s_mul_i32 s43, s43, 14336
    s_add_u32 s4, s42, s43
    s_add_u32 s43, s33, 1
    s_and_b32 s43, s43, 3
    s_mul_i32 s43, s43, 14336
    s_add_u32 s5, s42, s43
    s_add_u32 s43, s33, 2
    s_and_b32 s43, s43, 3
    s_mul_i32 s43, s43, 14336
    s_add_u32 s6, s42, s43
    s_add_u32 s43, s33, 3
    s_and_b32 s43, s43, 3
    s_mul_i32 s43, s43, 14336
    s_add_u32 s7, s42, s43
    v_and_b32 v96, 31, v0
    v_lshlrev_b32 v96, 6, v96
    v_lshrrev_b32 v97, 5, v0
    s_add_u32 s42, s32, s33
    s_waitcnt lgkmcnt(12)
    s_add_u32 m0, s37, 12288
    s_add_u32 s38, s38, 57344
    buffer_load_dwordx4 v6, s[12:15], s38 offen lds
    buffer_load_dwordx4 v7, s[12:15], s38 offen offset:1024 lds
    s_waitcnt vmcnt(16)
    ds_read_b64_tr_b16 a[80:81], v8 offset:20480
    ds_read_b64_tr_b16 a[82:83], v8 offset:20992
    ds_read_b64_tr_b16 a[84:85], v9 offset:20480
    ds_read_b64_tr_b16 a[86:87], v9 offset:20992
    s_and_b32 s42, s42, 3
    s_lshl_b32 s42, s42, 2
    s_lshl_b32 s43, s42, 1
    s_sub_u32 s43, 32, s43
    s_cmp_eq_u32 s42, 0
    s_cselect_b32 s43, 16, s43
    v_mul_u32_u24 v132, s43, v97
    v_add_u32 v132, s42, v132
    v_cvt_f32_u32 v132, v132
    s_add_u32 s42, s42, 1
    s_lshl_b32 s43, s42, 1
    s_sub_u32 s43, 32, s43
    v_mul_u32_u24 v133, s43, v97
    v_add_u32 v133, s42, v133
    v_cvt_f32_u32 v133, v133
    s_add_u32 s42, s42, 1
    s_lshl_b32 s43, s42, 1
    s_sub_u32 s43, 32, s43
    v_mul_u32_u24 v134, s43, v97
    v_add_u32 v134, s42, v134
    v_cvt_f32_u32 v134, v134
    s_add_u32 s42, s42, 1
    s_lshl_b32 s43, s42, 1
    s_sub_u32 s43, 32, s43
    v_mul_u32_u24 v135, s43, v97
    v_add_u32 v135, s42, v135
    v_cvt_f32_u32 v135, v135
    s_lshl_b32 s42, s32, 10
    s_waitcnt lgkmcnt(12)
    s_add_u32 m0, s37, 14336
    s_add_u32 s38, s38, 57344
    buffer_load_dwordx4 v6, s[12:15], s38 offen lds
    buffer_load_dwordx4 v7, s[12:15], s38 offen offset:1024 lds
    s_waitcnt vmcnt(14)
    ds_read_b64_tr_b16 a[88:89], v8 offset:0
    ds_read_b64_tr_b16 a[90:91], v8 offset:512
    ds_read_b64_tr_b16 a[92:93], v9 offset:0
    ds_read_b64_tr_b16 a[94:95], v9 offset:512
    s_add_u32 s42, s42, 65536
    v_add_u32 v98, s42, v1
    s_cmp_eq_u32 s34, 0
    s_cselect_b32 s42, 0x3e800000, 0
    v_add_u32 v112, s34, v96
    v_cvt_f32_u32 v112, v112
    v_mul_f32 v112, 0x3a000000, v112
    v_mul_f32 v100, v112, v132
    v_mul_f32 v101, v112, v133
    v_mul_f32 v102, v112, v134
    v_mul_f32 v103, v112, v135
    v_sin_f32 v104, v100
    v_sin_f32 v105, v101
    v_sin_f32 v106, v102
    v_sin_f32 v107, v103
    v_cos_f32 v100, v100
    v_cos_f32 v101, v101
    v_cos_f32 v102, v102
    v_cos_f32 v103, v103
    v_cvt_pk_f16_f32 v108, v100, v104
    v_cvt_pk_f16_f32 v109, v101, v105
    v_cvt_pk_f16_f32 v110, v102, v106
    v_cvt_pk_f16_f32 v111, v103, v107
    ds_write_b128 v98, v[108:111] offset:0
    s_waitcnt lgkmcnt(13)
    s_add_u32 m0, s37, 16384
    s_add_u32 s38, s38, 57344
    buffer_load_dwordx4 v6, s[12:15], s38 offen lds
    buffer_load_dwordx4 v7, s[12:15], s38 offen offset:1024 lds
    s_waitcnt vmcnt(14)
    ds_read_b64_tr_b16 a[96:97], v8 offset:2048
    ds_read_b64_tr_b16 a[98:99], v8 offset:2560
    ds_read_b64_tr_b16 a[100:101], v9 offset:2048
    ds_read_b64_tr_b16 a[102:103], v9 offset:2560
    v_add_u32 v128, s35, v96
    v_cvt_f32_u32 v128, v128
    v_mul_f32 v128, 0x3a000000, v128
    v_fma_f32 v116, v128, v132, s42
    v_fma_f32 v117, v128, v133, s42
    v_fma_f32 v118, v128, v134, s42
    v_fma_f32 v119, v128, v135, s42
    v_sin_f32 v120, v116
    v_sin_f32 v121, v117
    v_sin_f32 v122, v118
    v_sin_f32 v123, v119
    v_cos_f32 v116, v116
    v_cos_f32 v117, v117
    v_cos_f32 v118, v118
    v_cos_f32 v119, v119
    v_cvt_pk_f16_f32 v124, v116, v120
    v_cvt_pk_f16_f32 v125, v117, v121
    v_cvt_pk_f16_f32 v126, v118, v122
    v_cvt_pk_f16_f32 v127, v119, v123
    ds_write_b128 v98, v[124:127] offset:4096
    v_and_b32 v91, 31, v0
    s_mul_i32 s42, s32, 7
    v_lshl_add_u32 v92, v90, 2, s42
    v_mul_u32_u24 v13, 912, v91
    v_mul_u32_u24 v89, 16, v92
    v_add_u32 v13, v13, v89
    v_sub_u32 v92, 832, v89
    s_cmp_eq_u32 s34, 0
    s_cselect_b32 s42, 32, 63
    s_cselect_b32 s43, 31, 63
    s_cselect_b32 s44, 63, 31
    v_sub_u32 v93, s42, v91
    v_and_b32 v93, s43, v93
    v_mul_u32_u24 v14, 912, v93
    v_add_u32 v14, v14, v92
    v_sub_u32 v93, s44, v91
    v_mul_u32_u24 v15, 912, v93
    v_add_u32 v15, v15, v92
    s_cmp_eq_u32 s32, 0
    s_cselect_b32 s52, 0, -1
    s_mov_b32 s53, -1
    v_add_u32 v253, 65536, v1
    s_mul_i32 s42, s32, 112
    v_mul_u32_u24 v90, 48, v90
    v_subrev_u32 v255, s42, v13
    v_sub_u32 v255, v255, v90
    s_mov_b32 s54, 0xfffefffe
    s_lshl_b32 s49, s32, 7
    v_lshlrev_b32 v2, 9, s33
    s_add_u32 s49, s49, 15056896
    s_mov_b64 exec, 1
    buffer_load_dword v3, v2, s[24:27], s49 offen sc1
    s_mov_b64 exec, -1
    buffer_load_dwordx4 v[16:19], v12, s[24:27], s4 offen offset:0 sc1
    s_waitcnt vmcnt(14)
    ds_read_b64_tr_b16 a[104:105], v8 offset:4096
    ds_read_b64_tr_b16 a[106:107], v8 offset:4608
    ds_read_b64_tr_b16 a[108:109], v9 offset:4096
    ds_read_b64_tr_b16 a[110:111], v9 offset:4608
    buffer_load_dwordx4 v[20:23], v12, s[24:27], s4 offen offset:3584 sc1
    s_waitcnt vmcnt(13)
    ds_read_b64_tr_b16 a[112:113], v8 offset:6144
    ds_read_b64_tr_b16 a[114:115], v8 offset:6656
    ds_read_b64_tr_b16 a[116:117], v9 offset:6144
    ds_read_b64_tr_b16 a[118:119], v9 offset:6656
    buffer_load_dwordx4 v[24:27], v252, s[24:27], s4 offen offset:0 sc1
    s_waitcnt vmcnt(12)
    ds_read_b64_tr_b16 a[120:121], v8 offset:8192
    ds_read_b64_tr_b16 a[122:123], v8 offset:8704
    ds_read_b64_tr_b16 a[124:125], v9 offset:8192
    ds_read_b64_tr_b16 a[126:127], v9 offset:8704
    buffer_load_dwordx4 v[28:31], v252, s[24:27], s4 offen offset:3584 sc1
L_pad2:
    s_cbranch_execz L_ret0
    s_waitcnt vmcnt(11)
    ds_read_b64_tr_b16 a[128:129], v8 offset:10240
    ds_read_b64_tr_b16 a[130:131], v8 offset:10752
    ds_read_b64_tr_b16 a[132:133], v9 offset:10240
    ds_read_b64_tr_b16 a[134:135], v9 offset:10752
    buffer_load_dwordx4 v[32:35], v12, s[24:27], s5 offen offset:0 sc1
    s_waitcnt vmcnt(10)
    ds_read_b64_tr_b16 a[136:137], v8 offset:12288
    ds_read_b64_tr_b16 a[138:139], v8 offset:12800
    ds_read_b64_tr_b16 a[140:141], v9 offset:12288
    ds_read_b64_tr_b16 a[142:143], v9 offset:12800
    buffer_load_dwordx4 v[36:39], v12, s[24:27], s5 offen offset:3584 sc1
    s_waitcnt vmcnt(9)
    ds_read_b64_tr_b16 a[144:145], v8 offset:14336
    ds_read_b64_tr_b16 a[146:147], v8 offset:14848
    ds_read_b64_tr_b16 a[148:149], v9 offset:14336
    ds_read_b64_tr_b16 a[150:151], v9 offset:14848
    buffer_load_dwordx4 v[40:43], v252, s[24:27], s5 offen offset:0 sc1
    s_waitcnt vmcnt(8)
    ds_read_b64_tr_b16 a[152:153], v8 offset:16384
    ds_read_b64_tr_b16 a[154:155], v8 offset:16896
    ds_read_b64_tr_b16 a[156:157], v9 offset:16384
    ds_read_b64_tr_b16 a[158:159], v9 offset:16896
    buffer_load_dwordx4 v[44:47], v252, s[24:27], s5 offen offset:3584 sc1
    buffer_load_dwordx4 v[48:51], v12, s[24:27], s6 offen offset:0 sc1
    buffer_load_dwordx4 v[52:55], v12, s[24:27], s6 offen offset:3584 sc1
    buffer_load_dwordx4 v[56:59], v252, s[24:27], s6 offen offset:0 sc1
    s_waitcnt lgkmcnt(0)
    s_barrier
    ds_read_b128 v[144:147], v253 offset:0
    ds_read_b128 v[148:151], v253 offset:4096
    s_waitcnt vmcnt(7)
    buffer_load_dwordx4 v[60:63], v252, s[24:27], s6 offen offset:3584 sc1
    buffer_load_dwordx4 v[64:67], v12, s[24:27], s7 offen offset:0 sc1
    buffer_load_dwordx4 v[68:71], v12, s[24:27], s7 offen offset:3584 sc1
    buffer_load_dwordx4 v[72:75], v252, s[24:27], s7 offen offset:0 sc1
    buffer_load_dwordx4 v[76:79], v252, s[24:27], s7 offen offset:3584 sc1
    v_cmp_ne_u32 vcc, s28, v3
    s_nop 0
    s_and_b64 vcc, vcc, 1
    s_cbranch_scc1 slow_f0_x_1
ok_f0_x_2:
    v_xor_b32 v254, s28, v16
    v_bitop3_b32 v254, v254, v17, s29 bitop3:0xf6
    v_bitop3_b32 v254, v254, v18, s30 bitop3:0xf6
    v_bitop3_b32 v254, v254, v19, s31 bitop3:0xf6
    v_bitop3_b32 v254, v254, v20, s28 bitop3:0xf6
    v_bitop3_b32 v254, v254, v21, s29 bitop3:0xf6
    v_bitop3_b32 v254, v254, v22, s30 bitop3:0xf6
    v_bitop3_b32 v254, v254, v23, s31 bitop3:0xf6
    v_bitop3_b32 v254, v254, v24, s28 bitop3:0xf6
    v_bitop3_b32 v254, v254, v25, s29 bitop3:0xf6
    v_bitop3_b32 v254, v254, v26, s30 bitop3:0xf6
    v_bitop3_b32 v254, v254, v27, s31 bitop3:0xf6
    v_bitop3_b32 v254, v254, v28, s28 bitop3:0xf6
    v_bitop3_b32 v254, v254, v29, s29 bitop3:0xf6
    v_bitop3_b32 v254, v254, v30, s30 bitop3:0xf6
    v_bitop3_b32 v254, v254, v31, s31 bitop3:0xf6
    v_and_b32 v254, 0x10001, v254
    v_cmp_ne_u32 vcc, 0, v254
    s_cbranch_vccnz slow_U0_0_3
ok_U0_0_4:
    v_and_b32 v220, s54, v16
    v_and_b32 v221, s54, v20
    v_and_b32 v222, s54, v24
    v_and_b32 v223, s54, v28
    v_and_b32 v228, s54, v18
    v_and_b32 v229, s54, v22
    v_and_b32 v230, s54, v26
    v_and_b32 v231, s54, v30
    s_waitcnt lgkmcnt(1)
    v_mfma_f32_32x32x16_f16 v[80:95], v[220:223], v[144:147], 0
    v_and_b32 v224, s54, v17
    v_and_b32 v225, s54, v21
    v_and_b32 v226, s54, v25
    v_and_b32 v227, s54, v29
    v_mfma_f32_32x32x16_f16 v[96:111], v[228:231], v[144:147], 0
    ds_read_b128 v[144:147], v253 offset:1024
    v_and_b32 v232, s54, v19
    v_and_b32 v233, s54, v23
    v_and_b32 v234, s54, v27
    v_and_b32 v235, s54, v31
    s_waitcnt lgkmcnt(1)
    v_mfma_f32_32x32x16_f16 v[112:127], v[224:227], v[148:151], 0
    v_mfma_f32_32x32x16_f16 v[128:143], v[232:235], v[148:151], 0
    ds_read_b128 v[148:151], v253 offset:5120
    ds_read_b128 v[16:19], v13 offset:0
    ds_read_b128 v[20:23], v14 offset:48
    ds_read_b128 v[24:27], v13 offset:16
    ds_read_b128 v[28:31], v14 offset:32
    s_waitcnt vmcnt(8)
    v_xor_b32 v254, s28, v32
    v_bitop3_b32 v254, v254, v33, s29 bitop3:0xf6
    v_bitop3_b32 v254, v254, v34, s30 bitop3:0xf6
    v_bitop3_b32 v254, v254, v35, s31 bitop3:0xf6
    v_bitop3_b32 v254, v254, v36, s28 bitop3:0xf6
    v_bitop3_b32 v254, v254, v37, s29 bitop3:0xf6
    v_bitop3_b32 v254, v254, v38, s30 bitop3:0xf6
    v_bitop3_b32 v254, v254, v39, s31 bitop3:0xf6
    v_bitop3_b32 v254, v254, v40, s28 bitop3:0xf6
    v_bitop3_b32 v254, v254, v41, s29 bitop3:0xf6
    v_bitop3_b32 v254, v254, v42, s30 bitop3:0xf6
    v_bitop3_b32 v254, v254, v43, s31 bitop3:0xf6
    v_bitop3_b32 v254, v254, v44, s28 bitop3:0xf6
    v_bitop3_b32 v254, v254, v45, s29 bitop3:0xf6
    v_bitop3_b32 v254, v254, v46, s30 bitop3:0xf6
    v_bitop3_b32 v254, v254, v47, s31 bitop3:0xf6
    v_and_b32 v254, 0x10001, v254
    v_cmp_ne_u32 vcc, 0, v254
    s_cbranch_vccnz slow_U0_1_5
ok_U0_1_6:
    s_lshl_b32 s38, s33, 2
    s_add_u32 s38, s38, s32
    s_mul_i32 s38, s38, 73728
    s_add_u32 s38, s38, 12976128
    buffer_load_dwordx4 a[160:163], v1, s[24:27], s38 offen offset:0 sc1
    buffer_load_dwordx4 a[164:167], v1, s[24:27], s38 offen offset:1024 sc1
    v_and_b32 v236, s54, v32
    v_and_b32 v237, s54, v36
    v_and_b32 v238, s54, v40
    v_and_b32 v239, s54, v44
    v_and_b32 v244, s54, v34
    v_and_b32 v245, s54, v38
    v_and_b32 v246, s54, v42
    v_and_b32 v247, s54, v46
    s_waitcnt lgkmcnt(5)
    v_mfma_f32_32x32x16_f16 v[80:95], v[236:239], v[144:147], v[80:95]
    v_and_b32 v240, s54, v33
    v_and_b32 v241, s54, v37
    v_and_b32 v242, s54, v41
    v_and_b32 v243, s54, v45
    v_mfma_f32_32x32x16_f16 v[96:111], v[244:247], v[144:147], v[96:111]
    buffer_load_dwordx4 a[168:171], v1, s[24:27], s38 offen offset:2048 sc1
    buffer_load_dwordx4 a[172:175], v1, s[24:27], s38 offen offset:3072 sc1
    ds_read_b128 v[144:147], v253 offset:2048
    v_and_b32 v248, s54, v35
    v_and_b32 v249, s54, v39
    v_and_b32 v250, s54, v43
    v_and_b32 v251, s54, v47
    s_waitcnt lgkmcnt(5)
    v_mfma_f32_32x32x16_f16 v[112:127], v[240:243], v[148:151], v[112:127]
    v_mfma_f32_32x32x16_f16 v[128:143], v[248:251], v[148:151], v[128:143]
    ds_read_b128 v[148:151], v253 offset:6144
    ds_read_b128 v[32:35], v13 offset:32
    ds_read_b128 v[36:39], v14 offset:16
    v_mov_b32 v40, v13
    v_mov_b32 v41, v14
    s_mov_b32 exec_lo, 0
    v_add_u32 v40, 29120, v13
    v_add_u32 v41, 64, v15
    s_mov_b32 exec_lo, -1
    s_waitcnt vmcnt(8)
    v_xor_b32 v254, s28, v48
    v_bitop3_b32 v254, v254, v49, s29 bitop3:0xf6
    v_bitop3_b32 v254, v254, v50, s30 bitop3:0xf6
    v_bitop3_b32 v254, v254, v51, s31 bitop3:0xf6
    v_bitop3_b32 v254, v254, v52, s28 bitop3:0xf6
    v_bitop3_b32 v254, v254, v53, s29 bitop3:0xf6
    v_bitop3_b32 v254, v254, v54, s30 bitop3:0xf6
    v_bitop3_b32 v254, v254, v55, s31 bitop3:0xf6
    v_bitop3_b32 v254, v254, v56, s28 bitop3:0xf6
    v_bitop3_b32 v254, v254, v57, s29 bitop3:0xf6
    v_bitop3_b32 v254, v254, v58, s30 bitop3:0xf6
    v_bitop3_b32 v254, v254, v59, s31 bitop3:0xf6
    v_bitop3_b32 v254, v254, v60, s28 bitop3:0xf6
    v_bitop3_b32 v254, v254, v61, s29 bitop3:0xf6
    v_bitop3_b32 v254, v254, v62, s30 bitop3:0xf6
    v_bitop3_b32 v254, v254, v63, s31 bitop3:0xf6
    v_and_b32 v254, 0x10001, v254
    v_cmp_ne_u32 vcc, 0, v254
    s_cbranch_vccnz slow_U0_2_7
ok_U0_2_8:
    s_add_u32 s38, s38, 4096
    buffer_load_dwordx4 a[176:179], v1, s[24:27], s38 offen offset:0 sc1
    buffer_load_dwordx4 a[180:183], v1, s[24:27], s38 offen offset:1024 sc1
    v_and_b32 v220, s54, v48
    v_and_b32 v221, s54, v52
    v_and_b32 v222, s54, v56
    v_and_b32 v223, s54, v60
    v_and_b32 v228, s54, v50
    v_and_b32 v229, s54, v54
    v_and_b32 v230, s54, v58
    v_and_b32 v231, s54, v62
    s_waitcnt lgkmcnt(3)
    v_mfma_f32_32x32x16_f16 v[80:95], v[220:223], v[144:147], v[80:95]
    v_and_b32 v224, s54, v49
    v_and_b32 v225, s54, v53
    v_and_b32 v226, s54, v57
    v_and_b32 v227, s54, v61
    v_mfma_f32_32x32x16_f16 v[96:111], v[228:231], v[144:147], v[96:111]
    buffer_load_dwordx4 a[184:187], v1, s[24:27], s38 offen offset:2048 sc1
    buffer_load_dwordx4 a[188:191], v1, s[24:27], s38 offen offset:3072 sc1
    ds_read_b128 v[144:147], v253 offset:3072
    v_and_b32 v232, s54, v51
    v_and_b32 v233, s54, v55
    v_and_b32 v234, s54, v59
    v_and_b32 v235, s54, v63
    s_waitcnt lgkmcnt(3)
    v_mfma_f32_32x32x16_f16 v[112:127], v[224:227], v[148:151], v[112:127]
    v_mfma_f32_32x32x16_f16 v[128:143], v[232:235], v[148:151], v[128:143]
    ds_read_b128 v[148:151], v253 offset:7168
    s_lshl_b32 s49, s32, 7
    v_lshlrev_b32 v2, 9, v0
    s_add_u32 s49, s49, 15060992
    s_mov_b64 exec, 127
    buffer_load_dword v3, v2, s[24:27], s49 offen sc1
    s_mov_b64 exec, -1
    ds_read_b128 v[48:51], v13 offset:29184
    ds_read_b128 v[52:55], v15 offset:48
    ds_read_b128 v[56:59], v13 offset:29200
    ds_read_b128 v[60:63], v15 offset:32
    s_waitcnt vmcnt(9)
    v_xor_b32 v254, s28, v64
    v_bitop3_b32 v254, v254, v65, s29 bitop3:0xf6
    v_bitop3_b32 v254, v254, v66, s30 bitop3:0xf6
    v_bitop3_b32 v254, v254, v67, s31 bitop3:0xf6
    v_bitop3_b32 v254, v254, v68, s28 bitop3:0xf6
    v_bitop3_b32 v254, v254, v69, s29 bitop3:0xf6
    v_bitop3_b32 v254, v254, v70, s30 bitop3:0xf6
    v_bitop3_b32 v254, v254, v71, s31 bitop3:0xf6
    v_bitop3_b32 v254, v254, v72, s28 bitop3:0xf6
    v_bitop3_b32 v254, v254, v73, s29 bitop3:0xf6
    v_bitop3_b32 v254, v254, v74, s30 bitop3:0xf6
    v_bitop3_b32 v254, v254, v75, s31 bitop3:0xf6
    v_bitop3_b32 v254, v254, v76, s28 bitop3:0xf6
    v_bitop3_b32 v254, v254, v77, s29 bitop3:0xf6
    v_bitop3_b32 v254, v254, v78, s30 bitop3:0xf6
    v_bitop3_b32 v254, v254, v79, s31 bitop3:0xf6
    v_and_b32 v254, 0x10001, v254
    v_cmp_ne_u32 vcc, 0, v254
    s_cbranch_vccnz slow_U0_3_9
ok_U0_3_10:
    s_add_u32 s38, s38, 4096
    buffer_load_dwordx4 a[192:195], v1, s[24:27], s38 offen offset:0 sc1
    buffer_load_dwordx4 a[196:199], v1, s[24:27], s38 offen offset:1024 sc1
    v_and_b32 v236, s54, v64
    v_and_b32 v237, s54, v68
    v_and_b32 v238, s54, v72
    v_and_b32 v239, s54, v76
    v_and_b32 v244, s54, v66
    v_and_b32 v245, s54, v70
    v_and_b32 v246, s54, v74
    v_and_b32 v247, s54, v78
    s_waitcnt lgkmcnt(5)
    v_mfma_f32_32x32x16_f16 v[80:95], v[236:239], v[144:147], v[80:95]
    v_and_b32 v240, s54, v65
    v_and_b32 v241, s54, v69
    v_and_b32 v242, s54, v73
    v_and_b32 v243, s54, v77
    v_mfma_f32_32x32x16_f16 v[96:111], v[244:247], v[144:147], v[96:111]
    buffer_load_dwordx4 a[200:203], v1, s[24:27], s38 offen offset:2048 sc1
    buffer_load_dwordx4 a[204:207], v1, s[24:27], s38 offen offset:3072 sc1
    v_and_b32 v248, s54, v67
    v_and_b32 v249, s54, v71
    v_and_b32 v250, s54, v75
    v_and_b32 v251, s54, v79
    s_waitcnt lgkmcnt(4)
    v_mfma_f32_32x32x16_f16 v[112:127], v[240:243], v[148:151], v[112:127]
    v_mfma_f32_32x32x16_f16 v[128:143], v[248:251], v[148:151], v[128:143]
    ds_read_b128 v[64:67], v13 offset:29216
    ds_read_b128 v[68:71], v15 offset:16
    ds_read_b128 v[72:75], v40 offset:48
    ds_read_b128 v[76:79], v41 offset:0
    v_lshrrev_b32 v253, 3, v0
    v_lshl_add_u32 v253, s32, 3, v253
    v_mul_u32_u24 v252, 912, v253
    v_and_b32 v254, 7, v0
    v_lshl_add_u32 v252, v254, 4, v252
    v_lshlrev_b32 v253, 3, v253
    s_lshl_b32 s42, s32, 3
    v_mov_b32 v12, v80
    v_cndmask_b32 v80, 0, v80, s[52:53]
    v_dot2_f32_bf16 v144, v16, s39, v80
    v_dot2_f32_bf16 v145, v16, s40, v96
    v_dot2_f32_bf16 v146, v17, s39, v81
    v_dot2_f32_bf16 v147, v17, s40, v97
    v_dot2_f32_bf16 v148, v18, s39, v82
    v_dot2_f32_bf16 v149, v18, s40, v98
    v_dot2_f32_bf16 v150, v19, s39, v83
    v_dot2_f32_bf16 v151, v19, s40, v99
    v_dot2_f32_bf16 v80, v20, s39, v84
    v_cvt_pk_bf16_f32 v16, v144, v145
    v_cvt_pk_bf16_f32 v17, v146, v147
    v_cvt_pk_bf16_f32 v18, v148, v149
    v_cvt_pk_bf16_f32 v19, v150, v151
    ds_write_b128 v13, v[16:19] offset:0
    s_add_u32 s38, s38, 4096
    buffer_load_dwordx4 a[208:211], v1, s[24:27], s38 offen offset:0 sc1
    buffer_load_dwordx4 a[212:215], v1, s[24:27], s38 offen offset:1024 sc1
    v_dot2c_f32_bf16 v99, s40, v20
    v_dot2c_f32_bf16 v83, s39, v21
    v_dot2c_f32_bf16 v98, s40, v21
    v_dot2c_f32_bf16 v82, s39, v22
    v_dot2c_f32_bf16 v97, s40, v22
    v_dot2c_f32_bf16 v81, s39, v23
    v_dot2c_f32_bf16 v96, s40, v23
    v_cvt_pk_bf16_f32 v20, v80, v99
    v_cvt_pk_bf16_f32 v21, v83, v98
    v_cvt_pk_bf16_f32 v22, v82, v97
    v_cvt_pk_bf16_f32 v23, v81, v96
    ds_write_b128 v14, v[20:23] offset:48
    v_dot2_f32_bf16 v144, v24, s39, v84
    v_dot2_f32_bf16 v145, v24, s40, v100
    v_dot2_f32_bf16 v146, v25, s39, v85
    v_dot2_f32_bf16 v147, v25, s40, v101
    v_dot2_f32_bf16 v148, v26, s39, v86
    v_dot2_f32_bf16 v149, v26, s40, v102
    v_dot2_f32_bf16 v150, v27, s39, v87
    v_dot2_f32_bf16 v151, v27, s40, v103
    v_dot2_f32_bf16 v84, v28, s39, v88
    v_cvt_pk_bf16_f32 v24, v144, v145
    v_cvt_pk_bf16_f32 v25, v146, v147
    v_cvt_pk_bf16_f32 v26, v148, v149
    v_cvt_pk_bf16_f32 v27, v150, v151
    ds_write_b128 v13, v[24:27] offset:16
    buffer_load_dwordx4 a[216:219], v1, s[24:27], s38 offen offset:2048 sc1
    buffer_load_dwordx4 a[220:223], v1, s[24:27], s38 offen offset:3072 sc1
    v_dot2c_f32_bf16 v103, s40, v28
    v_dot2c_f32_bf16 v87, s39, v29
    v_dot2c_f32_bf16 v102, s40, v29
    v_dot2c_f32_bf16 v86, s39, v30
    v_dot2c_f32_bf16 v101, s40, v30
    v_dot2c_f32_bf16 v85, s39, v31
    v_dot2c_f32_bf16 v100, s40, v31
    v_cvt_pk_bf16_f32 v28, v84, v103
    v_cvt_pk_bf16_f32 v29, v87, v102
    v_cvt_pk_bf16_f32 v30, v86, v101
    v_cvt_pk_bf16_f32 v31, v85, v100
    ds_write_b128 v14, v[28:31] offset:32
    s_waitcnt vmcnt(8)
    v_cmp_ne_u32 vcc, s28, v3
    s_nop 0
    s_and_b64 vcc, vcc, 127
    s_cbranch_scc1 slow_f1_x_11
ok_f1_x_12:
    v_dot2_f32_bf16 v144, v32, s39, v88
    v_dot2_f32_bf16 v145, v32, s40, v104
    v_dot2_f32_bf16 v146, v33, s39, v89
    v_dot2_f32_bf16 v147, v33, s40, v105
    v_dot2_f32_bf16 v148, v34, s39, v90
    v_dot2_f32_bf16 v149, v34, s40, v106
    v_dot2_f32_bf16 v150, v35, s39, v91
    v_dot2_f32_bf16 v151, v35, s40, v107
    v_dot2_f32_bf16 v88, v36, s39, v92
    v_cvt_pk_bf16_f32 v32, v144, v145
    v_cvt_pk_bf16_f32 v33, v146, v147
    s_add_u32 s38, s38, 4096
    buffer_load_dwordx4 a[224:227], v1, s[24:27], s38 offen offset:0 sc1
    buffer_load_dwordx4 a[228:231], v1, s[24:27], s38 offen offset:1024 sc1
    v_cvt_pk_bf16_f32 v34, v148, v149
    v_cvt_pk_bf16_f32 v35, v150, v151
    ds_write_b128 v13, v[32:35] offset:32
    v_dot2c_f32_bf16 v107, s40, v36
    v_dot2c_f32_bf16 v91, s39, v37
    v_dot2c_f32_bf16 v106, s40, v37
    v_dot2c_f32_bf16 v90, s39, v38
    v_dot2c_f32_bf16 v105, s40, v38
    v_dot2c_f32_bf16 v89, s39, v39
    v_dot2c_f32_bf16 v104, s40, v39
    v_cvt_pk_bf16_f32 v36, v88, v107
    v_cvt_pk_bf16_f32 v37, v91, v106
    v_cvt_pk_bf16_f32 v38, v90, v105
    v_cvt_pk_bf16_f32 v39, v89, v104
    ds_write_b128 v14, v[36:39] offset:16
    buffer_load_dwordx4 a[232:235], v1, s[24:27], s38 offen offset:2048 sc1
    buffer_load_dwordx4 a[236:239], v1, s[24:27], s38 offen offset:3072 sc1
    v_mov_b32 v254, v112
    v_cndmask_b32 v112, 0, v112, s[52:53]
    s_waitcnt lgkmcnt(12)
    v_dot2_f32_bf16 v144, v48, s39, v112
    v_dot2_f32_bf16 v145, v48, s40, v128
    v_dot2_f32_bf16 v146, v49, s39, v113
    v_dot2_f32_bf16 v147, v49, s40, v129
    v_dot2_f32_bf16 v148, v50, s39, v114
    v_dot2_f32_bf16 v149, v50, s40, v130
    v_dot2_f32_bf16 v150, v51, s39, v115
    v_dot2_f32_bf16 v151, v51, s40, v131
    v_dot2_f32_bf16 v112, v52, s39, v116
    v_cvt_pk_bf16_f32 v48, v144, v145
    v_cvt_pk_bf16_f32 v49, v146, v147
    v_cvt_pk_bf16_f32 v50, v148, v149
    v_cvt_pk_bf16_f32 v51, v150, v151
    ds_write_b128 v13, v[48:51] offset:29184
    v_dot2c_f32_bf16 v131, s40, v52
    v_dot2c_f32_bf16 v115, s39, v53
    v_dot2c_f32_bf16 v130, s40, v53
    v_dot2c_f32_bf16 v114, s39, v54
    v_dot2c_f32_bf16 v129, s40, v54
    v_dot2c_f32_bf16 v113, s39, v55
    v_dot2c_f32_bf16 v128, s40, v55
    v_permlane32_swap_b32 v12, v254
    v_cvt_pk_bf16_f32 v52, v112, v131
    v_cvt_pk_bf16_f32 v53, v115, v130
    v_cvt_pk_bf16_f32 v54, v114, v129
    v_cvt_pk_bf16_f32 v55, v113, v128
    ds_write_b128 v15, v[52:55] offset:48
    s_add_u32 s38, s38, 4096
    buffer_load_dwordx4 a[240:243], v1, s[24:27], s38 offen offset:0 sc1
    buffer_load_dwordx4 a[244:247], v1, s[24:27], s38 offen offset:1024 sc1
    s_waitcnt lgkmcnt(12)
    v_dot2_f32_bf16 v144, v56, s39, v116
    v_dot2_f32_bf16 v145, v56, s40, v132
    v_dot2_f32_bf16 v146, v57, s39, v117
    v_dot2_f32_bf16 v147, v57, s40, v133
    v_dot2_f32_bf16 v148, v58, s39, v118
    v_dot2_f32_bf16 v149, v58, s40, v134
    v_dot2_f32_bf16 v150, v59, s39, v119
    v_dot2_f32_bf16 v151, v59, s40, v135
    v_dot2_f32_bf16 v116, v60, s39, v120
    v_cvt_pk_bf16_f32 v56, v144, v145
    v_cvt_pk_bf16_f32 v57, v146, v147
    v_cvt_pk_bf16_f32 v58, v148, v149
    v_cvt_pk_bf16_f32 v59, v150, v151
    ds_write_b128 v13, v[56:59] offset:29200
    buffer_load_dwordx4 a[248:251], v1, s[24:27], s38 offen offset:2048 sc1
    buffer_load_dwordx4 a[252:255], v1, s[24:27], s38 offen offset:3072 sc1
    v_dot2c_f32_bf16 v135, s40, v60
    v_dot2c_f32_bf16 v119, s39, v61
    v_dot2c_f32_bf16 v134, s40, v61
    v_dot2c_f32_bf16 v118, s39, v62
    v_dot2c_f32_bf16 v133, s40, v62
    v_dot2c_f32_bf16 v117, s39, v63
    v_dot2c_f32_bf16 v132, s40, v63
    v_cvt_pk_bf16_f32 v60, v116, v135
    v_cvt_pk_bf16_f32 v61, v119, v134
    v_cvt_pk_bf16_f32 v62, v118, v133
    v_cvt_pk_bf16_f32 v63, v117, v132
    ds_write_b128 v15, v[60:63] offset:32
    s_waitcnt lgkmcnt(12)
    v_dot2_f32_bf16 v144, v64, s39, v120
    v_dot2_f32_bf16 v145, v64, s40, v136
    v_dot2_f32_bf16 v146, v65, s39, v121
    v_dot2_f32_bf16 v147, v65, s40, v137
    v_dot2_f32_bf16 v148, v66, s39, v122
    v_dot2_f32_bf16 v149, v66, s40, v138
    v_dot2_f32_bf16 v150, v67, s39, v123
    v_dot2_f32_bf16 v151, v67, s40, v139
    v_dot2_f32_bf16 v120, v68, s39, v124
    v_cvt_pk_bf16_f32 v64, v144, v145
    v_cvt_pk_bf16_f32 v65, v146, v147
    v_cvt_pk_bf16_f32 v66, v148, v149
    v_cvt_pk_bf16_f32 v67, v150, v151
    ds_write_b128 v13, v[64:67] offset:29216
    s_add_u32 s38, s38, 4096
    buffer_load_dwordx4 v[152:155], v1, s[24:27], s38 offen offset:0 sc1
    buffer_load_dwordx4 v[156:159], v1, s[24:27], s38 offen offset:1024 sc1
    v_dot2c_f32_bf16 v139, s40, v68
    v_dot2c_f32_bf16 v123, s39, v69
    v_dot2c_f32_bf16 v138, s40, v69
    v_dot2c_f32_bf16 v122, s39, v70
    v_dot2c_f32_bf16 v137, s40, v70
    v_dot2c_f32_bf16 v121, s39, v71
    v_dot2c_f32_bf16 v136, s40, v71
    v_cvt_pk_bf16_f32 v68, v120, v139
    v_cvt_pk_bf16_f32 v69, v123, v138
    v_cvt_pk_bf16_f32 v70, v122, v137
    v_cvt_pk_bf16_f32 v71, v121, v136
    ds_write_b128 v15, v[68:71] offset:16
    s_waitcnt lgkmcnt(12)
    v_permlane32_swap_b32 v92, v124
    v_permlane32_swap_b32 v108, v140
    v_permlane32_swap_b32 v93, v125
    v_permlane32_swap_b32 v109, v141
    v_permlane32_swap_b32 v94, v126
    v_permlane32_swap_b32 v110, v142
    v_permlane32_swap_b32 v95, v127
    v_permlane32_swap_b32 v111, v143
    v_dot2_f32_bf16 v144, v72, s39, v92
    v_dot2_f32_bf16 v145, v72, s40, v108
    v_dot2_f32_bf16 v146, v73, s39, v93
    v_dot2_f32_bf16 v147, v73, s40, v109
    v_dot2_f32_bf16 v148, v74, s39, v94
    v_dot2_f32_bf16 v149, v74, s40, v110
    v_dot2_f32_bf16 v150, v75, s39, v95
    v_dot2_f32_bf16 v151, v75, s40, v111
    v_dot2_f32_bf16 v92, v76, s39, v254
    v_cvt_pk_bf16_f32 v72, v144, v145
    v_cvt_pk_bf16_f32 v73, v146, v147
    v_cvt_pk_bf16_f32 v74, v148, v149
    v_cvt_pk_bf16_f32 v75, v150, v151
    ds_write_b128 v40, v[72:75] offset:48
    buffer_load_dwordx4 v[160:163], v1, s[24:27], s38 offen offset:2048 sc1
    buffer_load_dwordx4 v[164:167], v1, s[24:27], s38 offen offset:3072 sc1
    v_dot2c_f32_bf16 v111, s40, v76
    v_dot2c_f32_bf16 v95, s39, v77
    v_dot2c_f32_bf16 v110, s40, v77
    v_dot2c_f32_bf16 v94, s39, v78
    v_dot2c_f32_bf16 v109, s40, v78
    v_dot2c_f32_bf16 v93, s39, v79
    v_dot2c_f32_bf16 v108, s40, v79
    v_cvt_pk_bf16_f32 v76, v92, v111
    v_cvt_pk_bf16_f32 v77, v95, v110
    v_cvt_pk_bf16_f32 v78, v94, v109
    v_cvt_pk_bf16_f32 v79, v93, v108
    ds_write_b128 v41, v[76:79] offset:0
    s_add_u32 s38, s38, 4096
    buffer_load_dwordx4 v[168:171], v1, s[24:27], s38 offen offset:0 sc1
    buffer_load_dwordx4 v[172:175], v1, s[24:27], s38 offen offset:1024 sc1
    v_mov_b32 v12, v255
    v_mov_b32 v13, v252
    v_mov_b32 v15, v253
    s_waitcnt lgkmcnt(0)
    s_barrier
    buffer_load_dwordx4 v[176:179], v1, s[24:27], s38 offen offset:2048 sc1
    buffer_load_dwordx4 v[180:183], v1, s[24:27], s38 offen offset:3072 sc1
    ds_read_b128 v[96:99], v12 offset:0
    ds_read_b128 v[100:103], v12 offset:32
    s_waitcnt lgkmcnt(1)
    v_mfma_f32_32x32x16_bf16 v[16:31], a[0:3], v[96:99], 0
    ds_read_b128 v[104:107], v12 offset:64
    ds_read_b128 v[112:115], v13 offset:0
    s_mul_i32 s43, s33, 128
    v_and_b32 v110, 7, v0
    v_add_u32 v110, s42, v110
    v_mfma_f32_32x32x16_bf16 v[32:47], a[4:7], v[96:99], 0
    v_mul_u32_u24 v80, 912, v110
    v_lshrrev_b32 v110, 3, v0
    v_lshl_add_u32 v80, v110, 4, v80
    v_add_u32 v80, s43, v80
    v_and_b32 v14, 31, v0
    s_waitcnt lgkmcnt(2)
    v_mfma_f32_32x32x16_bf16 v[16:31], a[8:11], v[100:103], v[16:31]
    ds_read_b128 v[96:99], v12 offset:96
    v_lshlrev_b32 v14, 3, v14
    s_mov_b32 s52, -1
    s_mov_b32 s53, 0
    s_mov_b32 s54, 0x80008000
    v_mfma_f32_32x32x16_bf16 v[32:47], a[12:15], v[100:103], v[32:47]
    s_lshl_b32 s49, s32, 7
    v_lshlrev_b32 v2, 9, v0
    s_add_u32 s49, s49, 15065088
    s_mov_b64 exec, 127
    buffer_load_dword v3, v2, s[24:27], s49 offen sc1
    s_mov_b64 exec, -1
    s_add_u32 s38, s38, 4096
    buffer_load_dwordx4 v[184:187], v1, s[24:27], s38 offen offset:0 sc1
    ds_read_b128 v[116:119], v13 offset:128
    s_waitcnt lgkmcnt(2)
    v_lshlrev_b32 v122, 16, v112
    v_and_b32 v124, s69, v112
    v_add_f32 v120, v122, v124
    v_mfma_f32_32x32x16_bf16 v[16:31], a[16:19], v[104:107], v[16:31]
    ds_read_b128 v[100:103], v12 offset:128
    buffer_load_dwordx4 v[188:191], v1, s[24:27], s38 offen offset:1024 sc1
    v_mul_f32 v121, v122, v122
    v_fmac_f32 v121, v124, v124
    v_lshlrev_b32 v123, 16, v113
    v_and_b32 v125, s69, v113
    v_mfma_f32_32x32x16_bf16 v[32:47], a[20:23], v[104:107], v[32:47]
    v_add_f32 v120, v120, v123
    v_fmac_f32 v121, v123, v123
    v_add_f32 v120, v120, v125
    v_fmac_f32 v121, v125, v125
    v_lshlrev_b32 v122, 16, v114
    s_waitcnt lgkmcnt(2)
    v_mfma_f32_32x32x16_bf16 v[16:31], a[24:27], v[96:99], v[16:31]
    ds_read_b128 v[104:107], v12 offset:160
    buffer_load_dwordx4 v[192:195], v1, s[24:27], s38 offen offset:2048 sc1
    v_and_b32 v124, s69, v114
    v_add_f32 v120, v120, v122
    v_fmac_f32 v121, v122, v122
    v_mfma_f32_32x32x16_bf16 v[32:47], a[28:31], v[96:99], v[32:47]
    ds_read_b128 v[144:147], v80 offset:0
    v_add_f32 v120, v120, v124
    v_fmac_f32 v121, v124, v124
    v_lshlrev_b32 v123, 16, v115
    v_and_b32 v125, s69, v115
    s_waitcnt lgkmcnt(2)
    v_mfma_f32_32x32x16_bf16 v[16:31], a[32:35], v[100:103], v[16:31]
    ds_read_b128 v[96:99], v12 offset:192
    ds_read_b128 v[112:115], v13 offset:256
    buffer_load_dwordx4 v[196:199], v1, s[24:27], s38 offen offset:3072 sc1
    v_add_f32 v120, v120, v123
    v_fmac_f32 v121, v123, v123
    v_add_f32 v120, v120, v125
    v_fmac_f32 v121, v125, v125
    v_mfma_f32_32x32x16_bf16 v[32:47], a[36:39], v[100:103], v[32:47]
    v_lshlrev_b32 v122, 16, v116
    v_and_b32 v124, s69, v116
    v_add_f32 v120, v120, v122
    v_fmac_f32 v121, v122, v122
    v_add_f32 v120, v120, v124
    s_waitcnt lgkmcnt(3)
    v_mfma_f32_32x32x16_bf16 v[16:31], a[40:43], v[104:107], v[16:31]
    ds_read_b128 v[100:103], v12 offset:224
    v_fmac_f32 v121, v124, v124
    v_lshlrev_b32 v123, 16, v117
    v_and_b32 v125, s69, v117
    v_add_f32 v120, v120, v123
    v_mfma_f32_32x32x16_bf16 v[32:47], a[44:47], v[104:107], v[32:47]
    s_add_u32 s38, s38, 4096
    buffer_load_dwordx4 v[200:203], v1, s[24:27], s38 offen offset:0 sc1
    v_fmac_f32 v121, v123, v123
    v_add_f32 v120, v120, v125
    v_fmac_f32 v121, v125, v125
    v_lshlrev_b32 v122, 16, v118
    s_waitcnt lgkmcnt(2)
    v_mfma_f32_32x32x16_bf16 v[16:31], a[48:51], v[96:99], v[16:31]
    ds_read_b128 v[104:107], v12 offset:256
    ds_read_b128 v[148:151], v80 offset:29184
    buffer_load_dwordx4 v[204:207], v1, s[24:27], s38 offen offset:1024 sc1
    v_and_b32 v124, s69, v118
    v_add_f32 v120, v120, v122
    v_fmac_f32 v121, v122, v122
    v_add_f32 v120, v120, v124
    v_mfma_f32_32x32x16_bf16 v[32:47], a[52:55], v[96:99], v[32:47]
    v_fmac_f32 v121, v124, v124
    v_lshlrev_b32 v123, 16, v119
    v_and_b32 v125, s69, v119
    v_add_f32 v120, v120, v123
    v_fmac_f32 v121, v123, v123
    s_waitcnt lgkmcnt(2)
    v_mfma_f32_32x32x16_bf16 v[16:31], a[56:59], v[100:103], v[16:31]
    ds_read_b128 v[96:99], v12 offset:288
    ds_read_b128 v[116:119], v13 offset:384
    buffer_load_dwordx4 v[208:211], v1, s[24:27], s38 offen offset:2048 sc1
    v_add_f32 v120, v120, v125
    v_fmac_f32 v121, v125, v125
    v_lshlrev_b32 v122, 16, v112
    v_and_b32 v124, s69, v112
    v_mfma_f32_32x32x16_bf16 v[32:47], a[60:63], v[100:103], v[32:47]
    v_add_f32 v120, v120, v122
    v_fmac_f32 v121, v122, v122
    v_add_f32 v120, v120, v124
    v_fmac_f32 v121, v124, v124
    v_lshlrev_b32 v123, 16, v113
    s_waitcnt lgkmcnt(3)
    v_mfma_f32_32x32x16_bf16 v[16:31], a[64:67], v[104:107], v[16:31]
    ds_read_b128 v[100:103], v12 offset:320
    buffer_load_dwordx4 v[212:215], v1, s[24:27], s38 offen offset:3072 sc1
    v_and_b32 v125, s69, v113
    v_add_f32 v120, v120, v123
    v_fmac_f32 v121, v123, v123
    v_add_f32 v120, v120, v125
    v_mfma_f32_32x32x16_bf16 v[32:47], a[68:71], v[104:107], v[32:47]
    v_fmac_f32 v121, v125, v125
    v_lshlrev_b32 v122, 16, v114
    v_and_b32 v124, s69, v114
    v_add_f32 v120, v120, v122
    v_fmac_f32 v121, v122, v122
    s_waitcnt lgkmcnt(2)
    v_mfma_f32_32x32x16_bf16 v[16:31], a[72:75], v[96:99], v[16:31]
    ds_read_b128 v[104:107], v12 offset:352
    v_add_f32 v120, v120, v124
    v_fmac_f32 v121, v124, v124
    v_lshlrev_b32 v123, 16, v115
    v_and_b32 v125, s69, v115
    v_mfma_f32_32x32x16_bf16 v[32:47], a[76:79], v[96:99], v[32:47]
    ds_read_b128 v[112:115], v13 offset:512
    v_add_f32 v120, v120, v123
    v_fmac_f32 v121, v123, v123
    v_add_f32 v120, v120, v125
    v_fmac_f32 v121, v125, v125
    s_waitcnt lgkmcnt(3)
    s_waitcnt lgkmcnt(2)
    v_mfma_f32_32x32x16_bf16 v[16:31], a[80:83], v[100:103], v[16:31]
    ds_read_b128 v[96:99], v12 offset:384
L_pad3:
    s_cbranch_execz L_ret0
    v_lshlrev_b32 v122, 16, v116
    v_and_b32 v124, s69, v116
    v_add_f32 v120, v120, v122
    v_fmac_f32 v121, v122, v122
    v_mfma_f32_32x32x16_bf16 v[32:47], a[84:87], v[100:103], v[32:47]
    v_add_f32 v120, v120, v124
    v_fmac_f32 v121, v124, v124
    v_lshlrev_b32 v123, 16, v117
    v_and_b32 v125, s69, v117
    s_waitcnt vmcnt(8)
    v_cmp_ne_u32 vcc, s28, v3
    s_nop 0
    s_and_b64 vcc, vcc, 127
    s_cbranch_scc1 slow_f2_x_13
ok_f2_x_14:
    s_waitcnt lgkmcnt(2)
    v_mfma_f32_32x32x16_bf16 v[16:31], a[88:91], v[104:107], v[16:31]
    ds_read_b128 v[100:103], v12 offset:416
    s_add_u32 s38, s38, 4096
    buffer_load_dwordx4 v[216:219], v1, s[24:27], s38 offen offset:0 sc1
    buffer_load_dwordx4 v[220:223], v1, s[24:27], s38 offen offset:1024 sc1
    v_add_f32 v120, v120, v123
    v_fmac_f32 v121, v123, v123
    v_add_f32 v120, v120, v125
    v_fmac_f32 v121, v125, v125
    v_mfma_f32_32x32x16_bf16 v[32:47], a[92:95], v[104:107], v[32:47]
    s_lshl_b32 s49, s33, 2
    s_add_u32 s49, s49, s32
    s_lshl_b32 s49, s49, 9
    s_add_u32 s49, s49, 15040512
    v_and_b32 v6, 0x1f0, v1
    buffer_load_dwordx4 v[2:5], v6, s[24:27], s49 offen sc1
    buffer_load_dwordx4 v[224:227], v1, s[24:27], s38 offen offset:2048 sc1
    buffer_load_dwordx4 v[228:231], v1, s[24:27], s38 offen offset:3072 sc1
    v_lshlrev_b32 v122, 16, v118
    v_and_b32 v124, s69, v118
    v_add_f32 v120, v120, v122
    v_fmac_f32 v121, v122, v122
    s_waitcnt lgkmcnt(1)
    v_mfma_f32_32x32x16_bf16 v[16:31], a[96:99], v[96:99], v[16:31]
    ds_read_b128 v[104:107], v12 offset:448
    s_add_u32 s38, s38, 4096
    buffer_load_dwordx4 v[232:235], v1, s[24:27], s38 offen offset:0 sc1
    v_add_f32 v120, v120, v124
    v_fmac_f32 v121, v124, v124
    v_lshlrev_b32 v123, 16, v119
    v_and_b32 v125, s69, v119
    v_mfma_f32_32x32x16_bf16 v[32:47], a[100:103], v[96:99], v[32:47]
    ds_read_b128 v[116:119], v13 offset:640
    v_add_f32 v120, v120, v123
    v_fmac_f32 v121, v123, v123
    v_add_f32 v120, v120, v125
    v_fmac_f32 v121, v125, v125
    s_waitcnt lgkmcnt(2)
    v_mfma_f32_32x32x16_bf16 v[16:31], a[104:107], v[100:103], v[16:31]
    ds_read_b128 v[96:99], v12 offset:480
    buffer_load_dwordx4 v[236:239], v1, s[24:27], s38 offen offset:1024 sc1
    v_lshlrev_b32 v122, 16, v112
    v_and_b32 v124, s69, v112
    v_add_f32 v120, v120, v122
    v_fmac_f32 v121, v122, v122
    v_mfma_f32_32x32x16_bf16 v[32:47], a[108:111], v[100:103], v[32:47]
    v_add_f32 v120, v120, v124
    v_fmac_f32 v121, v124, v124
    v_lshlrev_b32 v123, 16, v113
    v_and_b32 v125, s69, v113
    v_add_f32 v120, v120, v123
    s_waitcnt lgkmcnt(2)
    v_mfma_f32_32x32x16_bf16 v[16:31], a[112:115], v[104:107], v[16:31]
    ds_read_b128 v[100:103], v12 offset:512
    buffer_load_dwordx4 v[240:243], v1, s[24:27], s38 offen offset:2048 sc1
    v_fmac_f32 v121, v123, v123
    v_add_f32 v120, v120, v125
    v_fmac_f32 v121, v125, v125
    v_lshlrev_b32 v122, 16, v114
    v_mfma_f32_32x32x16_bf16 v[32:47], a[116:119], v[104:107], v[32:47]
    v_and_b32 v124, s69, v114
    v_add_f32 v120, v120, v122
    v_fmac_f32 v121, v122, v122
    v_add_f32 v120, v120, v124
    v_fmac_f32 v121, v124, v124
    s_waitcnt lgkmcnt(1)
    v_mfma_f32_32x32x16_bf16 v[16:31], a[120:123], v[96:99], v[16:31]
    ds_read_b128 v[104:107], v12 offset:544
    v_lshlrev_b32 v123, 16, v115
    v_and_b32 v125, s69, v115
    v_add_f32 v120, v120, v123
    v_fmac_f32 v121, v123, v123
    v_mfma_f32_32x32x16_bf16 v[32:47], a[124:127], v[96:99], v[32:47]
    ds_read_b128 v[112:115], v13 offset:768
    buffer_load_dwordx4 v[244:247], v1, s[24:27], s38 offen offset:3072 sc1
    v_add_f32 v120, v120, v125
    v_fmac_f32 v121, v125, v125
    v_lshlrev_b32 v122, 16, v116
    v_and_b32 v124, s69, v116
    s_waitcnt lgkmcnt(2)
    v_mfma_f32_32x32x16_bf16 v[16:31], a[128:131], v[100:103], v[16:31]
    ds_read_b128 v[96:99], v12 offset:576
    v_add_f32 v120, v120, v122
    v_fmac_f32 v121, v122, v122
    v_add_f32 v120, v120, v124
    v_fmac_f32 v121, v124, v124
    v_mfma_f32_32x32x16_bf16 v[32:47], a[132:135], v[100:103], v[32:47]
    s_add_u32 s38, s38, 4096
    buffer_load_dwordx4 v[248:251], v1, s[24:27], s38 offen offset:0 sc1
    v_lshlrev_b32 v123, 16, v117
    v_and_b32 v125, s69, v117
    v_add_f32 v120, v120, v123
    v_fmac_f32 v121, v123, v123
    s_waitcnt lgkmcnt(2)
    v_mfma_f32_32x32x16_bf16 v[16:31], a[136:139], v[104:107], v[16:31]
    ds_read_b128 v[100:103], v12 offset:608
    v_add_f32 v120, v120, v125
    v_fmac_f32 v121, v125, v125
    v_lshlrev_b32 v122, 16, v118
    v_and_b32 v124, s69, v118
    v_mfma_f32_32x32x16_bf16 v[32:47], a[140:143], v[104:107], v[32:47]
    buffer_load_dwordx4 v[252:255], v1, s[24:27], s38 offen offset:1024 sc1
    v_add_f32 v120, v120, v122
    v_fmac_f32 v121, v122, v122
    v_add_f32 v120, v120, v124
    v_fmac_f32 v121, v124, v124
    s_waitcnt lgkmcnt(1)
    v_mfma_f32_32x32x16_bf16 v[16:31], a[144:147], v[96:99], v[16:31]
    ds_read_b128 v[104:107], v12 offset:640
    v_lshlrev_b32 v123, 16, v119
    v_and_b32 v125, s69, v119
    v_add_f32 v120, v120, v123
    v_fmac_f32 v121, v123, v123
    v_mfma_f32_32x32x16_bf16 v[32:47], a[148:151], v[96:99], v[32:47]
    s_add_u32 m0, s37, -2048
    s_nop 0
    buffer_load_dwordx4 v1, s[24:27], s38 offen offset:2048 sc1 lds
    v_add_f32 v120, v120, v125
    v_fmac_f32 v121, v125, v125
    v_lshlrev_b32 v122, 16, v112
    v_and_b32 v124, s69, v112
    v_add_f32 v120, v120, v122
    s_waitcnt lgkmcnt(1)
    v_mfma_f32_32x32x16_bf16 v[16:31], a[152:155], v[100:103], v[16:31]
    ds_read_b128 v[96:99], v12 offset:672
    buffer_load_dwordx4 v1, s[24:27], s38 offen offset:3072 sc1 lds
    v_fmac_f32 v121, v122, v122
    v_add_f32 v120, v120, v124
    v_fmac_f32 v121, v124, v124
    v_lshlrev_b32 v123, 16, v113
    v_mfma_f32_32x32x16_bf16 v[32:47], a[156:159], v[100:103], v[32:47]
    v_and_b32 v125, s69, v113
    v_add_f32 v120, v120, v123
    v_fmac_f32 v121, v123, v123
    v_add_f32 v120, v120, v125
    v_fmac_f32 v121, v125, v125
    s_waitcnt lgkmcnt(1)
    v_mfma_f32_32x32x16_bf16 v[16:31], a[160:163], v[104:107], v[16:31]
    ds_read_b128 v[100:103], v12 offset:704
    v_lshlrev_b32 v122, 16, v114
    v_and_b32 v124, s69, v114
    v_add_f32 v120, v120, v122
    v_fmac_f32 v121, v122, v122
    v_mfma_f32_32x32x16_bf16 v[32:47], a[164:167], v[104:107], v[32:47]
    s_add_u32 m0, s37, 2048
    s_add_u32 s38, s38, 4096
    buffer_load_dwordx4 v1, s[24:27], s38 offen offset:0 sc1 lds
    v_add_f32 v120, v120, v124
    v_fmac_f32 v121, v124, v124
    v_lshlrev_b32 v123, 16, v115
    v_and_b32 v125, s69, v115
    v_add_f32 v120, v120, v123
    s_waitcnt lgkmcnt(1)
    v_mfma_f32_32x32x16_bf16 v[16:31], a[168:171], v[96:99], v[16:31]
    ds_read_b128 v[104:107], v12 offset:736
    buffer_load_dwordx4 v1, s[24:27], s38 offen offset:1024 sc1 lds
    v_fmac_f32 v121, v123, v123
    v_add_f32 v120, v120, v125
    v_fmac_f32 v121, v125, v125
    s_nop 0
    v_mfma_f32_32x32x16_bf16 v[32:47], a[172:175], v[96:99], v[32:47]
    v_add_f32_dpp v120, v120, v120 quad_perm:[1,0,3,2] row_mask:0xf bank_mask:0xf
    v_add_f32_dpp v121, v121, v121 quad_perm:[1,0,3,2] row_mask:0xf bank_mask:0xf
    s_nop 0
    v_add_f32_dpp v120, v120, v120 quad_perm:[2,3,0,1] row_mask:0xf bank_mask:0xf
    v_add_f32_dpp v121, v121, v121 quad_perm:[2,3,0,1] row_mask:0xf bank_mask:0xf
    s_waitcnt lgkmcnt(1)
    v_mfma_f32_32x32x16_bf16 v[16:31], a[176:179], v[100:103], v[16:31]
    ds_read_b128 v[96:99], v12 offset:768
    buffer_load_dwordx4 v1, s[24:27], s38 offen offset:2048 sc1 lds
    s_nop 0
    v_add_f32_dpp v120, v120, v120 row_half_mirror row_mask:0xf bank_mask:0xf
    v_add_f32_dpp v121, v121, v121 row_half_mirror row_mask:0xf bank_mask:0xf
    v_mul_f32 v120, 0xbb124925, v120
    v_mfma_f32_32x32x16_bf16 v[32:47], a[180:183], v[100:103], v[32:47]
    v_mul_f32 v122, v120, v120
    v_fmamk_f32 v121, v121, 0xbb124925, v122
    v_min_f32 v121, 0, v121
    v_sub_f32 v121, 0x3727c5ac, v121
    s_waitcnt lgkmcnt(1)
    v_mfma_f32_32x32x16_bf16 v[16:31], a[184:187], v[104:107], v[16:31]
    ds_read_b128 v[100:103], v12 offset:800
    buffer_load_dwordx4 v1, s[24:27], s38 offen offset:3072 sc1 lds
    v_rsq_f32 v121, v121
    v_mfma_f32_32x32x16_bf16 v[32:47], a[188:191], v[104:107], v[32:47]
    ds_write_b64 v15, v[120:121] offset:64512
    s_waitcnt lgkmcnt(2)
    v_mfma_f32_32x32x16_bf16 v[16:31], a[192:195], v[96:99], v[16:31]
    ds_read_b128 v[104:107], v12 offset:832
    v_mfma_f32_32x32x16_bf16 v[32:47], a[196:199], v[96:99], v[32:47]
    s_add_u32 m0, s37, 6144
    s_add_u32 s38, s38, 4096
    buffer_load_dwordx4 v1, s[24:27], s38 offen offset:0 sc1 lds
    s_waitcnt lgkmcnt(1)
    s_barrier
    ds_read_b32 v110, v14 offset:64512
    s_waitcnt vmcnt(15)
    v_mfma_f32_32x32x16_bf16 v[16:31], a[200:203], v[100:103], v[16:31]
    ds_read_b128 v[96:99], v12 offset:864
    buffer_load_dwordx4 v1, s[24:27], s38 offen offset:1024 sc1 lds
    s_waitcnt lgkmcnt(2)
    v_mfma_f32_32x32x16_bf16 v[16:31], a[208:211], v[104:107], v[16:31]
    s_waitcnt lgkmcnt(0)
    v_mfma_f32_32x32x16_bf16 v[16:31], a[216:219], v[96:99], v[16:31]
    buffer_load_dwordx4 v1, s[24:27], s38 offen offset:2048 sc1 lds
    v_cndmask_b32 v110, 0, v110, s[52:53]
    v_cvt_pk_bf16_f32 v108, v110, v110
    v_and_b32 v111, s69, v108
    v_sub_f32 v110, v110, v111
    v_cvt_pk_bf16_f32 v109, v110, 0
    s_nop 1
    v_mfma_f32_32x32x8_bf16 v[16:31], v[2:3], v[108:109], v[16:31]
    ds_read_b128 v[112:115], v13 offset:29184
    s_nop 3
    v_mfma_f32_32x32x16_bf16 v[32:47], a[204:207], v[100:103], v[32:47]
    ds_read_b128 v[100:103], v12 offset:29184
    ds_read_b128 v[116:119], v13 offset:29312
    s_nop 2
    v_mfma_f32_32x32x16_bf16 v[32:47], a[212:215], v[104:107], v[32:47]
    ds_read_b128 v[104:107], v12 offset:29216
    v_cvt_pk_bf16_f32 v80, v16, v17
    v_cvt_pk_bf16_f32 v81, v18, v19
    v_cvt_pk_bf16_f32 v82, v20, v21
    v_cvt_pk_bf16_f32 v83, -v22, -v23
    v_pk_max_i16 v80, v80, 0
    v_mfma_f32_32x32x16_bf16 v[32:47], a[220:223], v[96:99], v[32:47]
    buffer_load_dwordx4 v1, s[24:27], s38 offen offset:3072 sc1 lds
    v_pk_max_i16 v81, v81, 0
    v_pk_max_i16 v82, v82, 0
    v_pk_max_u16 v83, v83, s54
    v_cvt_pk_bf16_f32 v84, v24, v25
    v_mfma_f32_32x32x8_bf16 v[32:47], v[4:5], v[108:109], v[32:47]
    buffer_store_dwordx4 v[80:83], v1, s[24:27], s60 offen offset:0 sc1
    v_cvt_pk_bf16_f32 v85, v26, v27
    v_cvt_pk_bf16_f32 v86, v28, v29
    v_cvt_pk_bf16_f32 v87, -v30, -v31
    v_pk_max_i16 v84, v84, 0
    v_pk_max_i16 v85, v85, 0
    s_waitcnt lgkmcnt(2)
    v_mfma_f32_32x32x16_bf16 v[48:63], a[0:3], v[100:103], 0
    ds_read_b128 v[96:99], v12 offset:29248
    v_pk_max_i16 v86, v86, 0
    v_pk_max_u16 v87, v87, s54
    v_mfma_f32_32x32x16_bf16 v[64:79], a[4:7], v[100:103], 0
    buffer_store_dwordx4 v[84:87], v1, s[24:27], s60 offen offset:1024 sc1
    v_lshlrev_b32 v122, 16, v112
    v_and_b32 v124, s69, v112
    v_add_f32 v120, v122, v124
    v_mul_f32 v121, v122, v122
    s_waitcnt lgkmcnt(1)
    v_mfma_f32_32x32x16_bf16 v[48:63], a[8:11], v[104:107], v[48:63]
    ds_read_b128 v[100:103], v12 offset:29280
    v_cvt_pk_bf16_f32 v88, v32, v33
    v_cvt_pk_bf16_f32 v89, v34, v35
    v_cvt_pk_bf16_f32 v90, v36, v37
    v_cvt_pk_bf16_f32 v91, -v38, -v39
    v_pk_max_i16 v88, v88, 0
    v_mfma_f32_32x32x16_bf16 v[64:79], a[12:15], v[104:107], v[64:79]
    v_pk_max_i16 v89, v89, 0
    v_pk_max_i16 v90, v90, 0
    v_pk_max_u16 v91, v91, s54
    v_cvt_pk_bf16_f32 v92, v40, v41
    v_cvt_pk_bf16_f32 v93, v42, v43
    s_waitcnt lgkmcnt(1)
    v_mfma_f32_32x32x16_bf16 v[48:63], a[16:19], v[96:99], v[48:63]
    ds_read_b128 v[104:107], v12 offset:29312
    buffer_store_dwordx4 v[88:91], v1, s[24:27], s60 offen offset:2048 sc1
    v_cvt_pk_bf16_f32 v94, v44, v45
    v_cvt_pk_bf16_f32 v95, -v46, -v47
    v_pk_max_i16 v92, v92, 0
    v_pk_max_i16 v93, v93, 0
    v_mfma_f32_32x32x16_bf16 v[64:79], a[20:23], v[96:99], v[64:79]
    v_pk_max_i16 v94, v94, 0
    v_pk_max_u16 v95, v95, s54
    v_fmac_f32 v121, v124, v124
    v_lshlrev_b32 v123, 16, v113
    v_and_b32 v125, s69, v113
    s_waitcnt lgkmcnt(1)
    v_mfma_f32_32x32x16_bf16 v[48:63], a[24:27], v[100:103], v[48:63]
    ds_read_b128 v[96:99], v12 offset:29344
    buffer_store_dwordx4 v[92:95], v1, s[24:27], s60 offen offset:3072 sc1
    v_add_f32 v120, v120, v123
    v_fmac_f32 v121, v123, v123
    v_add_f32 v120, v120, v125
    v_fmac_f32 v121, v125, v125
    v_mfma_f32_32x32x16_bf16 v[64:79], a[28:31], v[100:103], v[64:79]
    v_lshlrev_b32 v122, 16, v114
    v_and_b32 v124, s69, v114
    v_add_f32 v120, v120, v122
    v_fmac_f32 v121, v122, v122
    v_add_f32 v120, v120, v124
    s_waitcnt lgkmcnt(1)
    v_mfma_f32_32x32x16_bf16 v[48:63], a[32:35], v[104:107], v[48:63]
    ds_read_b128 v[100:103], v12 offset:29376
    v_fmac_f32 v121, v124, v124
    v_lshlrev_b32 v123, 16, v115
    v_and_b32 v125, s69, v115
    v_add_f32 v120, v120, v123
    v_mfma_f32_32x32x16_bf16 v[64:79], a[36:39], v[104:107], v[64:79]
    ds_read_b128 v[112:115], v13 offset:29440
    s_add_u32 m0, s37, 10240
    s_add_u32 s38, s38, 4096
    buffer_load_dwordx4 v1, s[24:27], s38 offen offset:0 sc1 lds
    v_fmac_f32 v121, v123, v123
    v_add_f32 v120, v120, v125
    v_fmac_f32 v121, v125, v125
    v_lshlrev_b32 v122, 16, v116
    s_waitcnt lgkmcnt(2)
    v_mfma_f32_32x32x16_bf16 v[48:63], a[40:43], v[96:99], v[48:63]
    ds_read_b128 v[104:107], v12 offset:29408
    buffer_load_dwordx4 v1, s[24:27], s38 offen offset:1024 sc1 lds
    v_and_b32 v124, s69, v116
    v_add_f32 v120, v120, v122
    v_fmac_f32 v121, v122, v122
    v_add_f32 v120, v120, v124
    v_mfma_f32_32x32x16_bf16 v[64:79], a[44:47], v[96:99], v[64:79]
    v_fmac_f32 v121, v124, v124
    v_lshlrev_b32 v123, 16, v117
    v_and_b32 v125, s69, v117
    v_add_f32 v120, v120, v123
    v_fmac_f32 v121, v123, v123
    s_waitcnt lgkmcnt(2)
    v_mfma_f32_32x32x16_bf16 v[48:63], a[48:51], v[100:103], v[48:63]
    ds_read_b128 v[96:99], v12 offset:29440
    v_add_f32 v120, v120, v125
    v_fmac_f32 v121, v125, v125
    v_lshlrev_b32 v122, 16, v118
    v_and_b32 v124, s69, v118
    v_mfma_f32_32x32x16_bf16 v[64:79], a[52:55], v[100:103], v[64:79]
    buffer_load_dwordx4 v1, s[24:27], s38 offen offset:2048 sc1 lds
    v_add_f32 v120, v120, v122
    v_fmac_f32 v121, v122, v122
    v_add_f32 v120, v120, v124
    v_fmac_f32 v121, v124, v124
    s_waitcnt lgkmcnt(1)
    v_mfma_f32_32x32x16_bf16 v[48:63], a[56:59], v[104:107], v[48:63]
    ds_read_b128 v[100:103], v12 offset:29472
    v_lshlrev_b32 v123, 16, v119
    v_and_b32 v125, s69, v119
    v_add_f32 v120, v120, v123
    v_fmac_f32 v121, v123, v123
    v_mfma_f32_32x32x16_bf16 v[64:79], a[60:63], v[104:107], v[64:79]
    ds_read_b128 v[116:119], v13 offset:29568
    buffer_load_dwordx4 v1, s[24:27], s38 offen offset:3072 sc1 lds
    v_add_f32 v120, v120, v125
    v_fmac_f32 v121, v125, v125
    v_lshlrev_b32 v122, 16, v112
    v_and_b32 v124, s69, v112
    s_waitcnt lgkmcnt(2)
    v_mfma_f32_32x32x16_bf16 v[48:63], a[64:67], v[96:99], v[48:63]
    ds_read_b128 v[104:107], v12 offset:29504
    v_add_f32 v120, v120, v122
    v_fmac_f32 v121, v122, v122
    v_add_f32 v120, v120, v124
    v_fmac_f32 v121, v124, v124
    v_mfma_f32_32x32x16_bf16 v[64:79], a[68:71], v[96:99], v[64:79]
    s_add_u32 m0, s37, 14336
    s_add_u32 s38, s38, 4096
    buffer_load_dwordx4 v1, s[24:27], s38 offen offset:0 sc1 lds
    v_lshlrev_b32 v123, 16, v113
    v_and_b32 v125, s69, v113
    v_add_f32 v120, v120, v123
    v_fmac_f32 v121, v123, v123
    s_waitcnt lgkmcnt(2)
    v_mfma_f32_32x32x16_bf16 v[48:63], a[72:75], v[100:103], v[48:63]
    ds_read_b128 v[96:99], v12 offset:29536
    buffer_load_dwordx4 v1, s[24:27], s38 offen offset:1024 sc1 lds
    v_add_f32 v120, v120, v125
    v_fmac_f32 v121, v125, v125
    v_lshlrev_b32 v122, 16, v114
    v_and_b32 v124, s69, v114
    v_mfma_f32_32x32x16_bf16 v[64:79], a[76:79], v[100:103], v[64:79]
    v_add_f32 v120, v120, v122
    v_fmac_f32 v121, v122, v122
    v_add_f32 v120, v120, v124
    v_fmac_f32 v121, v124, v124
    v_lshlrev_b32 v123, 16, v115
    s_waitcnt lgkmcnt(1)
    v_mfma_f32_32x32x16_bf16 v[48:63], a[80:83], v[104:107], v[48:63]
    ds_read_b128 v[100:103], v12 offset:29568
    v_and_b32 v125, s69, v115
    v_add_f32 v120, v120, v123
    v_fmac_f32 v121, v123, v123
    v_add_f32 v120, v120, v125
    v_mfma_f32_32x32x16_bf16 v[64:79], a[84:87], v[104:107], v[64:79]
    ds_read_b128 v[112:115], v13 offset:29696
    buffer_load_dwordx4 v1, s[24:27], s38 offen offset:2048 sc1 lds
    v_fmac_f32 v121, v125, v125
    v_lshlrev_b32 v122, 16, v116
    v_and_b32 v124, s69, v116
    v_add_f32 v120, v120, v122
    s_waitcnt lgkmcnt(2)
    v_mfma_f32_32x32x16_bf16 v[48:63], a[88:91], v[96:99], v[48:63]
    ds_read_b128 v[104:107], v12 offset:29600
    v_fmac_f32 v121, v122, v122
    v_add_f32 v120, v120, v124
    v_fmac_f32 v121, v124, v124
    v_lshlrev_b32 v123, 16, v117
    v_mfma_f32_32x32x16_bf16 v[64:79], a[92:95], v[96:99], v[64:79]
    buffer_load_dwordx4 v1, s[24:27], s38 offen offset:3072 sc1 lds
    v_and_b32 v125, s69, v117
    v_add_f32 v120, v120, v123
    v_fmac_f32 v121, v123, v123
    v_add_f32 v120, v120, v125
    s_waitcnt lgkmcnt(2)
    v_mfma_f32_32x32x16_bf16 v[48:63], a[96:99], v[100:103], v[48:63]
    ds_read_b128 v[96:99], v12 offset:29632
    v_fmac_f32 v121, v125, v125
    v_lshlrev_b32 v122, 16, v118
    v_and_b32 v124, s69, v118
    v_add_f32 v120, v120, v122
    v_mfma_f32_32x32x16_bf16 v[64:79], a[100:103], v[100:103], v[64:79]
    s_add_u32 m0, s37, 18432
    s_add_u32 s38, s38, 4096
    buffer_load_dwordx4 v1, s[24:27], s38 offen offset:0 sc1 lds
    v_fmac_f32 v121, v122, v122
    v_add_f32 v120, v120, v124
    v_fmac_f32 v121, v124, v124
    v_lshlrev_b32 v123, 16, v119
    s_waitcnt lgkmcnt(1)
    v_mfma_f32_32x32x16_bf16 v[48:63], a[104:107], v[104:107], v[48:63]
    ds_read_b128 v[100:103], v12 offset:29664
    buffer_load_dwordx4 v1, s[24:27], s38 offen offset:1024 sc1 lds
    v_and_b32 v125, s69, v119
    v_add_f32 v120, v120, v123
    v_fmac_f32 v121, v123, v123
    v_mfma_f32_32x32x16_bf16 v[64:79], a[108:111], v[104:107], v[64:79]
    ds_read_b128 v[116:119], v13 offset:29824
    v_add_f32 v120, v120, v125
    v_fmac_f32 v121, v125, v125
    v_lshlrev_b32 v122, 16, v112
    v_and_b32 v124, s69, v112
    s_waitcnt lgkmcnt(2)
    v_mfma_f32_32x32x16_bf16 v[48:63], a[112:115], v[96:99], v[48:63]
    ds_read_b128 v[104:107], v12 offset:29696
    v_add_f32 v120, v120, v122
    v_fmac_f32 v121, v122, v122
    v_add_f32 v120, v120, v124
    v_fmac_f32 v121, v124, v124
    v_mfma_f32_32x32x16_bf16 v[64:79], a[116:119], v[96:99], v[64:79]
    buffer_load_dwordx4 v1, s[24:27], s38 offen offset:2048 sc1 lds
    v_lshlrev_b32 v123, 16, v113
    v_and_b32 v125, s69, v113
    v_add_f32 v120, v120, v123
    v_fmac_f32 v121, v123, v123
    s_waitcnt lgkmcnt(2)
    v_mfma_f32_32x32x16_bf16 v[48:63], a[120:123], v[100:103], v[48:63]
    ds_read_b128 v[96:99], v12 offset:29728
    v_add_f32 v120, v120, v125
    v_fmac_f32 v121, v125, v125
    v_lshlrev_b32 v122, 16, v114
    v_and_b32 v124, s69, v114
    v_mfma_f32_32x32x16_bf16 v[64:79], a[124:127], v[100:103], v[64:79]
    buffer_load_dwordx4 v1, s[24:27], s38 offen offset:3072 sc1 lds
    v_add_f32 v120, v120, v122
    v_fmac_f32 v121, v122, v122
    v_add_f32 v120, v120, v124
    v_fmac_f32 v121, v124, v124
    s_waitcnt lgkmcnt(1)
    v_mfma_f32_32x32x16_bf16 v[48:63], a[128:131], v[104:107], v[48:63]
    ds_read_b128 v[100:103], v12 offset:29760
    v_lshlrev_b32 v123, 16, v115
    v_and_b32 v125, s69, v115
    v_add_f32 v120, v120, v123
    v_fmac_f32 v121, v123, v123
    v_mfma_f32_32x32x16_bf16 v[64:79], a[132:135], v[104:107], v[64:79]
    ds_read_b128 v[112:115], v13 offset:29952
    v_add_f32 v120, v120, v125
    v_fmac_f32 v121, v125, v125
    v_lshlrev_b32 v122, 16, v116
    v_and_b32 v124, s69, v116
    s_waitcnt lgkmcnt(2)
    v_mfma_f32_32x32x16_bf16 v[48:63], a[136:139], v[96:99], v[48:63]
    ds_read_b128 v[104:107], v12 offset:29792
    v_add_f32 v120, v120, v122
    v_fmac_f32 v121, v122, v122
    v_add_f32 v120, v120, v124
    v_fmac_f32 v121, v124, v124
    v_mfma_f32_32x32x16_bf16 v[64:79], a[140:143], v[96:99], v[64:79]
    v_lshlrev_b32 v123, 16, v117
    v_and_b32 v125, s69, v117
    v_add_f32 v120, v120, v123
    v_fmac_f32 v121, v123, v123
    v_add_f32 v120, v120, v125
    s_waitcnt lgkmcnt(2)
    v_mfma_f32_32x32x16_bf16 v[48:63], a[144:147], v[100:103], v[48:63]
    ds_read_b128 v[96:99], v12 offset:29824
    s_waitcnt vmcnt(12)
    buffer_load_dwordx4 v[16:19], v1, s[24:27], s61 offen offset:0 sc1
    v_fmac_f32 v121, v125, v125
    v_lshlrev_b32 v122, 16, v118
    v_and_b32 v124, s69, v118
    v_add_f32 v120, v120, v122
    v_mfma_f32_32x32x16_bf16 v[64:79], a[148:151], v[100:103], v[64:79]
    buffer_load_dwordx4 v[20:23], v1, s[24:27], s61 offen offset:1024 sc1
    v_fmac_f32 v121, v122, v122
    v_add_f32 v120, v120, v124
    v_fmac_f32 v121, v124, v124
    v_lshlrev_b32 v123, 16, v119
    s_waitcnt lgkmcnt(1)
    v_mfma_f32_32x32x16_bf16 v[48:63], a[152:155], v[104:107], v[48:63]
    ds_read_b128 v[100:103], v12 offset:29856
    v_and_b32 v125, s69, v119
    v_add_f32 v120, v120, v123
    v_fmac_f32 v121, v123, v123
    v_add_f32 v120, v120, v125
    v_mfma_f32_32x32x16_bf16 v[64:79], a[156:159], v[104:107], v[64:79]
    buffer_load_dwordx4 v[24:27], v1, s[24:27], s61 offen offset:2048 sc1
    v_fmac_f32 v121, v125, v125
    v_lshlrev_b32 v122, 16, v112
    v_and_b32 v124, s69, v112
    v_add_f32 v120, v120, v122
    s_waitcnt lgkmcnt(1)
    v_mfma_f32_32x32x16_bf16 v[48:63], a[160:163], v[96:99], v[48:63]
    ds_read_b128 v[104:107], v12 offset:29888
    v_fmac_f32 v121, v122, v122
    v_add_f32 v120, v120, v124
    v_fmac_f32 v121, v124, v124
    v_lshlrev_b32 v123, 16, v113
    v_mfma_f32_32x32x16_bf16 v[64:79], a[164:167], v[96:99], v[64:79]
    buffer_load_dwordx4 v[28:31], v1, s[24:27], s61 offen offset:3072 sc1
    v_and_b32 v125, s69, v113
    v_add_f32 v120, v120, v123
    v_fmac_f32 v121, v123, v123
    v_add_f32 v120, v120, v125
    s_waitcnt lgkmcnt(1)
    v_mfma_f32_32x32x16_bf16 v[48:63], a[168:171], v[100:103], v[48:63]
    ds_read_b128 v[96:99], v12 offset:29920
    v_fmac_f32 v121, v125, v125
    v_lshlrev_b32 v122, 16, v114
    v_and_b32 v124, s69, v114
    v_add_f32 v120, v120, v122
    v_mfma_f32_32x32x16_bf16 v[64:79], a[172:175], v[100:103], v[64:79]
    buffer_load_dwordx4 v[32:35], v1, s[24:27], s62 offen offset:0 sc1
    v_fmac_f32 v121, v122, v122
    v_add_f32 v120, v120, v124
    v_fmac_f32 v121, v124, v124
    v_lshlrev_b32 v123, 16, v115
    s_waitcnt lgkmcnt(1)
    v_mfma_f32_32x32x16_bf16 v[48:63], a[176:179], v[104:107], v[48:63]
    ds_read_b128 v[100:103], v12 offset:29952
    v_and_b32 v125, s69, v115
    v_add_f32 v120, v120, v123
    v_fmac_f32 v121, v123, v123
    v_add_f32 v120, v120, v125
    v_mfma_f32_32x32x16_bf16 v[64:79], a[180:183], v[104:107], v[64:79]
    buffer_load_dwordx4 v[36:39], v1, s[24:27], s62 offen offset:1024 sc1
    v_fmac_f32 v121, v125, v125
    s_nop 0
    v_add_f32_dpp v120, v120, v120 quad_perm:[1,0,3,2] row_mask:0xf bank_mask:0xf
    v_add_f32_dpp v121, v121, v121 quad_perm:[1,0,3,2] row_mask:0xf bank_mask:0xf
    s_waitcnt lgkmcnt(1)
    v_mfma_f32_32x32x16_bf16 v[48:63], a[184:187], v[96:99], v[48:63]
    ds_read_b128 v[104:107], v12 offset:29984
    s_nop 0
    v_add_f32_dpp v120, v120, v120 quad_perm:[2,3,0,1] row_mask:0xf bank_mask:0xf
    v_add_f32_dpp v121, v121, v121 quad_perm:[2,3,0,1] row_mask:0xf bank_mask:0xf
    s_nop 0
    v_mfma_f32_32x32x16_bf16 v[64:79], a[188:191], v[96:99], v[64:79]
    buffer_load_dwordx4 v[40:43], v1, s[24:27], s62 offen offset:2048 sc1
    v_add_f32_dpp v120, v120, v120 row_half_mirror row_mask:0xf bank_mask:0xf
    v_add_f32_dpp v121, v121, v121 row_half_mirror row_mask:0xf bank_mask:0xf
    v_mul_f32 v120, 0xbb124925, v120
    v_mul_f32 v122, v120, v120
    s_waitcnt lgkmcnt(1)
    v_mfma_f32_32x32x16_bf16 v[48:63], a[192:195], v[100:103], v[48:63]
    ds_read_b128 v[96:99], v12 offset:30016
    buffer_load_dwordx4 v[44:47], v1, s[24:27], s62 offen offset:3072 sc1
    v_fmamk_f32 v121, v121, 0xbb124925, v122
    v_min_f32 v121, 0, v121
    v_sub_f32 v121, 0x3727c5ac, v121
    v_rsq_f32 v121, v121
    v_mfma_f32_32x32x16_bf16 v[64:79], a[196:199], v[100:103], v[64:79]
    ds_write_b64 v15, v[120:121] offset:64768
    s_waitcnt lgkmcnt(2)
    v_mfma_f32_32x32x16_bf16 v[48:63], a[200:203], v[104:107], v[48:63]
    ds_read_b128 v[100:103], v12 offset:30048
    buffer_load_dwordx4 v[128:131], v1, s[24:27], s63 offen offset:0 sc1
    v_mfma_f32_32x32x16_bf16 v[64:79], a[204:207], v[104:107], v[64:79]
    s_waitcnt lgkmcnt(1)
    s_barrier
    ds_read_b32 v110, v14 offset:64768
    v_mfma_f32_32x32x16_bf16 v[48:63], a[208:211], v[96:99], v[48:63]
    buffer_load_dwordx4 v[132:135], v1, s[24:27], s63 offen offset:1024 sc1
    v_mfma_f32_32x32x16_bf16 v[64:79], a[212:215], v[96:99], v[64:79]
    s_waitcnt lgkmcnt(1)
    v_mfma_f32_32x32x16_bf16 v[48:63], a[216:219], v[100:103], v[48:63]
    buffer_load_dwordx4 v[136:139], v1, s[24:27], s63 offen offset:2048 sc1
    s_waitcnt lgkmcnt(0)
    v_cndmask_b32 v110, 0, v110, s[52:53]
    v_cvt_pk_bf16_f32 v108, v110, v110
    v_and_b32 v111, s69, v108
    v_sub_f32 v110, v110, v111
    v_cvt_pk_bf16_f32 v109, v110, 0
    v_add_u32 v8, 114688, v1
    v_mfma_f32_32x32x16_bf16 v[64:79], a[220:223], v[100:103], v[64:79]
    v_mfma_f32_32x32x8_bf16 v[48:63], v[2:3], v[108:109], v[48:63]
    v_mfma_f32_32x32x8_bf16 v[64:79], v[4:5], v[108:109], v[64:79]
    buffer_load_dwordx4 v[140:143], v1, s[24:27], s63 offen offset:3072 sc1
    s_nop 9
    v_cvt_pk_bf16_f32 v112, v48, v49
    v_cvt_pk_bf16_f32 v113, v50, v51
    v_cvt_pk_bf16_f32 v114, v52, v53
    v_cvt_pk_bf16_f32 v115, -v54, -v55
    v_pk_max_i16 v112, v112, 0
    v_pk_max_i16 v113, v113, 0
    v_pk_max_i16 v114, v114, 0
    v_pk_max_u16 v115, v115, s54
    buffer_store_dwordx4 v[112:115], v8, s[24:27], s60 offen offset:0 sc1
    v_cvt_pk_bf16_f32 v116, v56, v57
    v_cvt_pk_bf16_f32 v117, v58, v59
    v_cvt_pk_bf16_f32 v118, v60, v61
    v_cvt_pk_bf16_f32 v119, -v62, -v63
    v_pk_max_i16 v116, v116, 0
    v_pk_max_i16 v117, v117, 0
    v_pk_max_i16 v118, v118, 0
    v_pk_max_u16 v119, v119, s54
    buffer_store_dwordx4 v[116:119], v8, s[24:27], s60 offen offset:1024 sc1
    v_cvt_pk_bf16_f32 v120, v64, v65
    v_cvt_pk_bf16_f32 v121, v66, v67
    v_cvt_pk_bf16_f32 v122, v68, v69
    v_cvt_pk_bf16_f32 v123, -v70, -v71
    v_pk_max_i16 v120, v120, 0
    v_pk_max_i16 v121, v121, 0
    v_pk_max_i16 v122, v122, 0
    v_pk_max_u16 v123, v123, s54
    buffer_store_dwordx4 v[120:123], v8, s[24:27], s60 offen offset:2048 sc1
    v_cvt_pk_bf16_f32 v124, v72, v73
    v_cvt_pk_bf16_f32 v125, v74, v75
    v_cvt_pk_bf16_f32 v126, v76, v77
    v_cvt_pk_bf16_f32 v127, -v78, -v79
    v_pk_max_i16 v124, v124, 0
    v_pk_max_i16 v125, v125, 0
    v_pk_max_i16 v126, v126, 0
    v_pk_max_u16 v127, v127, s54
    buffer_store_dwordx4 v[124:127], v8, s[24:27], s60 offen offset:3072 sc1
    v_mfma_f32_32x32x16_bf16 v[48:63], a[224:227], v[80:83], 0
    v_and_b32 v96, 7, v0
    v_lshrrev_b32 v97, 3, v0
    s_lshl_b32 s42, s32, 3
    v_add_u32 v96, s42, v96
    v_mul_u32_u24 v13, 1088, v97
    v_mfma_f32_32x32x16_bf16 v[64:79], a[228:231], v[80:83], 0
    v_lshl_add_u32 v13, v96, 4, v13
    v_bfe_i32 v98, v97, 0, 1
    v_lshl_add_u32 v13, v98, 6, v13
    v_lshlrev_b32 v14, 3, v96
    v_lshrrev_b32 v98, 4, v96
    v_mfma_f32_32x32x16_bf16 v[48:63], a[232:235], v[84:87], v[48:63]
    v_mul_u32_u24 v98, 14336, v98
    v_and_b32 v15, 15, v96
    v_lshl_add_u32 v15, v15, 4, v98
    v_lshl_add_u32 v15, v97, 8, v15
    s_mul_i32 s56, s34, 28672
    v_mfma_f32_32x32x16_bf16 v[64:79], a[236:239], v[84:87], v[64:79]
    s_lshl_b32 s42, s33, 11
    s_add_u32 s56, s56, s42
    s_add_u32 s56, s56, 3670016
    s_mul_i32 s57, s35, 28672
    s_lshl_b32 s42, s33, 11
    v_mfma_f32_32x32x16_bf16 v[48:63], a[240:243], v[88:91], v[48:63]
    s_waitcnt vmcnt(14)
    v_or_b32 v12, v16, v17
    v_bitop3_b32 v12, v12, v18, v19 bitop3:0xfd
    v_or3_b32 v12, v20, v21, v12
    v_bitop3_b32 v12, v12, v22, v23 bitop3:0xfd
    v_mfma_f32_32x32x16_bf16 v[64:79], a[244:247], v[88:91], v[64:79]
    buffer_load_dwordx4 v[80:83], v1, s[24:27], s64 offen offset:0 sc1
    s_add_u32 s57, s57, s42
    s_waitcnt vmcnt(14)
    v_or3_b32 v12, v24, v25, v12
    v_bitop3_b32 v12, v12, v26, v27 bitop3:0xfd
    v_mfma_f32_32x32x16_bf16 v[48:63], a[248:251], v[92:95], v[48:63]
    s_waitcnt vmcnt(13)
L_pad4:
    s_cbranch_execz L_ret0
    v_or3_b32 v12, v28, v29, v12
    v_bitop3_b32 v12, v12, v30, v31 bitop3:0xfd
    v_and_b32 v12, s54, v12
    v_cmp_ne_u32 vcc, 0, v12
    v_mfma_f32_32x32x16_bf16 v[64:79], a[252:255], v[92:95], v[64:79]
    buffer_load_dwordx4 v[84:87], v1, s[24:27], s64 offen offset:1024 sc1
    s_cbranch_vccnz slow_h0_01_15
ok_h0_01_16:
    v_mfma_f32_32x32x16_bf16 v[48:63], v[152:155], v[16:19], v[48:63]
    s_add_u32 s57, s57, 3670016
    s_mul_i32 s42, s32, 8704
    v_add_u32 v9, s42, v1
    v_mfma_f32_32x32x16_bf16 v[64:79], v[156:159], v[16:19], v[64:79]
    buffer_load_dwordx4 v[88:91], v1, s[24:27], s64 offen offset:2048 sc1
    s_barrier
    v_mfma_f32_32x32x16_bf16 v[48:63], v[160:163], v[20:23], v[48:63]
    v_mfma_f32_32x32x16_bf16 v[64:79], v[164:167], v[20:23], v[64:79]
    buffer_load_dwordx4 v[92:95], v1, s[24:27], s64 offen offset:3072 sc1
    v_mfma_f32_32x32x16_bf16 v[48:63], v[168:171], v[24:27], v[48:63]
    s_waitcnt vmcnt(14)
    v_or_b32 v12, v32, v33
    v_bitop3_b32 v12, v12, v34, v35 bitop3:0xfd
    v_or3_b32 v12, v36, v37, v12
    v_bitop3_b32 v12, v12, v38, v39 bitop3:0xfd
    v_mfma_f32_32x32x16_bf16 v[64:79], v[172:175], v[24:27], v[64:79]
    buffer_load_dwordx4 v[16:19], v1, s[24:27], s65 offen offset:0 sc1
    s_waitcnt vmcnt(14)
    v_or3_b32 v12, v40, v41, v12
    v_bitop3_b32 v12, v12, v42, v43 bitop3:0xfd
    v_mfma_f32_32x32x16_bf16 v[48:63], v[176:179], v[28:31], v[48:63]
    s_waitcnt vmcnt(13)
    v_or3_b32 v12, v44, v45, v12
    v_bitop3_b32 v12, v12, v46, v47 bitop3:0xfd
    v_and_b32 v12, s54, v12
    v_cmp_ne_u32 vcc, 0, v12
    v_mfma_f32_32x32x16_bf16 v[64:79], v[180:183], v[28:31], v[64:79]
    buffer_load_dwordx4 v[20:23], v1, s[24:27], s65 offen offset:1024 sc1
    s_cbranch_vccnz slow_h0_02_17
ok_h0_02_18:
    v_mfma_f32_32x32x16_bf16 v[48:63], v[184:187], v[32:35], v[48:63]
    v_mfma_f32_32x32x16_bf16 v[64:79], v[188:191], v[32:35], v[64:79]
    buffer_load_dwordx4 v[24:27], v1, s[24:27], s65 offen offset:2048 sc1
    v_mfma_f32_32x32x16_bf16 v[48:63], v[192:195], v[36:39], v[48:63]
    v_mfma_f32_32x32x16_bf16 v[64:79], v[196:199], v[36:39], v[64:79]
    buffer_load_dwordx4 v[28:31], v1, s[24:27], s65 offen offset:3072 sc1
    v_mfma_f32_32x32x16_bf16 v[48:63], v[200:203], v[40:43], v[48:63]
    s_waitcnt vmcnt(14)
    v_or_b32 v12, v128, v129
    v_bitop3_b32 v12, v12, v130, v131 bitop3:0xfd
    v_or3_b32 v12, v132, v133, v12
    v_bitop3_b32 v12, v12, v134, v135 bitop3:0xfd
    v_mfma_f32_32x32x16_bf16 v[64:79], v[204:207], v[40:43], v[64:79]
    buffer_load_dwordx4 v[32:35], v1, s[24:27], s66 offen offset:0 sc1
    s_waitcnt vmcnt(14)
    v_or3_b32 v12, v136, v137, v12
    v_bitop3_b32 v12, v12, v138, v139 bitop3:0xfd
    v_mfma_f32_32x32x16_bf16 v[48:63], v[208:211], v[44:47], v[48:63]
    s_waitcnt vmcnt(13)
    v_or3_b32 v12, v140, v141, v12
    v_bitop3_b32 v12, v12, v142, v143 bitop3:0xfd
    v_and_b32 v12, s54, v12
    v_cmp_ne_u32 vcc, 0, v12
    v_mfma_f32_32x32x16_bf16 v[64:79], v[212:215], v[44:47], v[64:79]
    buffer_load_dwordx4 v[36:39], v1, s[24:27], s66 offen offset:1024 sc1
    s_cbranch_vccnz slow_h0_03_19
ok_h0_03_20:
    v_mfma_f32_32x32x16_bf16 v[48:63], v[216:219], v[128:131], v[48:63]
    v_mfma_f32_32x32x16_bf16 v[64:79], v[220:223], v[128:131], v[64:79]
    buffer_load_dwordx4 v[40:43], v1, s[24:27], s66 offen offset:2048 sc1
    v_mfma_f32_32x32x16_bf16 v[48:63], v[224:227], v[132:135], v[48:63]
    s_lshr_b32 s42, s32, 1
    s_lshl_b32 s42, s42, 5
    s_add_u32 s42, s42, s34
    s_lshl_b32 s42, s42, 1
    s_and_b32 s43, s32, 1
    v_mfma_f32_32x32x16_bf16 v[64:79], v[228:231], v[132:135], v[64:79]
    buffer_load_dwordx4 v[44:47], v1, s[24:27], s66 offen offset:3072 sc1
    s_add_u32 s42, s42, s43
    s_lshl_b32 s49, s42, 10
    s_add_u32 s49, s49, 12845056
    s_mul_i32 s42, s42, 14336
    v_mfma_f32_32x32x16_bf16 v[48:63], v[232:235], v[136:139], v[48:63]
    s_add_u32 s42, s42, 3670016
    s_lshl_b32 s43, s33, 11
    s_waitcnt vmcnt(10)
    v_or_b32 v12, v80, v81
    v_bitop3_b32 v12, v12, v82, v83 bitop3:0xfd
    v_or3_b32 v12, v84, v85, v12
    v_bitop3_b32 v12, v12, v86, v87 bitop3:0xfd
    v_mfma_f32_32x32x16_bf16 v[64:79], v[236:239], v[136:139], v[64:79]
    v_lshlrev_b32 v6, 7, v0
    s_lshl_b32 s48, s32, 10
    s_add_u32 s48, s48, 15069184
    s_mov_b64 exec, 0xff
    buffer_load_dword v6, v6, s[24:27], s48 offen sc1
    s_mov_b64 exec, -1
    buffer_load_dwordx4 v[128:131], v8, s[24:27], s61 offen offset:0 sc1
    s_add_u32 s0, s42, s43
    s_add_u32 s43, s43, 2048
    s_waitcnt vmcnt(11)
    v_or3_b32 v12, v88, v89, v12
    v_bitop3_b32 v12, v12, v90, v91 bitop3:0xfd
    v_mfma_f32_32x32x16_bf16 v[48:63], v[240:243], v[140:143], v[48:63]
    ds_read_b128 v[104:107], v10 offset:0
    buffer_load_dwordx4 v[132:135], v8, s[24:27], s61 offen offset:1024 sc1
    s_sub_u32 s44, s43, 14336
    s_min_u32 s43, s43, s44
    s_waitcnt vmcnt(11)
    v_or3_b32 v12, v92, v93, v12
    v_bitop3_b32 v12, v12, v94, v95 bitop3:0xfd
    v_and_b32 v12, s54, v12
    v_cmp_ne_u32 vcc, 0, v12
    v_mfma_f32_32x32x16_bf16 v[64:79], v[244:247], v[140:143], v[64:79]
    ds_read_b128 v[108:111], v10 offset:1024
    s_add_u32 s1, s42, s43
    s_add_u32 s43, s43, 2048
    s_cbranch_vccnz slow_h0_04_21
ok_h0_04_22:
    v_mfma_f32_32x32x16_bf16 v[48:63], v[248:251], v[80:83], v[48:63]
    ds_read_b128 v[96:99], v10 offset:2048
    buffer_load_dwordx4 v[136:139], v8, s[24:27], s61 offen offset:2048 sc1
    s_sub_u32 s44, s43, 14336
    s_min_u32 s43, s43, s44
    s_add_u32 s3, s42, s43
    v_mfma_f32_32x32x16_bf16 v[64:79], v[252:255], v[80:83], v[64:79]
    ds_read_b128 v[100:103], v10 offset:3072
    s_add_u32 s43, s43, 2048
    s_sub_u32 s44, s43, 14336
    s_min_u32 s43, s43, s44
    s_add_u32 s4, s42, s43
    s_waitcnt lgkmcnt(3)
    v_mfma_f32_32x32x16_bf16 v[48:63], v[104:107], v[84:87], v[48:63]
    ds_read_b128 v[104:107], v10 offset:4096
    buffer_load_dwordx4 v[140:143], v8, s[24:27], s61 offen offset:3072 sc1
    s_add_u32 s43, s43, 2048
    s_sub_u32 s44, s43, 14336
    s_min_u32 s43, s43, s44
    s_waitcnt lgkmcnt(3)
    v_mfma_f32_32x32x16_bf16 v[64:79], v[108:111], v[84:87], v[64:79]
    ds_read_b128 v[108:111], v10 offset:5120
    s_add_u32 s5, s42, s43
    s_add_u32 s43, s43, 2048
    s_sub_u32 s44, s43, 14336
    s_min_u32 s43, s43, s44
    s_waitcnt lgkmcnt(3)
    v_mfma_f32_32x32x16_bf16 v[48:63], v[96:99], v[88:91], v[48:63]
    ds_read_b128 v[96:99], v10 offset:6144
    buffer_load_dwordx4 v[80:83], v8, s[24:27], s62 offen offset:0 sc1
    s_add_u32 s6, s42, s43
    s_add_u32 s43, s43, 2048
    s_waitcnt vmcnt(12)
    v_or_b32 v12, v16, v17
    v_bitop3_b32 v12, v12, v18, v19 bitop3:0xfd
    v_or3_b32 v12, v20, v21, v12
    v_bitop3_b32 v12, v12, v22, v23 bitop3:0xfd
    s_waitcnt lgkmcnt(3)
    v_mfma_f32_32x32x16_bf16 v[64:79], v[100:103], v[88:91], v[64:79]
    ds_read_b128 v[100:103], v10 offset:7168
    buffer_load_dwordx4 v[84:87], v8, s[24:27], s62 offen offset:1024 sc1
    s_sub_u32 s44, s43, 14336
    s_min_u32 s43, s43, s44
    s_waitcnt vmcnt(12)
    v_or3_b32 v12, v24, v25, v12
    v_bitop3_b32 v12, v12, v26, v27 bitop3:0xfd
    s_waitcnt lgkmcnt(3)
    v_mfma_f32_32x32x16_bf16 v[48:63], v[104:107], v[92:95], v[48:63]
    ds_read_b128 v[104:107], v10 offset:8192
    s_add_u32 s7, s42, s43
    s_lshl_b32 s42, s34, 11
    s_waitcnt vmcnt(11)
    v_or3_b32 v12, v28, v29, v12
    v_bitop3_b32 v12, v12, v30, v31 bitop3:0xfd
    v_and_b32 v12, s54, v12
    v_cmp_ne_u32 vcc, 0, v12
    s_waitcnt lgkmcnt(3)
    v_mfma_f32_32x32x16_bf16 v[64:79], v[108:111], v[92:95], v[64:79]
    ds_read_b128 v[108:111], v10 offset:9216
    buffer_load_dwordx4 v[88:91], v8, s[24:27], s62 offen offset:2048 sc1
    s_lshr_b32 s43, s32, 1
    s_lshl_b32 s43, s43, 10
    s_cbranch_vccnz slow_h0_05_23
ok_h0_05_24:
    s_waitcnt lgkmcnt(3)
    v_mfma_f32_32x32x16_bf16 v[48:63], v[96:99], v[16:19], v[48:63]
    ds_read_b128 v[96:99], v10 offset:10240
    buffer_load_dwordx4 v[92:95], v8, s[24:27], s62 offen offset:3072 sc1
    s_add_u32 s42, s42, s43
    s_and_b32 s43, s32, 1
    s_lshl_b32 s43, s43, 7
    s_waitcnt lgkmcnt(3)
    v_mfma_f32_32x32x16_bf16 v[64:79], v[100:103], v[16:19], v[64:79]
    ds_read_b128 v[100:103], v10 offset:11264
    s_add_u32 s42, s42, s43
    s_lshr_b32 s43, s33, 1
    s_lshl_b32 s43, s43, 8
    s_add_u32 s42, s42, s43
    s_waitcnt lgkmcnt(3)
    v_mfma_f32_32x32x16_bf16 v[48:63], v[104:107], v[20:23], v[48:63]
    ds_read_b128 v[104:107], v10 offset:12288
    s_and_b32 s43, s33, 1
    s_lshl_b32 s43, s43, 3
    s_add_u32 s42, s42, s43
    s_add_u32 s58, s42, 12845056
    s_waitcnt lgkmcnt(3)
    v_mfma_f32_32x32x16_bf16 v[64:79], v[108:111], v[20:23], v[64:79]
    ds_read_b128 v[108:111], v10 offset:13312
    s_lshl_b32 s42, s35, 11
    s_lshr_b32 s43, s32, 1
    s_lshl_b32 s43, s43, 10
    s_add_u32 s42, s42, s43
    s_waitcnt lgkmcnt(3)
    v_mfma_f32_32x32x16_bf16 v[48:63], v[96:99], v[24:27], v[48:63]
    ds_read_b128 v[96:99], v10 offset:14336
    s_and_b32 s43, s32, 1
    s_waitcnt vmcnt(11)
    v_or_b32 v12, v32, v33
    v_bitop3_b32 v12, v12, v34, v35 bitop3:0xfd
    v_or3_b32 v12, v36, v37, v12
    v_bitop3_b32 v12, v12, v38, v39 bitop3:0xfd
    s_waitcnt lgkmcnt(3)
    v_mfma_f32_32x32x16_bf16 v[64:79], v[100:103], v[24:27], v[64:79]
    ds_read_b128 v[100:103], v10 offset:15360
    s_lshl_b32 s43, s43, 7
    s_waitcnt vmcnt(10)
    v_or3_b32 v12, v40, v41, v12
    v_bitop3_b32 v12, v12, v42, v43 bitop3:0xfd
    s_waitcnt lgkmcnt(3)
    v_mfma_f32_32x32x16_bf16 v[48:63], v[104:107], v[28:31], v[48:63]
    ds_read_b128 v[104:107], v10 offset:16384
    s_add_u32 s42, s42, s43
    s_waitcnt vmcnt(9)
    v_or3_b32 v12, v44, v45, v12
    v_bitop3_b32 v12, v12, v46, v47 bitop3:0xfd
    v_and_b32 v12, s54, v12
    v_cmp_ne_u32 vcc, 0, v12
    s_waitcnt lgkmcnt(3)
    v_mfma_f32_32x32x16_bf16 v[64:79], v[108:111], v[28:31], v[64:79]
    ds_read_b128 v[108:111], v10 offset:17408
    s_lshr_b32 s43, s33, 1
    s_cbranch_vccnz slow_h0_06_25
ok_h0_06_26:
    s_waitcnt lgkmcnt(3)
    v_mfma_f32_32x32x16_bf16 v[48:63], v[96:99], v[32:35], v[48:63]
    ds_read_b128 v[96:99], v10 offset:18432
    s_lshl_b32 s43, s43, 8
    s_add_u32 s42, s42, s43
    s_and_b32 s43, s33, 1
    s_lshl_b32 s43, s43, 3
    s_waitcnt lgkmcnt(3)
    v_mfma_f32_32x32x16_bf16 v[64:79], v[100:103], v[32:35], v[64:79]
    ds_read_b128 v[100:103], v10 offset:19456
    s_add_u32 s42, s42, s43
    s_add_u32 s59, s42, 12845056
    s_waitcnt lgkmcnt(3)
    v_mfma_f32_32x32x16_bf16 v[48:63], v[104:107], v[36:39], v[48:63]
    ds_read_b128 v[104:107], v10 offset:20480
    s_waitcnt lgkmcnt(3)
    v_mfma_f32_32x32x16_bf16 v[64:79], v[108:111], v[36:39], v[64:79]
    ds_read_b128 v[108:111], v10 offset:21504
    s_waitcnt lgkmcnt(3)
    v_mfma_f32_32x32x16_bf16 v[48:63], v[96:99], v[40:43], v[48:63]
    s_waitcnt lgkmcnt(2)
    v_mfma_f32_32x32x16_bf16 v[64:79], v[100:103], v[40:43], v[64:79]
    s_waitcnt lgkmcnt(1)
    v_mfma_f32_32x32x16_bf16 v[48:63], v[104:107], v[44:47], v[48:63]
    s_waitcnt lgkmcnt(0)
    v_mfma_f32_32x32x16_bf16 v[64:79], v[108:111], v[44:47], v[64:79]
    v_mfma_f32_32x32x16_bf16 v[16:31], a[224:227], v[112:115], 0
    v_mfma_f32_32x32x16_bf16 v[32:47], a[228:231], v[112:115], 0
    buffer_load_dwordx4 v[112:115], v8, s[24:27], s63 offen offset:0 sc1
    v_mfma_f32_32x32x16_bf16 v[16:31], a[232:235], v[116:119], v[16:31]
    ds_read_b32 v7, v14 offset:64516
    s_nop 4
    ds_write_b128 v9, v[48:51] offset:28672
    v_mfma_f32_32x32x16_bf16 v[32:47], a[236:239], v[116:119], v[32:47]
    buffer_load_dwordx4 v[116:119], v8, s[24:27], s63 offen offset:1024 sc1
    v_mfma_f32_32x32x16_bf16 v[16:31], a[240:243], v[120:123], v[16:31]
    ds_write_b128 v9, v[52:55] offset:29696
    s_waitcnt vmcnt(8)
    v_or_b32 v12, v128, v129
    v_bitop3_b32 v12, v12, v130, v131 bitop3:0xfd
    v_or3_b32 v12, v132, v133, v12
    v_bitop3_b32 v12, v12, v134, v135 bitop3:0xfd
    v_mfma_f32_32x32x16_bf16 v[32:47], a[244:247], v[120:123], v[32:47]
    buffer_load_dwordx4 v[120:123], v8, s[24:27], s63 offen offset:2048 sc1
    s_waitcnt vmcnt(8)
    v_or3_b32 v12, v136, v137, v12
    v_bitop3_b32 v12, v12, v138, v139 bitop3:0xfd
    v_mfma_f32_32x32x16_bf16 v[16:31], a[248:251], v[124:127], v[16:31]
    ds_write_b128 v9, v[56:59] offset:30848
    s_waitcnt vmcnt(7)
    v_or3_b32 v12, v140, v141, v12
    v_bitop3_b32 v12, v12, v142, v143 bitop3:0xfd
    v_and_b32 v12, s54, v12
    v_cmp_ne_u32 vcc, 0, v12
    v_mfma_f32_32x32x16_bf16 v[32:47], a[252:255], v[124:127], v[32:47]
    buffer_load_dwordx4 v[124:127], v8, s[24:27], s63 offen offset:3072 sc1
    s_cbranch_vccnz slow_h0_11_27
ok_h0_11_28:
    v_mfma_f32_32x32x16_bf16 v[16:31], v[152:155], v[128:131], v[16:31]
    ds_write_b128 v9, v[60:63] offset:31872
    v_mfma_f32_32x32x16_bf16 v[32:47], v[156:159], v[128:131], v[32:47]
    buffer_load_dwordx4 v[128:131], v8, s[24:27], s64 offen offset:0 sc1
    v_cmp_ne_u32 s[46:47], s28, v6
    s_nop 0
    s_and_b32 s46, s46, 0xff
    s_cbranch_scc1 slow_cnt_1_29
ok_cnt_1_30:
    v_mfma_f32_32x32x16_bf16 v[16:31], v[160:163], v[132:135], v[16:31]
    ds_write_b128 v9, v[64:67] offset:33024
    v_mfma_f32_32x32x16_bf16 v[32:47], v[164:167], v[132:135], v[32:47]
    buffer_load_dwordx4 v[132:135], v8, s[24:27], s64 offen offset:1024 sc1
    v_mfma_f32_32x32x16_bf16 v[16:31], v[168:171], v[136:139], v[16:31]
    ds_write_b128 v9, v[68:71] offset:34048
    s_waitcnt vmcnt(8)
    v_or_b32 v12, v80, v81
    v_bitop3_b32 v12, v12, v82, v83 bitop3:0xfd
    v_or3_b32 v12, v84, v85, v12
    v_bitop3_b32 v12, v12, v86, v87 bitop3:0xfd
    v_mfma_f32_32x32x16_bf16 v[32:47], v[172:175], v[136:139], v[32:47]
    buffer_load_dwordx4 v[136:139], v8, s[24:27], s64 offen offset:2048 sc1
    s_waitcnt vmcnt(8)
    v_or3_b32 v12, v88, v89, v12
    v_bitop3_b32 v12, v12, v90, v91 bitop3:0xfd
    v_mfma_f32_32x32x16_bf16 v[16:31], v[176:179], v[140:143], v[16:31]
    ds_write_b128 v9, v[72:75] offset:35200
    s_waitcnt vmcnt(7)
    v_or3_b32 v12, v92, v93, v12
    v_bitop3_b32 v12, v12, v94, v95 bitop3:0xfd
    v_and_b32 v12, s54, v12
    v_cmp_ne_u32 vcc, 0, v12
    v_mfma_f32_32x32x16_bf16 v[32:47], v[180:183], v[140:143], v[32:47]
    buffer_load_dwordx4 v[140:143], v8, s[24:27], s64 offen offset:3072 sc1
    s_cbranch_vccnz slow_h0_12_31
ok_h0_12_32:
    v_mfma_f32_32x32x16_bf16 v[16:31], v[184:187], v[80:83], v[16:31]
    ds_write_b128 v9, v[76:79] offset:36224
    v_mfma_f32_32x32x16_bf16 v[32:47], v[188:191], v[80:83], v[32:47]
    buffer_load_dwordx4 v[80:83], v8, s[24:27], s65 offen offset:0 sc1
    v_mfma_f32_32x32x16_bf16 v[16:31], v[192:195], v[84:87], v[16:31]
    s_waitcnt lgkmcnt(0)
    s_barrier
    ds_read_b128 v[48:51], v13 offset:28672
    v_mfma_f32_32x32x16_bf16 v[32:47], v[196:199], v[84:87], v[32:47]
    buffer_load_dwordx4 v[84:87], v8, s[24:27], s65 offen offset:1024 sc1
    ds_read_b128 v[52:55], v13 offset:29184
    v_mfma_f32_32x32x16_bf16 v[16:31], v[200:203], v[88:91], v[16:31]
    ds_read_b128 v[56:59], v13 offset:37376
    ds_read_b128 v[60:63], v13 offset:37888
    s_waitcnt vmcnt(8)
    v_or_b32 v12, v112, v113
    v_bitop3_b32 v12, v12, v114, v115 bitop3:0xfd
    v_or3_b32 v12, v116, v117, v12
    v_bitop3_b32 v12, v12, v118, v119 bitop3:0xfd
    v_mfma_f32_32x32x16_bf16 v[32:47], v[204:207], v[88:91], v[32:47]
    buffer_load_dwordx4 v[88:91], v8, s[24:27], s65 offen offset:2048 sc1
    ds_read_b128 v[64:67], v13 offset:46080
    ds_read_b128 v[68:71], v13 offset:46592
    s_waitcnt vmcnt(8)
    v_or3_b32 v12, v120, v121, v12
    v_bitop3_b32 v12, v12, v122, v123 bitop3:0xfd
    v_mfma_f32_32x32x16_bf16 v[16:31], v[208:211], v[92:95], v[16:31]
    ds_read_b128 v[72:75], v13 offset:54784
    ds_read_b128 v[76:79], v13 offset:55296
    s_waitcnt vmcnt(7)
    v_or3_b32 v12, v124, v125, v12
    v_bitop3_b32 v12, v12, v126, v127 bitop3:0xfd
    v_and_b32 v12, s54, v12
    v_cmp_ne_u32 vcc, 0, v12
    v_mfma_f32_32x32x16_bf16 v[32:47], v[212:215], v[92:95], v[32:47]
    buffer_load_dwordx4 v[92:95], v8, s[24:27], s65 offen offset:3072 sc1
    s_cbranch_vccnz slow_h0_13_33
ok_h0_13_34:
    v_mfma_f32_32x32x16_bf16 v[16:31], v[216:219], v[112:115], v[16:31]
    s_waitcnt lgkmcnt(4)
    v_add_f32 v48, v48, v56
    v_add_f32 v49, v49, v57
    v_add_f32 v50, v50, v58
    v_add_f32 v51, v51, v59
    v_mfma_f32_32x32x16_bf16 v[32:47], v[220:223], v[112:115], v[32:47]
    buffer_load_dwordx4 v[112:115], v8, s[24:27], s66 offen offset:0 sc1
    v_add_f32 v52, v52, v60
    v_add_f32 v53, v53, v61
    v_add_f32 v54, v54, v62
    v_add_f32 v55, v55, v63
    s_waitcnt lgkmcnt(2)
    v_mfma_f32_32x32x16_bf16 v[16:31], v[224:227], v[116:119], v[16:31]
    v_add_f32 v48, v48, v64
    v_add_f32 v49, v49, v65
    v_add_f32 v50, v50, v66
    v_add_f32 v51, v51, v67
    v_add_f32 v52, v52, v68
    v_mfma_f32_32x32x16_bf16 v[32:47], v[228:231], v[116:119], v[32:47]
    buffer_load_dwordx4 v[116:119], v8, s[24:27], s66 offen offset:1024 sc1
    v_add_f32 v53, v53, v69
    v_add_f32 v54, v54, v70
    v_add_f32 v55, v55, v71
    s_waitcnt lgkmcnt(0)
    v_add_f32 v48, v48, v72
    v_mfma_f32_32x32x16_bf16 v[16:31], v[232:235], v[120:123], v[16:31]
    v_add_f32 v49, v49, v73
    v_add_f32 v50, v50, v74
    v_add_f32 v51, v51, v75
    v_add_f32 v52, v52, v76
    s_waitcnt vmcnt(8)
    v_or_b32 v12, v128, v129
    v_bitop3_b32 v12, v12, v130, v131 bitop3:0xfd
    v_or3_b32 v12, v132, v133, v12
    v_bitop3_b32 v12, v12, v134, v135 bitop3:0xfd
    v_mfma_f32_32x32x16_bf16 v[32:47], v[236:239], v[120:123], v[32:47]
    buffer_load_dwordx4 v[120:123], v8, s[24:27], s66 offen offset:2048 sc1
    v_add_f32 v53, v53, v77
    v_add_f32 v54, v54, v78
    v_add_f32 v55, v55, v79
    v_lshlrev_b32 v56, 16, v144
    s_waitcnt vmcnt(8)
    v_or3_b32 v12, v136, v137, v12
    v_bitop3_b32 v12, v12, v138, v139 bitop3:0xfd
    v_mfma_f32_32x32x16_bf16 v[16:31], v[240:243], v[124:127], v[16:31]
    ds_read_b128 v[104:107], v10 offset:0
    v_and_b32 v57, s69, v144
    v_lshlrev_b32 v58, 16, v145
    v_and_b32 v59, s69, v145
    v_lshlrev_b32 v60, 16, v146
    s_waitcnt vmcnt(7)
    v_or3_b32 v12, v140, v141, v12
    v_bitop3_b32 v12, v12, v142, v143 bitop3:0xfd
    v_and_b32 v12, s54, v12
    v_cmp_ne_u32 vcc, 0, v12
    v_mfma_f32_32x32x16_bf16 v[32:47], v[244:247], v[124:127], v[32:47]
    ds_read_b128 v[108:111], v10 offset:1024
    buffer_load_dwordx4 v[124:127], v8, s[24:27], s66 offen offset:3072 sc1
    v_and_b32 v61, s69, v146
    v_lshlrev_b32 v62, 16, v147
    v_and_b32 v63, s69, v147
    v_fma_f32 v48, v7, v48, v56
    s_cbranch_vccnz slow_h0_14_35
ok_h0_14_36:
    v_mfma_f32_32x32x16_bf16 v[16:31], v[248:251], v[128:131], v[16:31]
    ds_read_b128 v[96:99], v10 offset:2048
    v_fma_f32 v49, v7, v49, v57
    v_fma_f32 v50, v7, v50, v58
    v_fma_f32 v51, v7, v51, v59
    v_fma_f32 v52, v7, v52, v60
    v_mfma_f32_32x32x16_bf16 v[32:47], v[252:255], v[128:131], v[32:47]
    ds_read_b128 v[100:103], v10 offset:3072
    v_fma_f32 v53, v7, v53, v61
    v_fma_f32 v54, v7, v54, v62
    v_fma_f32 v55, v7, v55, v63
    v_cvt_pk_bf16_f32 v144, v48, v49
    s_waitcnt lgkmcnt(3)
    v_mfma_f32_32x32x16_bf16 v[16:31], v[104:107], v[132:135], v[16:31]
    ds_read_b128 v[104:107], v10 offset:4096
    v_cvt_pk_bf16_f32 v145, v50, v51
    v_cvt_pk_bf16_f32 v146, v52, v53
    v_cvt_pk_bf16_f32 v147, v54, v55
    v_add_f32 v64, v48, v49
    s_waitcnt lgkmcnt(3)
    v_mfma_f32_32x32x16_bf16 v[32:47], v[108:111], v[132:135], v[32:47]
    ds_read_b128 v[108:111], v10 offset:5120
    buffer_store_dwordx4 v[144:147], v15, s[24:27], s56 offen sc1
    v_mul_f32 v65, v48, v48
    v_fmac_f32 v65, v49, v49
    v_add_f32 v64, v64, v50
    s_waitcnt lgkmcnt(3)
    v_mfma_f32_32x32x16_bf16 v[16:31], v[96:99], v[136:139], v[16:31]
    ds_read_b128 v[96:99], v10 offset:6144
    v_fmac_f32 v65, v50, v50
    v_add_f32 v64, v64, v51
    v_fmac_f32 v65, v51, v51
    s_waitcnt vmcnt(7)
    v_or_b32 v12, v80, v81
    v_bitop3_b32 v12, v12, v82, v83 bitop3:0xfd
    v_or3_b32 v12, v84, v85, v12
    v_bitop3_b32 v12, v12, v86, v87 bitop3:0xfd
    s_waitcnt lgkmcnt(3)
    v_mfma_f32_32x32x16_bf16 v[32:47], v[100:103], v[136:139], v[32:47]
    ds_read_b128 v[100:103], v10 offset:8192
    v_add_f32 v64, v64, v52
    v_fmac_f32 v65, v52, v52
    v_add_f32 v64, v64, v53
    s_waitcnt vmcnt(6)
    v_or3_b32 v12, v88, v89, v12
    v_bitop3_b32 v12, v12, v90, v91 bitop3:0xfd
    s_waitcnt lgkmcnt(3)
    v_mfma_f32_32x32x16_bf16 v[16:31], v[104:107], v[140:143], v[16:31]
    ds_read_b128 v[104:107], v10 offset:10240
    v_fmac_f32 v65, v53, v53
    v_add_f32 v64, v64, v54
    v_fmac_f32 v65, v54, v54
    s_waitcnt vmcnt(5)
    v_or3_b32 v12, v92, v93, v12
    v_bitop3_b32 v12, v12, v94, v95 bitop3:0xfd
    v_and_b32 v12, s54, v12
    v_cmp_ne_u32 vcc, 0, v12
    s_waitcnt lgkmcnt(3)
    v_mfma_f32_32x32x16_bf16 v[32:47], v[108:111], v[140:143], v[32:47]
    ds_read_b128 v[108:111], v10 offset:12288
    v_add_f32 v64, v64, v55
    v_fmac_f32 v65, v55, v55
    v_and_b32 v66, 0x70, v1
    s_cbranch_vccnz slow_h0_15_37
ok_h0_15_38:
    s_waitcnt lgkmcnt(3)
    v_mfma_f32_32x32x16_bf16 v[16:31], v[96:99], v[80:83], v[16:31]
    ds_read_b128 v[96:99], v10 offset:14336
    v_lshrrev_b32 v67, 5, v0
    v_permlane32_swap_b32 v64, v65
    s_waitcnt vmcnt(3)
    v_or_b32 v12, v112, v113
    v_bitop3_b32 v12, v12, v114, v115 bitop3:0xfd
    v_or3_b32 v12, v116, v117, v12
    v_bitop3_b32 v12, v12, v118, v119 bitop3:0xfd
    s_waitcnt lgkmcnt(3)
    v_mfma_f32_32x32x16_bf16 v[16:31], v[100:103], v[84:87], v[16:31]
    ds_read_b128 v[100:103], v10 offset:16384
    v_add_f32 v64, v64, v65
    v_mov_b32 v65, v64
    v_lshl_add_u32 v66, v67, 2, v66
    s_waitcnt vmcnt(2)
    v_or3_b32 v12, v120, v121, v12
    v_bitop3_b32 v12, v12, v122, v123 bitop3:0xfd
    s_waitcnt lgkmcnt(3)
    v_mfma_f32_32x32x16_bf16 v[16:31], v[104:107], v[88:91], v[16:31]
    ds_read_b128 v[104:107], v10 offset:18432
    v_permlane16_swap_b32 v64, v65
    v_add_f32 v64, v64, v65
    s_waitcnt vmcnt(1)
    v_or3_b32 v12, v124, v125, v12
    v_bitop3_b32 v12, v12, v126, v127 bitop3:0xfd
    v_and_b32 v12, s54, v12
    v_cmp_ne_u32 vcc, 0, v12
    s_waitcnt lgkmcnt(3)
    v_mfma_f32_32x32x16_bf16 v[16:31], v[108:111], v[92:95], v[16:31]
    ds_read_b128 v[108:111], v10 offset:20480
    v_add_f32_dpp v64, v64, v64 row_ror:8 row_mask:0xf bank_mask:0xf
    s_mov_b32 exec_lo, 0xff
    s_mov_b32 exec_hi, 0xff
    buffer_store_dword v64, v66, s[24:27], s58 offen sc1
    s_mov_b64 exec, -1
    s_cbranch_vccnz slow_h0_16_39
ok_h0_16_40:
    s_waitcnt lgkmcnt(3)
    v_mfma_f32_32x32x16_bf16 v[16:31], v[96:99], v[112:115], v[16:31]
    ds_read_b128 v[96:99], v10 offset:7168
    s_barrier
    ds_read_b32 v7, v14 offset:64772
    s_waitcnt lgkmcnt(4)
    v_mfma_f32_32x32x16_bf16 v[16:31], v[100:103], v[116:119], v[16:31]
    ds_read_b128 v[100:103], v10 offset:9216
    s_waitcnt lgkmcnt(4)
    v_mfma_f32_32x32x16_bf16 v[16:31], v[104:107], v[120:123], v[16:31]
    ds_read_b128 v[104:107], v10 offset:11264
    s_waitcnt lgkmcnt(4)
    v_mfma_f32_32x32x16_bf16 v[16:31], v[108:111], v[124:127], v[16:31]
    ds_read_b128 v[108:111], v10 offset:13312
    v_lshlrev_b32 v128, 16, v148
    v_and_b32 v129, s69, v148
    v_lshlrev_b32 v130, 16, v149
    v_and_b32 v131, s69, v149
    s_waitcnt lgkmcnt(4)
    v_mfma_f32_32x32x16_bf16 v[32:47], v[96:99], v[80:83], v[32:47]
    ds_read_b128 v[96:99], v10 offset:15360
    v_lshlrev_b32 v132, 16, v150
    v_and_b32 v133, s69, v150
    v_lshlrev_b32 v134, 16, v151
    v_and_b32 v135, s69, v151
    s_waitcnt lgkmcnt(3)
    v_mfma_f32_32x32x16_bf16 v[32:47], v[100:103], v[84:87], v[32:47]
    ds_read_b128 v[100:103], v10 offset:17408
    ds_write_b128 v9, v[16:19] offset:28672
    s_waitcnt lgkmcnt(4)
    v_mfma_f32_32x32x16_bf16 v[32:47], v[104:107], v[88:91], v[32:47]
    ds_read_b128 v[104:107], v10 offset:19456
    s_waitcnt lgkmcnt(4)
    v_mfma_f32_32x32x16_bf16 v[32:47], v[108:111], v[92:95], v[32:47]
    ds_read_b128 v[108:111], v10 offset:21504
    ds_write_b128 v9, v[20:23] offset:29696
    s_waitcnt lgkmcnt(5)
    v_mfma_f32_32x32x16_bf16 v[32:47], v[96:99], v[112:115], v[32:47]
    s_waitcnt lgkmcnt(4)
    v_mfma_f32_32x32x16_bf16 v[32:47], v[100:103], v[116:119], v[32:47]
    ds_write_b128 v9, v[24:27] offset:30848
    s_waitcnt lgkmcnt(3)
    v_mfma_f32_32x32x16_bf16 v[32:47], v[104:107], v[120:123], v[32:47]
    s_waitcnt lgkmcnt(2)
    v_mfma_f32_32x32x16_bf16 v[32:47], v[108:111], v[124:127], v[32:47]
    ds_write_b128 v9, v[28:31] offset:31872
    s_nop 10
    ds_write_b128 v9, v[32:35] offset:33024
    ds_write_b128 v9, v[36:39] offset:34048
    ds_write_b128 v9, v[40:43] offset:35200
    ds_write_b128 v9, v[44:47] offset:36224
    s_waitcnt lgkmcnt(0)
    s_barrier
    ds_read_b128 v[48:51], v13 offset:28672
    ds_read_b128 v[52:55], v13 offset:29184
    ds_read_b128 v[56:59], v13 offset:37376
    ds_read_b128 v[60:63], v13 offset:37888
    ds_read_b128 v[64:67], v13 offset:46080
    ds_read_b128 v[68:71], v13 offset:46592
    ds_read_b128 v[72:75], v13 offset:54784
    ds_read_b128 v[76:79], v13 offset:55296
    s_waitcnt lgkmcnt(4)
    v_pk_add_f32 v[48:49], v[48:49], v[56:57]
    v_pk_add_f32 v[50:51], v[50:51], v[58:59]
    v_pk_add_f32 v[52:53], v[52:53], v[60:61]
    v_pk_add_f32 v[54:55], v[54:55], v[62:63]
    s_waitcnt lgkmcnt(0)
    v_pk_add_f32 v[64:65], v[64:65], v[72:73]
    v_pk_add_f32 v[66:67], v[66:67], v[74:75]
    v_pk_add_f32 v[68:69], v[68:69], v[76:77]
    v_pk_add_f32 v[70:71], v[70:71], v[78:79]
    v_pk_add_f32 v[48:49], v[48:49], v[64:65]
    v_pk_add_f32 v[50:51], v[50:51], v[66:67]
    v_pk_add_f32 v[52:53], v[52:53], v[68:69]
    v_pk_add_f32 v[54:55], v[54:55], v[70:71]
    v_pk_fma_f32 v[48:49], v[48:49], v[6:7], v[128:129] op_sel:[0,1,0]
    v_pk_fma_f32 v[50:51], v[50:51], v[6:7], v[130:131] op_sel:[0,1,0]
    v_pk_fma_f32 v[52:53], v[52:53], v[6:7], v[132:133] op_sel:[0,1,0]
    v_pk_fma_f32 v[54:55], v[54:55], v[6:7], v[134:135] op_sel:[0,1,0]
    v_cvt_pk_bf16_f32 v148, v48, v49
    v_cvt_pk_bf16_f32 v149, v50, v51
    v_cvt_pk_bf16_f32 v150, v52, v53
    v_cvt_pk_bf16_f32 v151, v54, v55
    buffer_store_dwordx4 v[148:151], v15, s[24:27], s57 offen sc1
    v_add_f32 v64, v48, v49
    v_mul_f32 v65, v48, v48
    v_fmac_f32 v65, v49, v49
    v_add_f32 v64, v64, v50
    v_fmac_f32 v65, v50, v50
    v_add_f32 v64, v64, v51
    v_fmac_f32 v65, v51, v51
    v_add_f32 v64, v64, v52
    v_fmac_f32 v65, v52, v52
    v_add_f32 v64, v64, v53
    v_fmac_f32 v65, v53, v53
    v_add_f32 v64, v64, v54
    v_fmac_f32 v65, v54, v54
    v_add_f32 v64, v64, v55
    v_fmac_f32 v65, v55, v55
    v_and_b32 v66, 0x70, v1
    v_lshrrev_b32 v67, 5, v0
    v_permlane32_swap_b32 v64, v65
    v_add_f32 v64, v64, v65
    v_mov_b32 v65, v64
    v_lshl_add_u32 v66, v67, 2, v66
    s_nop 0
    v_permlane16_swap_b32 v64, v65
    v_add_f32 v64, v64, v65
    s_nop 1
    v_add_f32_dpp v64, v64, v64 row_ror:8 row_mask:0xf bank_mask:0xf
    s_mov_b32 exec_lo, 0xff
    s_mov_b32 exec_hi, 0xff
    buffer_store_dword v64, v66, s[24:27], s59 offen sc1
    s_mov_b64 exec, -1
    s_lshl_b32 s46, s2, 2
    s_add_u32 s46, s46, s32
    s_cmp_eq_u32 s46, 128
    s_cbranch_scc1 L_epoch
L_epoch_ret:
    v_and_b32 v72, 15, v0
    s_and_b32 s42, s32, 1
    s_lshl_b32 s43, s33, 5
    s_add_u32 s42, s42, s43
    v_lshl_add_u32 v72, v72, 1, s42
    v_mov_b32 v73, 224
L_pad5:
    s_cbranch_execz L_pad7
    v_cmp_eq_u32 vcc, 0, v72
    v_lshrrev_b32 v75, 4, v0
    s_lshl_b32 s43, s43, 1
    v_lshl_add_u32 v75, v75, 3, s43
    v_cndmask_b32 v72, v72, v73, vcc
    v_cvt_f32_u32 v75, v75
    v_cvt_f32_u32 v72, v72
    s_cmp_ge_u32 s32, 2
    s_cselect_b32 s42, 0xc2e00000, 0
    v_fma_f32 v73, v75, v72, s42
    v_mul_f32 v72, 0x3b124925, v72
    v_mul_f32 v75, 0x3b124925, v73
    v_rndne_f32 v75, v75
    v_fmamk_f32 v73, v75, 0xc3e00000, v73
    v_mul_f32 v73, 0x3b124925, v73
    v_mul_f32 v74, 0x42000000, v72
    v_cos_f32 v74, v74
    s_mul_i32 s42, s32, 7168
    s_add_u32 s42, s42, 0
    v_add_u32 v75, s42, v1
    v_add_f32 v74, v74, v74
    v_fmamk_f32 v76, v72, 0x00000000, v73
    v_fmamk_f32 v77, v72, 0x3f800000, v73
    v_fmamk_f32 v78, v72, 0x40000000, v73
    v_fmamk_f32 v79, v72, 0x40400000, v73
    v_fmamk_f32 v80, v72, 0x40800000, v73
    v_fmamk_f32 v81, v72, 0x40a00000, v73
    v_fmamk_f32 v82, v72, 0x40c00000, v73
    v_fmamk_f32 v83, v72, 0x40e00000, v73
    v_cos_f32 v76, v76
    v_cos_f32 v77, v77
    v_cos_f32 v78, v78
    v_cos_f32 v79, v79
    v_cos_f32 v80, v80
    v_cos_f32 v81, v81
    v_cos_f32 v82, v82
    s_cmp_lt_u32 s32, 2
    s_cbranch_scc0 xskip_41
    buffer_load_dwordx4 v[16:19], v1, s[24:27], s0 offen offset:0 sc1
    buffer_load_dwordx4 v[44:47], v1, s[24:27], s4 offen offset:1024 sc1
    buffer_load_dwordx4 v[20:23], v1, s[24:27], s0 offen offset:1024 sc1
    buffer_load_dwordx4 v[48:51], v1, s[24:27], s5 offen offset:0 sc1
    buffer_load_dwordx4 v[24:27], v1, s[24:27], s1 offen offset:0 sc1
    buffer_load_dwordx4 v[52:55], v1, s[24:27], s5 offen offset:1024 sc1
xskip_41:
    v_cos_f32 v83, v83
    v_cvt_pk_bf16_f32 v92, v76, v77
    v_cvt_pk_bf16_f32 v93, v78, v79
    v_cvt_pk_bf16_f32 v94, v80, v81
    v_cvt_pk_bf16_f32 v95, v82, v83
    ds_write_b128 v75, v[92:95] offset:0
    v_fmamk_f32 v84, v72, 0x42000000, v73
    v_fmamk_f32 v85, v72, 0x42040000, v73
    v_fmamk_f32 v86, v72, 0x42080000, v73
    v_fmamk_f32 v87, v72, 0x420c0000, v73
    v_fmamk_f32 v88, v72, 0x42100000, v73
    v_fmamk_f32 v89, v72, 0x42140000, v73
    v_fmamk_f32 v90, v72, 0x42180000, v73
    v_fmamk_f32 v91, v72, 0x421c0000, v73
    v_cos_f32 v84, v84
    v_cos_f32 v85, v85
    v_cos_f32 v86, v86
    v_cos_f32 v87, v87
    v_cos_f32 v88, v88
    v_cos_f32 v89, v89
    v_cos_f32 v90, v90
    v_cos_f32 v91, v91
    v_cvt_pk_bf16_f32 v96, v84, v85
    v_cvt_pk_bf16_f32 v97, v86, v87
    v_cvt_pk_bf16_f32 v98, v88, v89
    v_cvt_pk_bf16_f32 v99, v90, v91
    ds_write_b128 v75, v[96:99] offset:1024
    v_pk_fma_f32 v[76:77], v[74:75], v[84:85], v[76:77] op_sel_hi:[0,1,1] neg_lo:[0,0,1] neg_hi:[0,0,1]
    s_cmp_lt_u32 s32, 2
    s_cbranch_scc0 xskip_42
    buffer_load_dwordx4 v[28:31], v1, s[24:27], s1 offen offset:1024 sc1
    buffer_load_dwordx4 v[136:139], v1, s[24:27], s49 offen sc1
    buffer_load_dwordx4 v[56:59], v1, s[24:27], s6 offen offset:0 sc1
    buffer_load_dwordx4 v[32:35], v1, s[24:27], s3 offen offset:0 sc1
    buffer_load_dwordx4 v[60:63], v1, s[24:27], s6 offen offset:1024 sc1
xskip_42:
    v_pk_fma_f32 v[78:79], v[74:75], v[86:87], v[78:79] op_sel_hi:[0,1,1] neg_lo:[0,0,1] neg_hi:[0,0,1]
    v_pk_fma_f32 v[80:81], v[74:75], v[88:89], v[80:81] op_sel_hi:[0,1,1] neg_lo:[0,0,1] neg_hi:[0,0,1]
    v_pk_fma_f32 v[82:83], v[74:75], v[90:91], v[82:83] op_sel_hi:[0,1,1] neg_lo:[0,0,1] neg_hi:[0,0,1]
    v_cvt_pk_bf16_f32 v92, v76, v77
    v_cvt_pk_bf16_f32 v93, v78, v79
    v_cvt_pk_bf16_f32 v94, v80, v81
    v_cvt_pk_bf16_f32 v95, v82, v83
    ds_write_b128 v75, v[92:95] offset:2048
    v_pk_fma_f32 v[84:85], v[74:75], v[76:77], v[84:85] op_sel_hi:[0,1,1] neg_lo:[0,0,1] neg_hi:[0,0,1]
    v_pk_fma_f32 v[86:87], v[74:75], v[78:79], v[86:87] op_sel_hi:[0,1,1] neg_lo:[0,0,1] neg_hi:[0,0,1]
    v_pk_fma_f32 v[88:89], v[74:75], v[80:81], v[88:89] op_sel_hi:[0,1,1] neg_lo:[0,0,1] neg_hi:[0,0,1]
    v_pk_fma_f32 v[90:91], v[74:75], v[82:83], v[90:91] op_sel_hi:[0,1,1] neg_lo:[0,0,1] neg_hi:[0,0,1]
    v_cvt_pk_bf16_f32 v96, v84, v85
    v_cvt_pk_bf16_f32 v97, v86, v87
    v_cvt_pk_bf16_f32 v98, v88, v89
    v_cvt_pk_bf16_f32 v99, v90, v91
    ds_write_b128 v75, v[96:99] offset:3072
    v_pk_fma_f32 v[76:77], v[74:75], v[84:85], v[76:77] op_sel_hi:[0,1,1] neg_lo:[0,0,1] neg_hi:[0,0,1]
    v_pk_fma_f32 v[78:79], v[74:75], v[86:87], v[78:79] op_sel_hi:[0,1,1] neg_lo:[0,0,1] neg_hi:[0,0,1]
    v_pk_fma_f32 v[80:81], v[74:75], v[88:89], v[80:81] op_sel_hi:[0,1,1] neg_lo:[0,0,1] neg_hi:[0,0,1]
    v_pk_fma_f32 v[82:83], v[74:75], v[90:91], v[82:83] op_sel_hi:[0,1,1] neg_lo:[0,0,1] neg_hi:[0,0,1]
    v_cvt_pk_bf16_f32 v92, v76, v77
    v_cvt_pk_bf16_f32 v93, v78, v79
    v_cvt_pk_bf16_f32 v94, v80, v81
    v_cvt_pk_bf16_f32 v95, v82, v83
    ds_write_b128 v75, v[92:95] offset:4096
    v_pk_fma_f32 v[84:85], v[74:75], v[76:77], v[84:85] op_sel_hi:[0,1,1] neg_lo:[0,0,1] neg_hi:[0,0,1]
    v_pk_fma_f32 v[86:87], v[74:75], v[78:79], v[86:87] op_sel_hi:[0,1,1] neg_lo:[0,0,1] neg_hi:[0,0,1]
    v_pk_fma_f32 v[88:89], v[74:75], v[80:81], v[88:89] op_sel_hi:[0,1,1] neg_lo:[0,0,1] neg_hi:[0,0,1]
    v_pk_fma_f32 v[90:91], v[74:75], v[82:83], v[90:91] op_sel_hi:[0,1,1] neg_lo:[0,0,1] neg_hi:[0,0,1]
    v_cvt_pk_bf16_f32 v96, v84, v85
    v_cvt_pk_bf16_f32 v97, v86, v87
    v_cvt_pk_bf16_f32 v98, v88, v89
    v_cvt_pk_bf16_f32 v99, v90, v91
    ds_write_b128 v75, v[96:99] offset:5120
    v_pk_fma_f32 v[76:77], v[74:75], v[84:85], v[76:77] op_sel_hi:[0,1,1] neg_lo:[0,0,1] neg_hi:[0,0,1]
    v_pk_fma_f32 v[78:79], v[74:75], v[86:87], v[78:79] op_sel_hi:[0,1,1] neg_lo:[0,0,1] neg_hi:[0,0,1]
    v_pk_fma_f32 v[80:81], v[74:75], v[88:89], v[80:81] op_sel_hi:[0,1,1] neg_lo:[0,0,1] neg_hi:[0,0,1]
    v_pk_fma_f32 v[82:83], v[74:75], v[90:91], v[82:83] op_sel_hi:[0,1,1] neg_lo:[0,0,1] neg_hi:[0,0,1]
    v_cvt_pk_bf16_f32 v92, v76, v77
    v_cvt_pk_bf16_f32 v93, v78, v79
    v_cvt_pk_bf16_f32 v94, v80, v81
    v_cvt_pk_bf16_f32 v95, v82, v83
    ds_write_b128 v75, v[92:95] offset:6144
    s_mov_b32 s52, -1
    s_mov_b32 s53, 0xffff
    v_and_b32 v148, 15, v0
    v_lshrrev_b32 v149, 4, v0
    v_lshrrev_b32 v14, 2, v148
    v_xor_b32 v14, v14, v149
    v_lshlrev_b32 v150, 5, v148
    v_lshl_add_u32 v150, v14, 3, v150
    s_lshl_b32 s42, s32, 9
    s_add_u32 s42, s42, 57344
    v_add_u32 v150, s42, v150
    s_lshl_b32 s42, s32, 2
    v_add_u32 v15, s42, v149
    v_cmp_eq_u32 vcc, 0, v15
    v_mul_u32_u24 v15, 114688, v15
    v_lshl_add_u32 v15, v148, 4, v15
    v_cndmask_b32 v151, -1.0, 0, vcc
    s_and_b32 s46, s2, 7
    s_lshl_b32 s46, s46, 2
    s_add_u32 s46, s46, s41
    s_mul_i32 s46, s46, 7
    s_add_u32 s46, s46, s33
    s_lshl_b32 s46, s46, 8
    s_add_u32 s46, s46, 1835008
    s_add_u32 s47, s46, 57344
    v_xor_b32 v14, v0, v149
    v_lshlrev_b32 v14, 3, v14
    s_cmp_lt_u32 s32, 2
    s_cbranch_scc1 xskip_43
    buffer_load_dwordx4 v[16:19], v1, s[24:27], s0 offen offset:0 sc1
    buffer_load_dwordx4 v[44:47], v1, s[24:27], s4 offen offset:1024 sc1
    buffer_load_dwordx4 v[20:23], v1, s[24:27], s0 offen offset:1024 sc1
    buffer_load_dwordx4 v[48:51], v1, s[24:27], s5 offen offset:0 sc1
    buffer_load_dwordx4 v[24:27], v1, s[24:27], s1 offen offset:0 sc1
    buffer_load_dwordx4 v[52:55], v1, s[24:27], s5 offen offset:1024 sc1
xskip_43:
    v_add_u32 v14, 57344, v14
    s_waitcnt lgkmcnt(0)
    s_barrier
    ds_read_b128 v[108:111], v1 offset:7168
    ds_read_b128 v[116:119], v1 offset:21504
    ds_read_b128 v[104:107], v1 offset:0
    ds_read_b128 v[112:115], v1 offset:14336
    v_bfe_u32 v100, v0, 1, 3
    s_lshl_b32 s42, s32, 3
    v_add_u32 v100, s42, v100
    v_and_b32 v102, 1, v0
    v_cvt_f32_u32 v101, v102
    v_cmp_eq_u32 vcc, 0, v100
    v_lshlrev_b32 v102, 5, v102
    v_mul_f32 v101, 0xbe800000, v101
    v_cndmask_b32 v100, v100, v102, vcc
    v_cndmask_b32 v101, v101, 0, vcc
    v_bfe_i32 v103, v100, 0, 1
    v_cvt_f32_u32 v100, v100
    v_and_b32 v102, 48, v0
    v_cvt_f32_u32 v102, v102
    v_and_b32 v103, 0x80008000, v103
    v_mul_f32 v100, 0x3c000000, v100
    v_fma_f32 v101, v102, v100, v101
    v_fmamk_f32 v120, v100, 0x00000000, v101
    v_fmamk_f32 v121, v100, 0x40800000, v101
    v_fmamk_f32 v122, v100, 0x41000000, v101
    v_fmamk_f32 v123, v100, 0x41400000, v101
    s_cmp_lt_u32 s32, 2
    s_cbranch_scc1 xskip_44
    buffer_load_dwordx4 v[28:31], v1, s[24:27], s1 offen offset:1024 sc1
    buffer_load_dwordx4 v[136:139], v1, s[24:27], s49 offen sc1
    buffer_load_dwordx4 v[56:59], v1, s[24:27], s6 offen offset:0 sc1
    buffer_load_dwordx4 v[32:35], v1, s[24:27], s3 offen offset:0 sc1
    buffer_load_dwordx4 v[60:63], v1, s[24:27], s6 offen offset:1024 sc1
xskip_44:
    v_fmamk_f32 v124, v100, 0x40000000, v101
    v_fmamk_f32 v125, v100, 0x40c00000, v101
    v_fmamk_f32 v126, v100, 0x41200000, v101
    v_fmamk_f32 v127, v100, 0x41600000, v101
    v_cos_f32 v120, v120
    v_cos_f32 v121, v121
    v_cos_f32 v122, v122
    v_cos_f32 v123, v123
    v_cos_f32 v124, v124
    v_cos_f32 v125, v125
    v_cos_f32 v126, v126
    v_cos_f32 v127, v127
    v_cvt_pk_f16_f32 v140, v120, v121
    v_cvt_pk_f16_f32 v141, v122, v123
    v_cvt_pk_f16_f32 v144, v124, v125
    v_cvt_pk_f16_f32 v145, v126, v127
    v_xor_b32 v142, v140, v103
    v_xor_b32 v143, v141, v103
    v_xor_b32 v146, v144, v103
    v_xor_b32 v147, v145, v103
    v_mul_u32_u24 v149, 80, v149
    ds_bpermute_b32 v100, v149, v11 offset:0
    ds_bpermute_b32 v101, v149, v11 offset:4
    ds_bpermute_b32 v102, v149, v11 offset:8
    ds_bpermute_b32 v103, v149, v11 offset:12
    s_waitcnt vmcnt(7)
    v_max_u32 v149, v16, v44
    v_max3_u32 v149, v149, v20, v48
    v_cmp_eq_u32 vcc, -1, v149
    s_cbranch_vccnz slow_x2_0_45
ok_x2_0_46:
    s_waitcnt lgkmcnt(6)
    v_mfma_f32_16x16x32_bf16 v[76:79], v[108:111], v[16:19], 0
    ds_read_b128 v[124:127], v1 offset:8192
    v_mfma_f32_16x16x32_bf16 v[88:91], v[116:119], v[16:19], 0
    ds_read_b128 v[132:135], v1 offset:22528
    s_waitcnt lgkmcnt(6)
    v_mfma_f32_16x16x32_bf16 v[72:75], v[104:107], v[16:19], 0
    ds_read_b128 v[120:123], v1 offset:1024
    v_mfma_f32_16x16x32_bf16 v[84:87], v[112:115], v[16:19], 0
    ds_read_b128 v[128:131], v1 offset:15360
    v_mfma_f32_16x16x32_bf16 v[80:83], v[108:111], v[44:47], 0
    buffer_load_dwordx4 v[36:39], v1, s[24:27], s3 offen offset:1024 sc1
    v_mfma_f32_16x16x32_bf16 v[92:95], v[116:119], v[44:47], 0
    buffer_load_dwordx4 v[64:67], v1, s[24:27], s7 offen offset:0 sc1
    v_mfma_f32_16x16x32_bf16 v[72:75], v[104:107], v[44:47], v[72:75]
    buffer_load_dwordx4 v[40:43], v1, s[24:27], s4 offen offset:0 sc1
    v_mfma_f32_16x16x32_bf16 v[84:87], v[112:115], v[44:47], v[84:87]
    buffer_load_dwordx4 v[68:71], v1, s[24:27], s7 offen offset:1024 sc1
    s_waitcnt lgkmcnt(2)
    v_mfma_f32_16x16x32_bf16 v[76:79], v[124:127], v[20:23], v[76:79]
    ds_read_b128 v[108:111], v1 offset:9216
    v_mfma_f32_16x16x32_bf16 v[88:91], v[132:135], v[20:23], v[88:91]
    ds_read_b128 v[116:119], v1 offset:23552
    s_waitcnt lgkmcnt(2)
    v_mfma_f32_16x16x32_bf16 v[72:75], v[120:123], v[20:23], v[72:75]
    ds_read_b128 v[104:107], v1 offset:2048
    v_mfma_f32_16x16x32_bf16 v[84:87], v[128:131], v[20:23], v[84:87]
    ds_read_b128 v[112:115], v1 offset:16384
    v_mfma_f32_16x16x32_bf16 v[80:83], v[124:127], v[48:51], v[80:83]
    s_waitcnt vmcnt(6)
    v_cndmask_b32 v138, 0, v138, s[52:53]
    v_cndmask_b32 v139, 0, v139, s[52:53]
    v_mfma_f32_16x16x32_bf16 v[92:95], v[132:135], v[48:51], v[92:95]
    v_max_u32 v149, v24, v52
    v_max3_u32 v149, v149, v28, v56
    v_mfma_f32_16x16x32_bf16 v[72:75], v[120:123], v[48:51], v[72:75]
    v_max3_u32 v149, v149, v136, v137
    v_max3_u32 v149, v149, v138, v139
    v_cmp_eq_u32 vcc, -1, v149
    v_mfma_f32_16x16x32_bf16 v[84:87], v[128:131], v[48:51], v[84:87]
    s_cbranch_vccnz slow_x2_2_47
ok_x2_2_48:
    s_waitcnt lgkmcnt(2)
    v_mfma_f32_16x16x32_bf16 v[76:79], v[108:111], v[24:27], v[76:79]
    ds_read_b128 v[124:127], v1 offset:10240
    v_add_f32 v136, v136, v138
    v_mfma_f32_16x16x32_bf16 v[88:91], v[116:119], v[24:27], v[88:91]
    ds_read_b128 v[132:135], v1 offset:24576
    v_add_f32 v137, v137, v139
    s_waitcnt lgkmcnt(2)
    v_mfma_f32_16x16x32_bf16 v[72:75], v[104:107], v[24:27], v[72:75]
    ds_read_b128 v[120:123], v1 offset:3072
    v_mfma_f32_16x16x32_bf16 v[84:87], v[112:115], v[24:27], v[84:87]
    ds_read_b128 v[128:131], v1 offset:17408
    v_permlane32_swap_b32 v136, v137
    v_mfma_f32_16x16x32_bf16 v[80:83], v[108:111], v[52:55], v[80:83]
    s_mul_i32 s68, s32, 7168
    s_add_u32 m0, s68, 28672
    s_mul_i32 s67, s35, 28672
    s_add_u32 s67, s67, s68
    s_add_u32 s67, s67, 3670016
    buffer_load_dwordx4 v1, s[24:27], s67 offen offset:0 sc1 lds
    v_mfma_f32_16x16x32_bf16 v[92:95], v[116:119], v[52:55], v[92:95]
    buffer_load_dwordx4 v1, s[24:27], s67 offen offset:1024 sc1 lds
    v_mfma_f32_16x16x32_bf16 v[72:75], v[104:107], v[52:55], v[72:75]
    buffer_load_dwordx4 v1, s[24:27], s67 offen offset:2048 sc1 lds
    v_mfma_f32_16x16x32_bf16 v[84:87], v[112:115], v[52:55], v[84:87]
    buffer_load_dwordx4 v1, s[24:27], s67 offen offset:3072 sc1 lds
    s_waitcnt lgkmcnt(2)
    v_mfma_f32_16x16x32_bf16 v[76:79], v[124:127], v[28:31], v[76:79]
    ds_read_b128 v[108:111], v1 offset:11264
    v_add_f32 v136, v136, v137
    v_mfma_f32_16x16x32_bf16 v[88:91], v[132:135], v[28:31], v[88:91]
    ds_read_b128 v[116:119], v1 offset:25600
    v_mov_b32 v137, v136
    s_waitcnt lgkmcnt(2)
    v_mfma_f32_16x16x32_bf16 v[72:75], v[120:123], v[28:31], v[72:75]
    ds_read_b128 v[104:107], v1 offset:4096
    v_mfma_f32_16x16x32_bf16 v[84:87], v[128:131], v[28:31], v[84:87]
    ds_read_b128 v[112:115], v1 offset:18432
    v_permlane16_swap_b32 v136, v137
    v_mfma_f32_16x16x32_bf16 v[80:83], v[124:127], v[56:59], v[80:83]
    v_add_f32 v96, v136, v137
    v_mfma_f32_16x16x32_bf16 v[92:95], v[132:135], v[56:59], v[92:95]
    s_waitcnt vmcnt(6)
    v_max_u32 v149, v32, v60
    v_mfma_f32_16x16x32_bf16 v[72:75], v[120:123], v[56:59], v[72:75]
    v_max3_u32 v149, v149, v36, v64
    v_cmp_eq_u32 vcc, -1, v149
    v_mfma_f32_16x16x32_bf16 v[84:87], v[128:131], v[56:59], v[84:87]
    s_cbranch_vccnz slow_x2_4_49
ok_x2_4_50:
    s_waitcnt lgkmcnt(2)
    v_mfma_f32_16x16x32_bf16 v[76:79], v[108:111], v[32:35], v[76:79]
    ds_read_b128 v[124:127], v1 offset:12288
    v_mov_b32 v148, v96
    v_mfma_f32_16x16x32_bf16 v[88:91], v[116:119], v[32:35], v[88:91]
    ds_read_b128 v[132:135], v1 offset:26624
    s_waitcnt lgkmcnt(2)
    v_mfma_f32_16x16x32_bf16 v[72:75], v[104:107], v[32:35], v[72:75]
    ds_read_b128 v[120:123], v1 offset:5120
    v_permlane32_swap_b32 v96, v148
    v_mfma_f32_16x16x32_bf16 v[84:87], v[112:115], v[32:35], v[84:87]
    ds_read_b128 v[128:131], v1 offset:19456
    v_mul_f32 v98, 0xbb924925, v96
    v_mfma_f32_16x16x32_bf16 v[80:83], v[108:111], v[60:63], v[80:83]
    s_add_u32 m0, m0, 4096
    s_add_u32 s67, s67, 4096
    buffer_load_dwordx4 v1, s[24:27], s67 offen offset:0 sc1 lds
    v_mfma_f32_16x16x32_bf16 v[92:95], v[116:119], v[60:63], v[92:95]
    buffer_load_dwordx4 v1, s[24:27], s67 offen offset:1024 sc1 lds
    v_mfma_f32_16x16x32_bf16 v[72:75], v[104:107], v[60:63], v[72:75]
    buffer_load_dwordx4 v1, s[24:27], s67 offen offset:2048 sc1 lds
    v_mfma_f32_16x16x32_bf16 v[84:87], v[112:115], v[60:63], v[84:87]
    v_mul_f32 v96, 0x3b124925, v96
    s_waitcnt lgkmcnt(2)
    v_mfma_f32_16x16x32_bf16 v[76:79], v[124:127], v[36:39], v[76:79]
    ds_read_b128 v[108:111], v1 offset:13312
    v_mul_f32 v96, v96, v96
    v_mfma_f32_16x16x32_bf16 v[88:91], v[132:135], v[36:39], v[88:91]
    ds_read_b128 v[116:119], v1 offset:27648
    v_fmamk_f32 v148, v148, 0xbb124925, v96
    s_waitcnt lgkmcnt(2)
    v_mfma_f32_16x16x32_bf16 v[72:75], v[120:123], v[36:39], v[72:75]
    ds_read_b128 v[104:107], v1 offset:6144
    v_min_f32 v148, 0, v148
    v_mfma_f32_16x16x32_bf16 v[84:87], v[128:131], v[36:39], v[84:87]
    ds_read_b128 v[112:115], v1 offset:20480
    v_sub_f32 v148, 0x3727c5ac, v148
    v_mfma_f32_16x16x32_bf16 v[80:83], v[124:127], v[64:67], v[80:83]
    v_rsq_f32 v148, v148
    v_mfma_f32_16x16x32_bf16 v[92:95], v[132:135], v[64:67], v[92:95]
    v_mfma_f32_16x16x32_bf16 v[72:75], v[120:123], v[64:67], v[72:75]
    s_waitcnt vmcnt(7)
    v_max_u32 v149, v40, v68
    v_mfma_f32_16x16x32_bf16 v[84:87], v[128:131], v[64:67], v[84:87]
    v_cmp_eq_u32 vcc, -1, v149
    s_cbranch_vccnz slow_x2_6_51
ok_x2_6_52:
    s_waitcnt lgkmcnt(2)
    v_mfma_f32_16x16x32_bf16 v[76:79], v[108:111], v[40:43], v[76:79]
    v_mfma_f32_16x16x32_bf16 v[80:83], v[108:111], v[68:71], v[80:83]
    v_mfma_f32_16x16x32_bf16 v[88:91], v[116:119], v[40:43], v[88:91]
    v_mfma_f32_16x16x32_bf16 v[92:95], v[116:119], v[68:71], v[92:95]
    s_waitcnt lgkmcnt(0)
    v_mfma_f32_16x16x32_bf16 v[72:75], v[104:107], v[40:43], v[72:75]
    v_mfma_f32_16x16x32_bf16 v[72:75], v[104:107], v[68:71], v[72:75]
    s_nop 2
    v_sub_f32 v76, v76, v80
    v_sub_f32 v77, v77, v81
    v_sub_f32 v78, v78, v82
    v_mfma_f32_16x16x32_bf16 v[84:87], v[112:115], v[40:43], v[84:87]
    v_sub_f32 v79, v79, v83
    v_mul_f32 v76, v76, v148
    v_mul_f32 v77, v77, v148
    v_mfma_f32_16x16x32_bf16 v[84:87], v[112:115], v[68:71], v[84:87]
    v_mul_f32 v78, v78, v148
    v_mul_f32 v79, v79, v148
    v_cvt_pk_f16_f32 v76, v76, v77
    v_cvt_pk_f16_f32 v77, v78, v79
    ds_write_b64 v150, v[76:77] offset:2048
    v_pk_add_f32 v[88:89], v[88:89], v[92:93] neg_lo:[0,1] neg_hi:[0,1]
    v_pk_add_f32 v[90:91], v[90:91], v[94:95] neg_lo:[0,1] neg_hi:[0,1]
    v_pk_mul_f32 v[88:89], v[88:89], v[148:149] op_sel_hi:[1,0]
    v_pk_mul_f32 v[90:91], v[90:91], v[148:149] op_sel_hi:[1,0]
    v_cvt_pk_f16_f32 v88, v88, v89
    v_cvt_pk_f16_f32 v89, v90, v91
    ds_write_b64 v150, v[88:89] offset:6144
    v_pk_fma_f32 v[72:73], v[100:101], v[98:99], v[72:73] op_sel_hi:[1,0,1]
    v_pk_fma_f32 v[74:75], v[102:103], v[98:99], v[74:75] op_sel_hi:[1,0,1]
    v_pk_mul_f32 v[72:73], v[72:73], v[148:149] op_sel_hi:[1,0]
    v_pk_mul_f32 v[74:75], v[74:75], v[148:149] op_sel_hi:[1,0]
    v_cvt_pk_f16_f32 v72, v72, v73
    v_cvt_pk_f16_f32 v73, v74, v75
    ds_write_b64 v150, v[72:73] offset:0
    v_pk_mul_f32 v[84:85], v[84:85], v[148:149] op_sel_hi:[1,0]
    v_pk_mul_f32 v[86:87], v[86:87], v[148:149] op_sel_hi:[1,0]
    v_cvt_pk_f16_f32 v84, v84, v85
    v_cvt_pk_f16_f32 v85, v86, v87
    ds_write_b64 v150, v[84:85] offset:4096
    s_waitcnt lgkmcnt(0)
    s_barrier
    ds_read_b64_tr_b16 v[72:73], v14 offset:0
    ds_read_b64_tr_b16 v[74:75], v14 offset:512
    ds_read_b64_tr_b16 v[88:89], v14 offset:4096
    ds_read_b64_tr_b16 v[90:91], v14 offset:4608
    ds_read_b64_tr_b16 v[76:77], v14 offset:1024
    ds_read_b64_tr_b16 v[78:79], v14 offset:1536
    ds_read_b64_tr_b16 v[92:93], v14 offset:5120
    ds_read_b64_tr_b16 v[94:95], v14 offset:5632
    ds_read_b64_tr_b16 v[80:81], v14 offset:2048
    ds_read_b64_tr_b16 v[82:83], v14 offset:2560
    ds_read_b64_tr_b16 v[96:97], v14 offset:6144
    ds_read_b64_tr_b16 v[98:99], v14 offset:6656
    ds_read_b64_tr_b16 v[84:85], v14 offset:3072
    ds_read_b64_tr_b16 v[86:87], v14 offset:3584
    ds_read_b64_tr_b16 v[100:101], v14 offset:7168
    ds_read_b64_tr_b16 v[102:103], v14 offset:7680
    s_waitcnt lgkmcnt(14)
    v_mfma_f32_16x16x32_f16 v[104:107], v[140:143], v[72:75], 0
    s_waitcnt lgkmcnt(12)
    v_mfma_f32_16x16x32_f16 v[112:115], v[140:143], v[88:91], 0
    s_waitcnt lgkmcnt(10)
    v_mfma_f32_16x16x32_f16 v[104:107], v[144:147], v[76:79], v[104:107]
    s_waitcnt lgkmcnt(8)
    v_mfma_f32_16x16x32_f16 v[112:115], v[144:147], v[92:95], v[112:115]
    s_waitcnt lgkmcnt(6)
    v_mfma_f32_16x16x32_f16 v[108:111], v[140:143], v[80:83], 0
    s_waitcnt lgkmcnt(4)
    v_mfma_f32_16x16x32_f16 v[116:119], v[140:143], v[96:99], 0
    s_waitcnt lgkmcnt(2)
    v_mfma_f32_16x16x32_f16 v[108:111], v[144:147], v[84:87], v[108:111]
    s_waitcnt lgkmcnt(0)
    v_mfma_f32_16x16x32_f16 v[116:119], v[144:147], v[100:103], v[116:119]
    v_fma_f32 v120, v151, v113, v104
    v_fma_f32 v121, v151, v105, -v112
    v_fma_f32 v122, -v151, v104, v113
    v_fma_f32 v123, v151, v112, v105
    v_cvt_pk_f16_f32 v72, v120, v121
    v_cvt_pk_f16_f32 v73, v122, v123
    v_fma_f32 v128, -1.0, v115, v106
    v_fma_f32 v129, -1.0, v107, -v114
    v_fma_f32 v130, 1.0, v106, v115
    v_fma_f32 v131, -1.0, v114, v107
    v_cvt_pk_f16_f32 v76, v128, v129
    v_cvt_pk_f16_f32 v77, v130, v131
    v_fma_f32 v124, v151, v117, v108
    v_fma_f32 v125, v151, v109, -v116
    v_fma_f32 v126, -v151, v108, v117
    v_fma_f32 v127, v151, v116, v109
    v_cvt_pk_f16_f32 v74, v124, v125
    v_cvt_pk_f16_f32 v75, v126, v127
    buffer_store_dwordx4 v[72:75], v15, s[24:27], s46 offen sc1
    v_fma_f32 v132, -1.0, v119, v110
    v_fma_f32 v133, -1.0, v111, -v118
    v_fma_f32 v134, 1.0, v110, v119
    v_fma_f32 v135, -1.0, v118, v111
    v_cvt_pk_f16_f32 v78, v132, v133
    v_cvt_pk_f16_f32 v79, v134, v135
    buffer_store_dwordx4 v[76:79], v15, s[24:27], s47 offen sc1
    s_cmp_lt_u32 s32, 2
    s_cbranch_scc1 L_t0_1
    s_mov_b64 exec, 0
    s_cmp_eq_u32 s32, 2
    s_cbranch_scc1 L_pad9
    s_branch L_pad10
L_t0_1:
    s_mul_i32 s42, s32, 14336
    v_add_u32 v88, s42, v1
    s_mul_i32 s42, s33, 2048
    v_add_u32 v89, s42, v88
    ds_write_b128 v89, v[16:19] offset:0
    ds_write_b128 v89, v[20:23] offset:1024
    s_add_u32 s42, s42, 2048
    s_sub_u32 s43, s42, 14336
    s_min_u32 s42, s42, s43
    v_add_u32 v89, s42, v88
    ds_write_b128 v89, v[24:27] offset:0
    ds_write_b128 v89, v[28:31] offset:1024
    s_add_u32 s42, s42, 2048
    s_sub_u32 s43, s42, 14336
    s_min_u32 s42, s42, s43
    v_add_u32 v89, s42, v88
    ds_write_b128 v89, v[32:35] offset:0
    ds_write_b128 v89, v[36:39] offset:1024
    s_add_u32 s42, s42, 2048
    s_sub_u32 s43, s42, 14336
    s_min_u32 s42, s42, s43
    v_add_u32 v89, s42, v88
    ds_write_b128 v89, v[40:43] offset:0
    ds_write_b128 v89, v[44:47] offset:1024
    s_add_u32 s42, s42, 2048
    s_sub_u32 s43, s42, 14336
    s_min_u32 s42, s42, s43
    v_add_u32 v89, s42, v88
    ds_write_b128 v89, v[48:51] offset:0
    ds_write_b128 v89, v[52:55] offset:1024
    s_add_u32 s42, s42, 2048
    s_sub_u32 s43, s42, 14336
    s_min_u32 s42, s42, s43
    v_add_u32 v89, s42, v88
    ds_write_b128 v89, v[56:59] offset:0
    ds_write_b128 v89, v[60:63] offset:1024
    s_add_u32 s42, s42, 2048
    s_sub_u32 s43, s42, 14336
    s_min_u32 s42, s42, s43
    v_add_u32 v89, s42, v88
    ds_write_b128 v89, v[64:67] offset:0
    ds_write_b128 v89, v[68:71] offset:1024
L_ret2:
    s_mov_b64 exec, -1
    v_bfe_u32 v88, v0, 2, 1
    v_bfe_u32 v89, v0, 3, 2
    v_and_b32 v90, 3, v0
    v_lshl_add_u32 v89, v88, 2, v89
    v_lshl_add_u32 v89, v89, 2, v90
    s_mul_i32 s44, s32, 448
    v_lshl_add_u32 v89, v89, 4, s44
    v_subrev_u32 v88, 1792, v89
    v_min_u32 v89, v88, v89
    v_lshrrev_b32 v90, 5, v0
    v_mul_u32_u24 v88, 1792, v90
    v_add_u32 v12, v88, v89
    v_add_u32 v6, 7168, v12
    s_mul_i32 s42, s34, 57344
    s_add_u32 s42, s42, 1835008
    s_add_u32 s43, s33, 0
    s_and_b32 s43, s43, 3
    s_mul_i32 s43, s43, 14336
    s_add_u32 s4, s42, s43
    s_add_u32 s43, s33, 1
    s_and_b32 s43, s43, 3
    s_mul_i32 s43, s43, 14336
    s_add_u32 s5, s42, s43
    s_add_u32 s43, s33, 2
    s_and_b32 s43, s43, 3
    s_mul_i32 s43, s43, 14336
    s_add_u32 s6, s42, s43
    s_add_u32 s43, s33, 3
    s_and_b32 s43, s43, 3
    s_mul_i32 s43, s43, 14336
    s_add_u32 s7, s42, s43
    s_waitcnt vmcnt(0)
    buffer_load_dwordx4 v[16:19], v12, s[24:27], s4 offen offset:0 sc1
    buffer_load_dwordx4 v[20:23], v12, s[24:27], s4 offen offset:3584 sc1
    buffer_load_dwordx4 v[24:27], v6, s[24:27], s4 offen offset:0 sc1
    buffer_load_dwordx4 v[28:31], v6, s[24:27], s4 offen offset:3584 sc1
    buffer_load_dwordx4 v[32:35], v12, s[24:27], s5 offen offset:0 sc1
    v_and_b32 v91, 31, v0
    s_mul_i32 s42, s32, 7
    v_lshl_add_u32 v92, v90, 2, s42
    v_lshrrev_b32 v88, 4, v91
    v_mul_u32_u24 v88, 14336, v88
    v_and_b32 v13, 15, v91
    v_lshl_add_u32 v13, v13, 4, v88
    v_mul_u32_u24 v89, 256, v92
    v_add_u32 v13, v13, v89
    v_sub_u32 v92, 13312, v89
    s_cmp_eq_u32 s34, 0
    s_cselect_b32 s42, 32, 63
    s_cselect_b32 s43, 31, 63
    s_cselect_b32 s44, 63, 31
    buffer_load_dwordx4 v[36:39], v12, s[24:27], s5 offen offset:3584 sc1
    v_sub_u32 v93, s42, v91
    v_and_b32 v93, s43, v93
    v_lshrrev_b32 v88, 4, v93
    v_mul_u32_u24 v88, 14336, v88
    v_and_b32 v14, 15, v93
    v_lshl_add_u32 v14, v14, 4, v88
    v_add_u32 v14, v14, v92
    v_sub_u32 v93, s44, v91
    v_lshrrev_b32 v88, 4, v93
    v_mul_u32_u24 v88, 14336, v88
    v_and_b32 v15, 15, v93
    v_lshl_add_u32 v15, v15, 4, v88
    v_add_u32 v15, v15, v92
    s_cmp_eq_u32 s32, 0
    s_cselect_b32 s52, 0, -1
    buffer_load_dwordx4 v[40:43], v6, s[24:27], s5 offen offset:0 sc1
    s_mov_b32 s53, -1
    v_add_u32 v7, 65536, v1
    s_mul_i32 s42, s32, 1792
    v_mul_u32_u24 v90, 768, v90
    v_subrev_u32 v9, s42, v13
    v_sub_u32 v9, v9, v90
    s_mul_i32 s42, s32, 7168
    v_add_u32 v88, s42, v1
    ds_read_b32 v90, v88 offset:28672
    ds_read_b32 v91, v88 offset:29696
    ds_read_b32 v92, v88 offset:30720
    ds_read_b32 v93, v88 offset:31744
    buffer_load_dwordx4 v[44:47], v6, s[24:27], s5 offen offset:3584 sc1
    ds_read_b32 v94, v88 offset:32768
    ds_read_b32 v95, v88 offset:33792
    ds_read_b32 v96, v88 offset:34816
    s_waitcnt lgkmcnt(0)
    v_max3_u32 v90, v90, v91, v92
    v_max3_u32 v90, v90, v93, v94
    v_max3_u32 v90, v90, v95, v96
    v_cmp_eq_u32 vcc, -1, v90
    buffer_load_dwordx4 v[48:51], v12, s[24:27], s6 offen offset:0 sc1
    buffer_load_dwordx4 v[52:55], v12, s[24:27], s6 offen offset:3584 sc1
    buffer_load_dwordx4 v[56:59], v6, s[24:27], s6 offen offset:0 sc1
    s_cbranch_vccnz slow_img_53
ok_img_54:
    s_barrier
    ds_read_b128 v[144:147], v7 offset:0
    ds_read_b128 v[148:151], v7 offset:4096
    s_waitcnt vmcnt(10)
    buffer_load_dwordx4 v[60:63], v6, s[24:27], s6 offen offset:3584 sc1
    v_mov_b32 v8, v16
    s_waitcnt vmcnt(10)
    buffer_load_dwordx4 v[64:67], v12, s[24:27], s7 offen offset:0 sc1
    v_max_u32 v8, v8, v20
    v_swap_b32 v17, v20
    s_waitcnt vmcnt(10)
    buffer_load_dwordx4 v[68:71], v12, s[24:27], s7 offen offset:3584 sc1
    v_max_u32 v8, v8, v24
    v_swap_b32 v18, v24
    v_swap_b32 v22, v25
    s_waitcnt vmcnt(10)
    buffer_load_dwordx4 v[72:75], v6, s[24:27], s7 offen offset:0 sc1
    buffer_load_dwordx4 v[76:79], v6, s[24:27], s7 offen offset:3584 sc1
L_pad6:
    s_cbranch_execz L_pad8
    v_max_u32 v8, v8, v28
    v_cmp_eq_u32 vcc, -1, v8
    v_swap_b32 v19, v28
    s_cbranch_vccnz slow_U1_0_55
ok_U1_0_56:
    s_waitcnt lgkmcnt(1)
    v_mfma_f32_32x32x16_f16 v[80:95], v[16:19], v[144:147], 0
    v_swap_b32 v27, v30
    v_swap_b32 v23, v29
    s_waitcnt lgkmcnt(0)
    v_mfma_f32_32x32x16_f16 v[96:111], v[24:27], v[144:147], 0
    ds_read_b128 v[144:147], v7 offset:1024
    s_waitcnt vmcnt(11)
    v_mov_b32 v8, v32
    v_mfma_f32_32x32x16_f16 v[112:127], v[20:23], v[148:151], 0
    s_waitcnt vmcnt(10)
    v_max_u32 v8, v8, v36
    v_swap_b32 v33, v36
    v_mfma_f32_32x32x16_f16 v[128:143], v[28:31], v[148:151], 0
    ds_read_b128 v[148:151], v7 offset:5120
    s_waitcnt vmcnt(9)
    v_max_u32 v8, v8, v40
    v_swap_b32 v34, v40
    v_swap_b32 v38, v41
    s_waitcnt vmcnt(8)
    v_max_u32 v8, v8, v44
    v_cmp_eq_u32 vcc, -1, v8
    v_swap_b32 v35, v44
    s_cbranch_vccnz slow_U1_1_60
ok_U1_1_61:
    s_waitcnt lgkmcnt(1)
    v_mfma_f32_32x32x16_f16 v[80:95], v[32:35], v[144:147], v[80:95]
    v_swap_b32 v43, v46
    v_swap_b32 v39, v45
    s_waitcnt lgkmcnt(0)
    v_mfma_f32_32x32x16_f16 v[96:111], v[40:43], v[144:147], v[96:111]
    ds_read_b128 v[144:147], v7 offset:2048
    ds_read_b128 v[16:19], v13 offset:0
    ds_read_b128 v[20:23], v14 offset:768
    s_waitcnt vmcnt(7)
    v_mov_b32 v8, v48
    v_mfma_f32_32x32x16_f16 v[112:127], v[36:39], v[148:151], v[112:127]
    ds_read_b128 v[24:27], v13 offset:256
    ds_read_b128 v[28:31], v14 offset:512
    s_waitcnt vmcnt(6)
    v_max_u32 v8, v8, v52
    v_swap_b32 v49, v52
    v_mfma_f32_32x32x16_f16 v[128:143], v[44:47], v[148:151], v[128:143]
    ds_read_b128 v[148:151], v7 offset:6144
    s_waitcnt vmcnt(5)
    v_max_u32 v8, v8, v56
    v_swap_b32 v50, v56
    v_swap_b32 v54, v57
    s_waitcnt vmcnt(4)
    v_max_u32 v8, v8, v60
    v_cmp_eq_u32 vcc, -1, v8
    v_swap_b32 v51, v60
    s_cbranch_vccnz slow_U1_2_64
ok_U1_2_65:
    s_waitcnt lgkmcnt(5)
    v_mfma_f32_32x32x16_f16 v[80:95], v[48:51], v[144:147], v[80:95]
    v_swap_b32 v59, v62
    v_swap_b32 v55, v61
    s_waitcnt lgkmcnt(0)
    v_mfma_f32_32x32x16_f16 v[96:111], v[56:59], v[144:147], v[96:111]
    ds_read_b128 v[144:147], v7 offset:3072
    ds_read_b128 v[32:35], v13 offset:512
    ds_read_b128 v[36:39], v14 offset:256
    s_waitcnt vmcnt(3)
    v_mov_b32 v8, v64
    v_mfma_f32_32x32x16_f16 v[112:127], v[52:55], v[148:151], v[112:127]
    v_mov_b32 v40, v13
    v_mov_b32 v41, v14
    s_mov_b32 exec_lo, 0
    v_add_u32 v40, 27648, v13
    v_add_u32 v41, 1024, v15
    s_mov_b32 exec_lo, -1
    s_waitcnt vmcnt(2)
    v_max_u32 v8, v8, v68
    v_swap_b32 v65, v68
    v_mfma_f32_32x32x16_f16 v[128:143], v[60:63], v[148:151], v[128:143]
    ds_read_b128 v[148:151], v7 offset:7168
    s_waitcnt vmcnt(1)
    v_max_u32 v8, v8, v72
    v_swap_b32 v66, v72
    v_swap_b32 v70, v73
    s_waitcnt vmcnt(0)
    v_max_u32 v8, v8, v76
    v_cmp_eq_u32 vcc, -1, v8
    v_swap_b32 v67, v76
    s_cbranch_vccnz slow_U1_3_67
ok_U1_3_68:
    s_waitcnt lgkmcnt(3)
    v_mfma_f32_32x32x16_f16 v[80:95], v[64:67], v[144:147], v[80:95]
    v_swap_b32 v75, v78
    v_swap_b32 v71, v77
    s_waitcnt lgkmcnt(0)
    v_mfma_f32_32x32x16_f16 v[96:111], v[72:75], v[144:147], v[96:111]
    ds_read_b128 v[48:51], v13 offset:28672
    ds_read_b128 v[52:55], v15 offset:768
    v_mfma_f32_32x32x16_f16 v[112:127], v[68:71], v[148:151], v[112:127]
    ds_read_b128 v[56:59], v13 offset:28928
    ds_read_b128 v[60:63], v15 offset:512
    v_mfma_f32_32x32x16_f16 v[128:143], v[76:79], v[148:151], v[128:143]
    ds_read_b128 v[64:67], v13 offset:29184
    ds_read_b128 v[68:71], v15 offset:256
    ds_read_b128 v[72:75], v40 offset:768
    ds_read_b128 v[76:79], v41 offset:0
    v_lshrrev_b32 v7, 3, v0
    v_lshl_add_u32 v7, s32, 3, v7
    v_lshrrev_b32 v8, 4, v7
    v_mul_u32_u24 v8, 14336, v8
    v_and_b32 v6, 15, v7
    v_lshl_add_u32 v6, v6, 4, v8
    v_and_b32 v8, 7, v0
    v_lshl_add_u32 v6, v8, 8, v6
    v_lshlrev_b32 v7, 3, v7
    s_lshl_b32 s42, s32, 3
    v_mov_b32 v12, v80
    v_cndmask_b32 v80, 0, v80, s[52:53]
    v_dot2_f32_bf16 v144, v16, s39, v80
    v_dot2_f32_bf16 v145, v16, s40, v96
    v_dot2_f32_bf16 v146, v17, s39, v81
    v_dot2_f32_bf16 v147, v17, s40, v97
    v_dot2_f32_bf16 v148, v18, s39, v82
    v_dot2_f32_bf16 v149, v18, s40, v98
    v_dot2_f32_bf16 v150, v19, s39, v83
    v_dot2_f32_bf16 v151, v19, s40, v99
    v_dot2_f32_bf16 v80, v20, s39, v84
    v_cvt_pk_bf16_f32 v16, v144, v145
    v_cvt_pk_bf16_f32 v17, v146, v147
    v_cvt_pk_bf16_f32 v18, v148, v149
    v_cvt_pk_bf16_f32 v19, v150, v151
    ds_write_b128 v13, v[16:19] offset:0
    v_dot2c_f32_bf16 v99, s40, v20
    v_dot2c_f32_bf16 v83, s39, v21
    v_dot2c_f32_bf16 v98, s40, v21
    v_dot2c_f32_bf16 v82, s39, v22
    v_dot2c_f32_bf16 v97, s40, v22
    v_dot2c_f32_bf16 v81, s39, v23
    v_dot2c_f32_bf16 v96, s40, v23
    v_cvt_pk_bf16_f32 v20, v80, v99
    v_cvt_pk_bf16_f32 v21, v83, v98
    v_cvt_pk_bf16_f32 v22, v82, v97
    v_cvt_pk_bf16_f32 v23, v81, v96
    ds_write_b128 v14, v[20:23] offset:768
    v_dot2_f32_bf16 v144, v24, s39, v84
    v_dot2_f32_bf16 v145, v24, s40, v100
    v_dot2_f32_bf16 v146, v25, s39, v85
    v_dot2_f32_bf16 v147, v25, s40, v101
    v_dot2_f32_bf16 v148, v26, s39, v86
    v_dot2_f32_bf16 v149, v26, s40, v102
    v_dot2_f32_bf16 v150, v27, s39, v87
    v_dot2_f32_bf16 v151, v27, s40, v103
    v_dot2_f32_bf16 v84, v28, s39, v88
    v_cvt_pk_bf16_f32 v24, v144, v145
    v_cvt_pk_bf16_f32 v25, v146, v147
    v_cvt_pk_bf16_f32 v26, v148, v149
    v_cvt_pk_bf16_f32 v27, v150, v151
    ds_write_b128 v13, v[24:27] offset:256
    v_dot2c_f32_bf16 v103, s40, v28
    v_dot2c_f32_bf16 v87, s39, v29
    v_dot2c_f32_bf16 v102, s40, v29
    v_dot2c_f32_bf16 v86, s39, v30
    v_dot2c_f32_bf16 v101, s40, v30
    v_dot2c_f32_bf16 v85, s39, v31
    v_dot2c_f32_bf16 v100, s40, v31
    v_cvt_pk_bf16_f32 v28, v84, v103
    v_cvt_pk_bf16_f32 v29, v87, v102
    v_cvt_pk_bf16_f32 v30, v86, v101
    v_cvt_pk_bf16_f32 v31, v85, v100
    ds_write_b128 v14, v[28:31] offset:512
    v_dot2_f32_bf16 v144, v32, s39, v88
    v_dot2_f32_bf16 v145, v32, s40, v104
    v_dot2_f32_bf16 v146, v33, s39, v89
    v_dot2_f32_bf16 v147, v33, s40, v105
    v_dot2_f32_bf16 v148, v34, s39, v90
    v_dot2_f32_bf16 v149, v34, s40, v106
    v_dot2_f32_bf16 v150, v35, s39, v91
    v_dot2_f32_bf16 v151, v35, s40, v107
    v_dot2_f32_bf16 v88, v36, s39, v92
    v_cvt_pk_bf16_f32 v32, v144, v145
    v_cvt_pk_bf16_f32 v33, v146, v147
    v_cvt_pk_bf16_f32 v34, v148, v149
    v_cvt_pk_bf16_f32 v35, v150, v151
    ds_write_b128 v13, v[32:35] offset:512
    v_dot2c_f32_bf16 v107, s40, v36
    v_dot2c_f32_bf16 v91, s39, v37
    v_dot2c_f32_bf16 v106, s40, v37
    v_dot2c_f32_bf16 v90, s39, v38
    v_dot2c_f32_bf16 v105, s40, v38
    v_dot2c_f32_bf16 v89, s39, v39
    v_dot2c_f32_bf16 v104, s40, v39
    v_cvt_pk_bf16_f32 v36, v88, v107
    v_cvt_pk_bf16_f32 v37, v91, v106
    v_cvt_pk_bf16_f32 v38, v90, v105
    v_cvt_pk_bf16_f32 v39, v89, v104
    ds_write_b128 v14, v[36:39] offset:256
    v_mov_b32 v8, v112
    v_cndmask_b32 v112, 0, v112, s[52:53]
    s_waitcnt lgkmcnt(12)
    v_dot2_f32_bf16 v144, v48, s39, v112
    v_dot2_f32_bf16 v145, v48, s40, v128
    v_dot2_f32_bf16 v146, v49, s39, v113
    v_dot2_f32_bf16 v147, v49, s40, v129
    v_dot2_f32_bf16 v148, v50, s39, v114
    v_dot2_f32_bf16 v149, v50, s40, v130
    v_dot2_f32_bf16 v150, v51, s39, v115
    v_dot2_f32_bf16 v151, v51, s40, v131
    v_dot2_f32_bf16 v112, v52, s39, v116
    v_cvt_pk_bf16_f32 v48, v144, v145
    v_cvt_pk_bf16_f32 v49, v146, v147
    v_cvt_pk_bf16_f32 v50, v148, v149
    v_cvt_pk_bf16_f32 v51, v150, v151
    ds_write_b128 v13, v[48:51] offset:28672
    v_dot2c_f32_bf16 v131, s40, v52
    v_dot2c_f32_bf16 v115, s39, v53
    v_dot2c_f32_bf16 v130, s40, v53
    v_dot2c_f32_bf16 v114, s39, v54
    v_dot2c_f32_bf16 v129, s40, v54
    v_dot2c_f32_bf16 v113, s39, v55
    v_dot2c_f32_bf16 v128, s40, v55
    v_permlane32_swap_b32 v12, v8
    v_cvt_pk_bf16_f32 v52, v112, v131
    v_cvt_pk_bf16_f32 v53, v115, v130
    v_cvt_pk_bf16_f32 v54, v114, v129
    v_cvt_pk_bf16_f32 v55, v113, v128
    ds_write_b128 v15, v[52:55] offset:768
    s_waitcnt lgkmcnt(12)
    v_dot2_f32_bf16 v144, v56, s39, v116
    v_dot2_f32_bf16 v145, v56, s40, v132
    v_dot2_f32_bf16 v146, v57, s39, v117
    v_dot2_f32_bf16 v147, v57, s40, v133
    v_dot2_f32_bf16 v148, v58, s39, v118
    v_dot2_f32_bf16 v149, v58, s40, v134
    v_dot2_f32_bf16 v150, v59, s39, v119
    v_dot2_f32_bf16 v151, v59, s40, v135
    v_dot2_f32_bf16 v116, v60, s39, v120
    v_cvt_pk_bf16_f32 v56, v144, v145
    v_cvt_pk_bf16_f32 v57, v146, v147
    v_cvt_pk_bf16_f32 v58, v148, v149
    v_cvt_pk_bf16_f32 v59, v150, v151
    ds_write_b128 v13, v[56:59] offset:28928
    v_dot2c_f32_bf16 v135, s40, v60
    v_dot2c_f32_bf16 v119, s39, v61
    v_dot2c_f32_bf16 v134, s40, v61
    v_dot2c_f32_bf16 v118, s39, v62
    v_dot2c_f32_bf16 v133, s40, v62
    v_dot2c_f32_bf16 v117, s39, v63
    v_dot2c_f32_bf16 v132, s40, v63
    v_cvt_pk_bf16_f32 v60, v116, v135
    v_cvt_pk_bf16_f32 v61, v119, v134
    v_cvt_pk_bf16_f32 v62, v118, v133
    v_cvt_pk_bf16_f32 v63, v117, v132
    ds_write_b128 v15, v[60:63] offset:512
    s_waitcnt lgkmcnt(12)
    v_dot2_f32_bf16 v144, v64, s39, v120
    v_dot2_f32_bf16 v145, v64, s40, v136
    v_dot2_f32_bf16 v146, v65, s39, v121
    v_dot2_f32_bf16 v147, v65, s40, v137
    v_dot2_f32_bf16 v148, v66, s39, v122
    v_dot2_f32_bf16 v149, v66, s40, v138
    v_dot2_f32_bf16 v150, v67, s39, v123
    v_dot2_f32_bf16 v151, v67, s40, v139
    v_dot2_f32_bf16 v120, v68, s39, v124
    v_cvt_pk_bf16_f32 v64, v144, v145
    v_cvt_pk_bf16_f32 v65, v146, v147
    v_cvt_pk_bf16_f32 v66, v148, v149
    v_cvt_pk_bf16_f32 v67, v150, v151
    ds_write_b128 v13, v[64:67] offset:29184
    v_dot2c_f32_bf16 v139, s40, v68
    v_dot2c_f32_bf16 v123, s39, v69
    v_dot2c_f32_bf16 v138, s40, v69
    v_dot2c_f32_bf16 v122, s39, v70
    v_dot2c_f32_bf16 v137, s40, v70
    v_dot2c_f32_bf16 v121, s39, v71
    v_dot2c_f32_bf16 v136, s40, v71
    v_cvt_pk_bf16_f32 v68, v120, v139
    v_cvt_pk_bf16_f32 v69, v123, v138
    v_cvt_pk_bf16_f32 v70, v122, v137
    v_cvt_pk_bf16_f32 v71, v121, v136
    ds_write_b128 v15, v[68:71] offset:256
    s_waitcnt lgkmcnt(12)
    v_permlane32_swap_b32 v92, v124
    v_permlane32_swap_b32 v108, v140
    v_permlane32_swap_b32 v93, v125
    v_permlane32_swap_b32 v109, v141
    v_permlane32_swap_b32 v94, v126
    v_permlane32_swap_b32 v110, v142
    v_permlane32_swap_b32 v95, v127
    v_permlane32_swap_b32 v111, v143
    v_dot2_f32_bf16 v144, v72, s39, v92
    v_dot2_f32_bf16 v145, v72, s40, v108
    v_dot2_f32_bf16 v146, v73, s39, v93
    v_dot2_f32_bf16 v147, v73, s40, v109
    v_dot2_f32_bf16 v148, v74, s39, v94
    v_dot2_f32_bf16 v149, v74, s40, v110
    v_dot2_f32_bf16 v150, v75, s39, v95
    v_dot2_f32_bf16 v151, v75, s40, v111
    v_dot2_f32_bf16 v92, v76, s39, v8
    v_cvt_pk_bf16_f32 v72, v144, v145
    v_cvt_pk_bf16_f32 v73, v146, v147
    v_cvt_pk_bf16_f32 v74, v148, v149
    v_cvt_pk_bf16_f32 v75, v150, v151
    ds_write_b128 v40, v[72:75] offset:768
    v_dot2c_f32_bf16 v111, s40, v76
    v_dot2c_f32_bf16 v95, s39, v77
    v_dot2c_f32_bf16 v110, s40, v77
    v_dot2c_f32_bf16 v94, s39, v78
    v_dot2c_f32_bf16 v109, s40, v78
    v_dot2c_f32_bf16 v93, s39, v79
    v_dot2c_f32_bf16 v108, s40, v79
    v_cvt_pk_bf16_f32 v76, v92, v111
    v_cvt_pk_bf16_f32 v77, v95, v110
    v_cvt_pk_bf16_f32 v78, v94, v109
    v_cvt_pk_bf16_f32 v79, v93, v108
    ds_write_b128 v41, v[76:79] offset:0
    v_mov_b32 v12, v9
    v_mov_b32 v13, v6
    v_mov_b32 v15, v7
    s_waitcnt lgkmcnt(0)
    s_barrier
    ds_read_b128 v[96:99], v12 offset:0
    ds_read_b128 v[100:103], v12 offset:512
    s_waitcnt lgkmcnt(1)
    v_mfma_f32_32x32x16_bf16 v[16:31], a[0:3], v[96:99], 0
    ds_read_b128 v[104:107], v12 offset:1024
    ds_read_b128 v[112:115], v13 offset:0
    s_mul_i32 s43, s33, 2048
    v_add_u32 v80, s43, v13
    v_and_b32 v14, 31, v0
    v_mfma_f32_32x32x16_bf16 v[32:47], a[4:7], v[96:99], 0
    v_lshlrev_b32 v14, 3, v14
    s_mov_b32 s52, -1
    s_mov_b32 s53, 0
    s_mov_b32 s54, 0x80008000
    ds_read_b128 v[116:119], v13 offset:2048
    s_waitcnt lgkmcnt(1)
    v_mfma_f32_32x32x16_bf16 v[16:31], a[8:11], v[100:103], v[16:31]
    ds_read_b128 v[96:99], v12 offset:1536
    v_lshlrev_b32 v122, 16, v112
    v_and_b32 v124, s69, v112
    v_add_f32 v120, v122, v124
    v_mul_f32 v121, v122, v122
    v_mfma_f32_32x32x16_bf16 v[32:47], a[12:15], v[100:103], v[32:47]
    v_fmac_f32 v121, v124, v124
    v_lshlrev_b32 v123, 16, v113
    v_and_b32 v125, s69, v113
    v_add_f32 v120, v120, v123
    v_fmac_f32 v121, v123, v123
    v_mfma_f32_32x32x16_bf16 v[16:31], a[16:19], v[104:107], v[16:31]
    ds_read_b128 v[100:103], v12 offset:2048
    v_add_f32 v120, v120, v125
    v_fmac_f32 v121, v125, v125
    v_lshlrev_b32 v122, 16, v114
    v_and_b32 v124, s69, v114
    v_mfma_f32_32x32x16_bf16 v[32:47], a[20:23], v[104:107], v[32:47]
    ds_read_b128 v[144:147], v80 offset:0
    v_add_f32 v120, v120, v122
    v_fmac_f32 v121, v122, v122
    v_add_f32 v120, v120, v124
    v_fmac_f32 v121, v124, v124
    s_waitcnt lgkmcnt(2)
    v_mfma_f32_32x32x16_bf16 v[16:31], a[24:27], v[96:99], v[16:31]
    ds_read_b128 v[104:107], v12 offset:2560
    v_lshlrev_b32 v123, 16, v115
    v_and_b32 v125, s69, v115
    v_add_f32 v120, v120, v123
    v_fmac_f32 v121, v123, v123
    v_mfma_f32_32x32x16_bf16 v[32:47], a[28:31], v[96:99], v[32:47]
    ds_read_b128 v[112:115], v13 offset:4096
    v_add_f32 v120, v120, v125
    v_fmac_f32 v121, v125, v125
    v_lshlrev_b32 v122, 16, v116
    v_and_b32 v124, s69, v116
    s_waitcnt lgkmcnt(3)
    v_mfma_f32_32x32x16_bf16 v[16:31], a[32:35], v[100:103], v[16:31]
    ds_read_b128 v[96:99], v12 offset:3072
    v_add_f32 v120, v120, v122
    v_fmac_f32 v121, v122, v122
    v_add_f32 v120, v120, v124
    v_fmac_f32 v121, v124, v124
    v_mfma_f32_32x32x16_bf16 v[32:47], a[36:39], v[100:103], v[32:47]
    v_lshlrev_b32 v123, 16, v117
    v_and_b32 v125, s69, v117
    v_add_f32 v120, v120, v123
    v_fmac_f32 v121, v123, v123
    v_add_f32 v120, v120, v125
    s_waitcnt lgkmcnt(2)
    v_mfma_f32_32x32x16_bf16 v[16:31], a[40:43], v[104:107], v[16:31]
    ds_read_b128 v[100:103], v12 offset:3584
    v_fmac_f32 v121, v125, v125
    v_lshlrev_b32 v122, 16, v118
    v_and_b32 v124, s69, v118
    v_add_f32 v120, v120, v122
    v_mfma_f32_32x32x16_bf16 v[32:47], a[44:47], v[104:107], v[32:47]
    ds_read_b128 v[148:151], v80 offset:28672
    v_fmac_f32 v121, v122, v122
    v_add_f32 v120, v120, v124
    v_fmac_f32 v121, v124, v124
    v_lshlrev_b32 v123, 16, v119
    s_waitcnt lgkmcnt(2)
    v_mfma_f32_32x32x16_bf16 v[16:31], a[48:51], v[96:99], v[16:31]
    ds_read_b128 v[104:107], v12 offset:4096
    v_and_b32 v125, s69, v119
    v_add_f32 v120, v120, v123
    v_fmac_f32 v121, v123, v123
    v_add_f32 v120, v120, v125
    v_mfma_f32_32x32x16_bf16 v[32:47], a[52:55], v[96:99], v[32:47]
    ds_read_b128 v[116:119], v13 offset:6144
    v_fmac_f32 v121, v125, v125
    v_lshlrev_b32 v122, 16, v112
    v_and_b32 v124, s69, v112
    v_add_f32 v120, v120, v122
    s_waitcnt lgkmcnt(3)
    v_mfma_f32_32x32x16_bf16 v[16:31], a[56:59], v[100:103], v[16:31]
    ds_read_b128 v[96:99], v12 offset:4608
    v_fmac_f32 v121, v122, v122
    v_add_f32 v120, v120, v124
    v_fmac_f32 v121, v124, v124
    v_lshlrev_b32 v123, 16, v113
    v_mfma_f32_32x32x16_bf16 v[32:47], a[60:63], v[100:103], v[32:47]
    v_and_b32 v125, s69, v113
    v_add_f32 v120, v120, v123
    v_fmac_f32 v121, v123, v123
    v_add_f32 v120, v120, v125
    v_fmac_f32 v121, v125, v125
    s_waitcnt lgkmcnt(2)
    v_mfma_f32_32x32x16_bf16 v[16:31], a[64:67], v[104:107], v[16:31]
    ds_read_b128 v[100:103], v12 offset:5120
    v_lshlrev_b32 v122, 16, v114
    v_and_b32 v124, s69, v114
    v_add_f32 v120, v120, v122
    v_fmac_f32 v121, v122, v122
    v_mfma_f32_32x32x16_bf16 v[32:47], a[68:71], v[104:107], v[32:47]
    v_add_f32 v120, v120, v124
    v_fmac_f32 v121, v124, v124
    v_lshlrev_b32 v123, 16, v115
    v_and_b32 v125, s69, v115
    v_add_f32 v120, v120, v123
    s_waitcnt lgkmcnt(1)
    v_mfma_f32_32x32x16_bf16 v[16:31], a[72:75], v[96:99], v[16:31]
    ds_read_b128 v[104:107], v12 offset:5632
    ds_read_b128 v[112:115], v13 offset:8192
    v_fmac_f32 v121, v123, v123
    v_add_f32 v120, v120, v125
    v_fmac_f32 v121, v125, v125
    v_lshlrev_b32 v122, 16, v116
    v_mfma_f32_32x32x16_bf16 v[32:47], a[76:79], v[96:99], v[32:47]
    v_and_b32 v124, s69, v116
    v_add_f32 v120, v120, v122
    v_fmac_f32 v121, v122, v122
    v_add_f32 v120, v120, v124
    v_fmac_f32 v121, v124, v124
    s_waitcnt lgkmcnt(2)
    v_mfma_f32_32x32x16_bf16 v[16:31], a[80:83], v[100:103], v[16:31]
    ds_read_b128 v[96:99], v12 offset:6144
    v_lshlrev_b32 v123, 16, v117
    v_and_b32 v125, s69, v117
    v_add_f32 v120, v120, v123
    v_fmac_f32 v121, v123, v123
    v_mfma_f32_32x32x16_bf16 v[32:47], a[84:87], v[100:103], v[32:47]
    v_add_f32 v120, v120, v125
    v_fmac_f32 v121, v125, v125
    v_lshlrev_b32 v122, 16, v118
    v_and_b32 v124, s69, v118
    v_add_f32 v120, v120, v122
    s_waitcnt lgkmcnt(2)
    v_mfma_f32_32x32x16_bf16 v[16:31], a[88:91], v[104:107], v[16:31]
    ds_read_b128 v[100:103], v12 offset:6656
    v_fmac_f32 v121, v122, v122
    v_add_f32 v120, v120, v124
    v_fmac_f32 v121, v124, v124
    v_lshlrev_b32 v123, 16, v119
    v_mfma_f32_32x32x16_bf16 v[32:47], a[92:95], v[104:107], v[32:47]
    v_and_b32 v125, s69, v119
    v_add_f32 v120, v120, v123
    v_fmac_f32 v121, v123, v123
    v_add_f32 v120, v120, v125
    v_fmac_f32 v121, v125, v125
    s_waitcnt lgkmcnt(1)
    v_mfma_f32_32x32x16_bf16 v[16:31], a[96:99], v[96:99], v[16:31]
    ds_read_b128 v[104:107], v12 offset:7168
    ds_read_b128 v[116:119], v13 offset:10240
    v_lshlrev_b32 v122, 16, v112
    v_and_b32 v124, s69, v112
    v_add_f32 v120, v120, v122
    v_fmac_f32 v121, v122, v122
    v_mfma_f32_32x32x16_bf16 v[32:47], a[100:103], v[96:99], v[32:47]
    v_add_f32 v120, v120, v124
    v_fmac_f32 v121, v124, v124
    v_lshlrev_b32 v123, 16, v113
    v_and_b32 v125, s69, v113
    v_add_f32 v120, v120, v123
    s_waitcnt lgkmcnt(2)
    v_mfma_f32_32x32x16_bf16 v[16:31], a[104:107], v[100:103], v[16:31]
    ds_read_b128 v[96:99], v12 offset:7680
    v_fmac_f32 v121, v123, v123
    v_add_f32 v120, v120, v125
    v_fmac_f32 v121, v125, v125
    v_lshlrev_b32 v122, 16, v114
    v_mfma_f32_32x32x16_bf16 v[32:47], a[108:111], v[100:103], v[32:47]
    v_and_b32 v124, s69, v114
    v_add_f32 v120, v120, v122
    v_fmac_f32 v121, v122, v122
    v_add_f32 v120, v120, v124
    v_fmac_f32 v121, v124, v124
    s_waitcnt lgkmcnt(2)
    v_mfma_f32_32x32x16_bf16 v[16:31], a[112:115], v[104:107], v[16:31]
    ds_read_b128 v[100:103], v12 offset:8192
    v_lshlrev_b32 v123, 16, v115
    v_and_b32 v125, s69, v115
    v_add_f32 v120, v120, v123
    v_fmac_f32 v121, v123, v123
    v_mfma_f32_32x32x16_bf16 v[32:47], a[116:119], v[104:107], v[32:47]
    ds_read_b128 v[112:115], v13 offset:12288
    v_add_f32 v120, v120, v125
    v_fmac_f32 v121, v125, v125
    s_waitcnt lgkmcnt(3)
    v_lshlrev_b32 v122, 16, v116
    v_and_b32 v124, s69, v116
    s_waitcnt lgkmcnt(2)
    v_mfma_f32_32x32x16_bf16 v[16:31], a[120:123], v[96:99], v[16:31]
    ds_read_b128 v[104:107], v12 offset:8704
    v_add_f32 v120, v120, v122
    v_fmac_f32 v121, v122, v122
    v_add_f32 v120, v120, v124
    v_fmac_f32 v121, v124, v124
    v_mfma_f32_32x32x16_bf16 v[32:47], a[124:127], v[96:99], v[32:47]
    v_lshlrev_b32 v123, 16, v117
    v_and_b32 v125, s69, v117
    v_add_f32 v120, v120, v123
    v_fmac_f32 v121, v123, v123
    v_add_f32 v120, v120, v125
    s_waitcnt lgkmcnt(2)
    v_mfma_f32_32x32x16_bf16 v[16:31], a[128:131], v[100:103], v[16:31]
    ds_read_b128 v[96:99], v12 offset:9216
    v_fmac_f32 v121, v125, v125
    v_lshlrev_b32 v122, 16, v118
    v_and_b32 v124, s69, v118
    v_add_f32 v120, v120, v122
    v_mfma_f32_32x32x16_bf16 v[32:47], a[132:135], v[100:103], v[32:47]
    v_fmac_f32 v121, v122, v122
    v_add_f32 v120, v120, v124
    v_fmac_f32 v121, v124, v124
    v_lshlrev_b32 v123, 16, v119
    v_and_b32 v125, s69, v119
    s_waitcnt lgkmcnt(1)
    v_mfma_f32_32x32x16_bf16 v[16:31], a[136:139], v[104:107], v[16:31]
    ds_read_b128 v[100:103], v12 offset:9728
    v_add_f32 v120, v120, v123
    v_fmac_f32 v121, v123, v123
    v_add_f32 v120, v120, v125
    v_fmac_f32 v121, v125, v125
    v_mfma_f32_32x32x16_bf16 v[32:47], a[140:143], v[104:107], v[32:47]
    v_lshlrev_b32 v122, 16, v112
    v_and_b32 v124, s69, v112
    v_add_f32 v120, v120, v122
    v_fmac_f32 v121, v122, v122
    v_add_f32 v120, v120, v124
    s_waitcnt lgkmcnt(1)
    v_mfma_f32_32x32x16_bf16 v[16:31], a[144:147], v[96:99], v[16:31]
    ds_read_b128 v[104:107], v12 offset:10240
    v_fmac_f32 v121, v124, v124
    v_lshlrev_b32 v123, 16, v113
    v_and_b32 v125, s69, v113
    v_add_f32 v120, v120, v123
    v_mfma_f32_32x32x16_bf16 v[32:47], a[148:151], v[96:99], v[32:47]
    v_fmac_f32 v121, v123, v123
    v_add_f32 v120, v120, v125
    v_fmac_f32 v121, v125, v125
    v_lshlrev_b32 v122, 16, v114
    v_and_b32 v124, s69, v114
    s_waitcnt lgkmcnt(1)
    v_mfma_f32_32x32x16_bf16 v[16:31], a[152:155], v[100:103], v[16:31]
    ds_read_b128 v[96:99], v12 offset:10752
    v_add_f32 v120, v120, v122
    v_fmac_f32 v121, v122, v122
    v_add_f32 v120, v120, v124
    v_fmac_f32 v121, v124, v124
    v_mfma_f32_32x32x16_bf16 v[32:47], a[156:159], v[100:103], v[32:47]
    v_lshlrev_b32 v123, 16, v115
    v_and_b32 v125, s69, v115
    v_add_f32 v120, v120, v123
    v_fmac_f32 v121, v123, v123
    v_add_f32 v120, v120, v125
    s_waitcnt lgkmcnt(1)
    v_mfma_f32_32x32x16_bf16 v[16:31], a[160:163], v[104:107], v[16:31]
    ds_read_b128 v[100:103], v12 offset:11264
    v_fmac_f32 v121, v125, v125
    s_nop 0
    v_add_f32_dpp v120, v120, v120 quad_perm:[1,0,3,2] row_mask:0xf bank_mask:0xf
    v_add_f32_dpp v121, v121, v121 quad_perm:[1,0,3,2] row_mask:0xf bank_mask:0xf
    v_mfma_f32_32x32x16_bf16 v[32:47], a[164:167], v[104:107], v[32:47]
    s_nop 0
    v_add_f32_dpp v120, v120, v120 quad_perm:[2,3,0,1] row_mask:0xf bank_mask:0xf
    v_add_f32_dpp v121, v121, v121 quad_perm:[2,3,0,1] row_mask:0xf bank_mask:0xf
    s_nop 0
    v_add_f32_dpp v120, v120, v120 row_half_mirror row_mask:0xf bank_mask:0xf
    s_waitcnt lgkmcnt(1)
    v_mfma_f32_32x32x16_bf16 v[16:31], a[168:171], v[96:99], v[16:31]
    ds_read_b128 v[104:107], v12 offset:11776
    v_add_f32_dpp v121, v121, v121 row_half_mirror row_mask:0xf bank_mask:0xf
    v_mul_f32 v120, 0xbb124925, v120
    v_mul_f32 v122, v120, v120
    v_fmamk_f32 v121, v121, 0xbb124925, v122
    v_mfma_f32_32x32x16_bf16 v[32:47], a[172:175], v[96:99], v[32:47]
    v_min_f32 v121, 0, v121
    v_sub_f32 v121, 0x3727c5ac, v121
    v_rsq_f32 v121, v121
    s_waitcnt lgkmcnt(1)
    v_mfma_f32_32x32x16_bf16 v[16:31], a[176:179], v[100:103], v[16:31]
    ds_read_b128 v[96:99], v12 offset:12288
    ds_write_b64 v15, v[120:121] offset:64512
    v_mfma_f32_32x32x16_bf16 v[32:47], a[180:183], v[100:103], v[32:47]
    s_waitcnt lgkmcnt(2)
    v_mfma_f32_32x32x16_bf16 v[16:31], a[184:187], v[104:107], v[16:31]
    ds_read_b128 v[100:103], v12 offset:12800
    s_waitcnt lgkmcnt(1)
    s_barrier
    v_mfma_f32_32x32x16_bf16 v[32:47], a[188:191], v[104:107], v[32:47]
    ds_read_b32 v110, v14 offset:64512
    v_mfma_f32_32x32x16_bf16 v[16:31], a[192:195], v[96:99], v[16:31]
    ds_read_b128 v[104:107], v12 offset:13312
    v_mfma_f32_32x32x16_bf16 v[32:47], a[196:199], v[96:99], v[32:47]
    s_waitcnt lgkmcnt(2)
    v_mfma_f32_32x32x16_bf16 v[16:31], a[200:203], v[100:103], v[16:31]
    ds_read_b128 v[96:99], v12 offset:13824
    s_waitcnt lgkmcnt(2)
    v_cndmask_b32 v110, 0, v110, s[52:53]
    v_cvt_pk_bf16_f32 v108, v110, v110
    v_and_b32 v111, s69, v108
    s_waitcnt lgkmcnt(1)
    v_mfma_f32_32x32x16_bf16 v[16:31], a[208:211], v[104:107], v[16:31]
    v_sub_f32 v110, v110, v111
    v_cvt_pk_bf16_f32 v109, v110, 0
    s_waitcnt lgkmcnt(0)
    v_mfma_f32_32x32x16_bf16 v[16:31], a[216:219], v[96:99], v[16:31]
    v_mfma_f32_32x32x8_bf16 v[16:31], v[2:3], v[108:109], v[16:31]
    ds_read_b128 v[112:115], v13 offset:28672
    s_nop 3
    v_mfma_f32_32x32x16_bf16 v[32:47], a[204:207], v[100:103], v[32:47]
    ds_read_b128 v[100:103], v12 offset:28672
    ds_read_b128 v[116:119], v13 offset:30720
    s_nop 2
    v_mfma_f32_32x32x16_bf16 v[32:47], a[212:215], v[104:107], v[32:47]
    ds_read_b128 v[104:107], v12 offset:29184
    v_cvt_pk_bf16_f32 v80, -v16, -v17
    v_cvt_pk_bf16_f32 v81, -v18, -v19
    v_cvt_pk_bf16_f32 v82, -v20, -v21
    v_cvt_pk_bf16_f32 v83, v22, v23
    v_pk_max_u16 v80, v80, s54
    v_mfma_f32_32x32x16_bf16 v[32:47], a[220:223], v[96:99], v[32:47]
    v_pk_max_u16 v81, v81, s54
    v_pk_max_u16 v82, v82, s54
    v_pk_max_i16 v83, v83, 0
    v_cvt_pk_bf16_f32 v84, -v24, -v25
    v_cvt_pk_bf16_f32 v85, -v26, -v27
    v_mfma_f32_32x32x8_bf16 v[32:47], v[4:5], v[108:109], v[32:47]
    buffer_store_dwordx4 v[80:83], v1, s[24:27], s60 offen offset:0 sc1
    v_cvt_pk_bf16_f32 v86, -v28, -v29
    v_cvt_pk_bf16_f32 v87, v30, v31
    v_pk_max_u16 v84, v84, s54
    v_pk_max_u16 v85, v85, s54
    v_pk_max_u16 v86, v86, s54
    s_waitcnt lgkmcnt(2)
    v_mfma_f32_32x32x16_bf16 v[48:63], a[0:3], v[100:103], 0
    ds_read_b128 v[96:99], v12 offset:29696
    v_pk_max_i16 v87, v87, 0
    v_mfma_f32_32x32x16_bf16 v[64:79], a[4:7], v[100:103], 0
    buffer_store_dwordx4 v[84:87], v1, s[24:27], s60 offen offset:1024 sc1
    v_lshlrev_b32 v122, 16, v112
    v_and_b32 v124, s69, v112
    v_add_f32 v120, v122, v124
    v_mul_f32 v121, v122, v122
    s_waitcnt lgkmcnt(1)
    v_mfma_f32_32x32x16_bf16 v[48:63], a[8:11], v[104:107], v[48:63]
    ds_read_b128 v[100:103], v12 offset:30208
    v_cvt_pk_bf16_f32 v88, -v32, -v33
    v_cvt_pk_bf16_f32 v89, -v34, -v35
    v_cvt_pk_bf16_f32 v90, -v36, -v37
    v_cvt_pk_bf16_f32 v91, v38, v39
    v_pk_max_u16 v88, v88, s54
    v_mfma_f32_32x32x16_bf16 v[64:79], a[12:15], v[104:107], v[64:79]
    v_pk_max_u16 v89, v89, s54
    v_pk_max_u16 v90, v90, s54
    v_pk_max_i16 v91, v91, 0
    v_cvt_pk_bf16_f32 v92, -v40, -v41
    v_cvt_pk_bf16_f32 v93, -v42, -v43
    s_waitcnt lgkmcnt(1)
    v_mfma_f32_32x32x16_bf16 v[48:63], a[16:19], v[96:99], v[48:63]
    ds_read_b128 v[104:107], v12 offset:30720
    buffer_store_dwordx4 v[88:91], v1, s[24:27], s60 offen offset:2048 sc1
    v_cvt_pk_bf16_f32 v94, -v44, -v45
    v_cvt_pk_bf16_f32 v95, v46, v47
    v_pk_max_u16 v92, v92, s54
L_pad7:
    s_cbranch_execz L_ret1
    v_pk_max_u16 v93, v93, s54
    v_mfma_f32_32x32x16_bf16 v[64:79], a[20:23], v[96:99], v[64:79]
    v_pk_max_u16 v94, v94, s54
    v_pk_max_i16 v95, v95, 0
    v_fmac_f32 v121, v124, v124
    v_lshlrev_b32 v123, 16, v113
    v_and_b32 v125, s69, v113
    s_waitcnt lgkmcnt(1)
    v_mfma_f32_32x32x16_bf16 v[48:63], a[24:27], v[100:103], v[48:63]
    ds_read_b128 v[96:99], v12 offset:31232
    buffer_store_dwordx4 v[92:95], v1, s[24:27], s60 offen offset:3072 sc1
    v_add_f32 v120, v120, v123
    v_fmac_f32 v121, v123, v123
    v_add_f32 v120, v120, v125
    v_fmac_f32 v121, v125, v125
    v_mfma_f32_32x32x16_bf16 v[64:79], a[28:31], v[100:103], v[64:79]
    v_lshlrev_b32 v122, 16, v114
    v_and_b32 v124, s69, v114
    v_add_f32 v120, v120, v122
    v_fmac_f32 v121, v122, v122
    v_add_f32 v120, v120, v124
    s_waitcnt lgkmcnt(1)
    v_mfma_f32_32x32x16_bf16 v[48:63], a[32:35], v[104:107], v[48:63]
    ds_read_b128 v[100:103], v12 offset:31744
    v_fmac_f32 v121, v124, v124
    v_lshlrev_b32 v123, 16, v115
    v_and_b32 v125, s69, v115
    v_add_f32 v120, v120, v123
    v_mfma_f32_32x32x16_bf16 v[64:79], a[36:39], v[104:107], v[64:79]
    ds_read_b128 v[112:115], v13 offset:32768
    v_fmac_f32 v121, v123, v123
    v_add_f32 v120, v120, v125
    v_fmac_f32 v121, v125, v125
    v_lshlrev_b32 v122, 16, v116
    s_waitcnt lgkmcnt(2)
    v_mfma_f32_32x32x16_bf16 v[48:63], a[40:43], v[96:99], v[48:63]
    ds_read_b128 v[104:107], v12 offset:32256
    v_and_b32 v124, s69, v116
    v_add_f32 v120, v120, v122
    v_fmac_f32 v121, v122, v122
    v_add_f32 v120, v120, v124
    v_mfma_f32_32x32x16_bf16 v[64:79], a[44:47], v[96:99], v[64:79]
    v_fmac_f32 v121, v124, v124
    v_lshlrev_b32 v123, 16, v117
    v_and_b32 v125, s69, v117
    v_add_f32 v120, v120, v123
    v_fmac_f32 v121, v123, v123
    s_waitcnt lgkmcnt(2)
    v_mfma_f32_32x32x16_bf16 v[48:63], a[48:51], v[100:103], v[48:63]
    ds_read_b128 v[96:99], v12 offset:32768
    v_add_f32 v120, v120, v125
    v_fmac_f32 v121, v125, v125
    v_lshlrev_b32 v122, 16, v118
    v_and_b32 v124, s69, v118
    v_mfma_f32_32x32x16_bf16 v[64:79], a[52:55], v[100:103], v[64:79]
    v_add_f32 v120, v120, v122
    v_fmac_f32 v121, v122, v122
    v_add_f32 v120, v120, v124
    v_fmac_f32 v121, v124, v124
    v_lshlrev_b32 v123, 16, v119
    s_waitcnt lgkmcnt(1)
    v_mfma_f32_32x32x16_bf16 v[48:63], a[56:59], v[104:107], v[48:63]
    ds_read_b128 v[100:103], v12 offset:33280
    v_and_b32 v125, s69, v119
    v_add_f32 v120, v120, v123
    v_fmac_f32 v121, v123, v123
    v_add_f32 v120, v120, v125
    v_mfma_f32_32x32x16_bf16 v[64:79], a[60:63], v[104:107], v[64:79]
    ds_read_b128 v[116:119], v13 offset:34816
    v_fmac_f32 v121, v125, v125
    v_lshlrev_b32 v122, 16, v112
    v_and_b32 v124, s69, v112
    v_add_f32 v120, v120, v122
    s_waitcnt lgkmcnt(2)
    v_mfma_f32_32x32x16_bf16 v[48:63], a[64:67], v[96:99], v[48:63]
    ds_read_b128 v[104:107], v12 offset:33792
    v_fmac_f32 v121, v122, v122
    v_add_f32 v120, v120, v124
    v_fmac_f32 v121, v124, v124
    v_lshlrev_b32 v123, 16, v113
    v_mfma_f32_32x32x16_bf16 v[64:79], a[68:71], v[96:99], v[64:79]
    v_and_b32 v125, s69, v113
    v_add_f32 v120, v120, v123
    v_fmac_f32 v121, v123, v123
    v_add_f32 v120, v120, v125
    v_fmac_f32 v121, v125, v125
    s_waitcnt lgkmcnt(2)
    v_mfma_f32_32x32x16_bf16 v[48:63], a[72:75], v[100:103], v[48:63]
    ds_read_b128 v[96:99], v12 offset:34304
    v_lshlrev_b32 v122, 16, v114
    v_and_b32 v124, s69, v114
    v_add_f32 v120, v120, v122
    v_fmac_f32 v121, v122, v122
    v_mfma_f32_32x32x16_bf16 v[64:79], a[76:79], v[100:103], v[64:79]
    v_add_f32 v120, v120, v124
    v_fmac_f32 v121, v124, v124
    v_lshlrev_b32 v123, 16, v115
    v_and_b32 v125, s69, v115
    v_add_f32 v120, v120, v123
    s_waitcnt lgkmcnt(1)
    v_mfma_f32_32x32x16_bf16 v[48:63], a[80:83], v[104:107], v[48:63]
    ds_read_b128 v[100:103], v12 offset:34816
    ds_read_b128 v[112:115], v13 offset:36864
    v_fmac_f32 v121, v123, v123
    v_add_f32 v120, v120, v125
    v_fmac_f32 v121, v125, v125
    v_lshlrev_b32 v122, 16, v116
    v_mfma_f32_32x32x16_bf16 v[64:79], a[84:87], v[104:107], v[64:79]
    v_and_b32 v124, s69, v116
    v_add_f32 v120, v120, v122
    v_fmac_f32 v121, v122, v122
    v_add_f32 v120, v120, v124
    v_fmac_f32 v121, v124, v124
    s_waitcnt lgkmcnt(2)
    v_mfma_f32_32x32x16_bf16 v[48:63], a[88:91], v[96:99], v[48:63]
    ds_read_b128 v[104:107], v12 offset:35328
    v_lshlrev_b32 v123, 16, v117
    v_and_b32 v125, s69, v117
    v_add_f32 v120, v120, v123
    v_fmac_f32 v121, v123, v123
    v_mfma_f32_32x32x16_bf16 v[64:79], a[92:95], v[96:99], v[64:79]
    v_add_f32 v120, v120, v125
    v_fmac_f32 v121, v125, v125
    v_lshlrev_b32 v122, 16, v118
    v_and_b32 v124, s69, v118
    v_add_f32 v120, v120, v122
    s_waitcnt lgkmcnt(2)
    v_mfma_f32_32x32x16_bf16 v[48:63], a[96:99], v[100:103], v[48:63]
    ds_read_b128 v[96:99], v12 offset:35840
    v_fmac_f32 v121, v122, v122
    v_add_f32 v120, v120, v124
    v_fmac_f32 v121, v124, v124
    v_lshlrev_b32 v123, 16, v119
    v_mfma_f32_32x32x16_bf16 v[64:79], a[100:103], v[100:103], v[64:79]
    v_and_b32 v125, s69, v119
    v_add_f32 v120, v120, v123
    v_fmac_f32 v121, v123, v123
    v_add_f32 v120, v120, v125
    v_fmac_f32 v121, v125, v125
    s_waitcnt lgkmcnt(1)
    v_mfma_f32_32x32x16_bf16 v[48:63], a[104:107], v[104:107], v[48:63]
    ds_read_b128 v[100:103], v12 offset:36352
    ds_read_b128 v[116:119], v13 offset:38912
    v_lshlrev_b32 v122, 16, v112
    v_and_b32 v124, s69, v112
    v_add_f32 v120, v120, v122
    v_fmac_f32 v121, v122, v122
    v_mfma_f32_32x32x16_bf16 v[64:79], a[108:111], v[104:107], v[64:79]
    v_add_f32 v120, v120, v124
    v_fmac_f32 v121, v124, v124
    v_lshlrev_b32 v123, 16, v113
    v_and_b32 v125, s69, v113
    v_add_f32 v120, v120, v123
    s_waitcnt lgkmcnt(2)
    v_mfma_f32_32x32x16_bf16 v[48:63], a[112:115], v[96:99], v[48:63]
    ds_read_b128 v[104:107], v12 offset:36864
    v_fmac_f32 v121, v123, v123
    v_add_f32 v120, v120, v125
    v_fmac_f32 v121, v125, v125
    v_lshlrev_b32 v122, 16, v114
    v_mfma_f32_32x32x16_bf16 v[64:79], a[116:119], v[96:99], v[64:79]
    v_and_b32 v124, s69, v114
    v_add_f32 v120, v120, v122
    v_fmac_f32 v121, v122, v122
    v_add_f32 v120, v120, v124
    v_fmac_f32 v121, v124, v124
    s_waitcnt lgkmcnt(2)
    v_mfma_f32_32x32x16_bf16 v[48:63], a[120:123], v[100:103], v[48:63]
    ds_read_b128 v[96:99], v12 offset:37376
    v_lshlrev_b32 v123, 16, v115
    v_and_b32 v125, s69, v115
    v_add_f32 v120, v120, v123
    v_fmac_f32 v121, v123, v123
    v_mfma_f32_32x32x16_bf16 v[64:79], a[124:127], v[100:103], v[64:79]
    ds_read_b128 v[112:115], v13 offset:40960
    v_add_f32 v120, v120, v125
    v_fmac_f32 v121, v125, v125
    s_waitcnt lgkmcnt(3)
    v_lshlrev_b32 v122, 16, v116
    v_and_b32 v124, s69, v116
    s_waitcnt lgkmcnt(2)
    v_mfma_f32_32x32x16_bf16 v[48:63], a[128:131], v[104:107], v[48:63]
    ds_read_b128 v[100:103], v12 offset:37888
    buffer_load_dwordx4 v[16:19], v1, s[24:27], s61 offen offset:0 sc1
    v_add_f32 v120, v120, v122
    v_fmac_f32 v121, v122, v122
    v_add_f32 v120, v120, v124
    v_fmac_f32 v121, v124, v124
    v_mfma_f32_32x32x16_bf16 v[64:79], a[132:135], v[104:107], v[64:79]
    buffer_load_dwordx4 v[20:23], v1, s[24:27], s61 offen offset:1024 sc1
    v_lshlrev_b32 v123, 16, v117
    v_and_b32 v125, s69, v117
    v_add_f32 v120, v120, v123
    v_fmac_f32 v121, v123, v123
    s_waitcnt lgkmcnt(2)
    v_mfma_f32_32x32x16_bf16 v[48:63], a[136:139], v[96:99], v[48:63]
    ds_read_b128 v[104:107], v12 offset:38400
    v_add_f32 v120, v120, v125
    v_fmac_f32 v121, v125, v125
    v_lshlrev_b32 v122, 16, v118
    v_and_b32 v124, s69, v118
    v_mfma_f32_32x32x16_bf16 v[64:79], a[140:143], v[96:99], v[64:79]
    buffer_load_dwordx4 v[24:27], v1, s[24:27], s61 offen offset:2048 sc1
    v_add_f32 v120, v120, v122
    v_fmac_f32 v121, v122, v122
    v_add_f32 v120, v120, v124
    v_fmac_f32 v121, v124, v124
    s_waitcnt lgkmcnt(1)
    v_mfma_f32_32x32x16_bf16 v[48:63], a[144:147], v[100:103], v[48:63]
    ds_read_b128 v[96:99], v12 offset:38912
    v_lshlrev_b32 v123, 16, v119
    v_and_b32 v125, s69, v119
    v_add_f32 v120, v120, v123
    v_fmac_f32 v121, v123, v123
    v_mfma_f32_32x32x16_bf16 v[64:79], a[148:151], v[100:103], v[64:79]
    buffer_load_dwordx4 v[28:31], v1, s[24:27], s61 offen offset:3072 sc1
    v_add_f32 v120, v120, v125
    v_fmac_f32 v121, v125, v125
    v_lshlrev_b32 v122, 16, v112
    v_and_b32 v124, s69, v112
    s_waitcnt lgkmcnt(1)
    v_mfma_f32_32x32x16_bf16 v[48:63], a[152:155], v[104:107], v[48:63]
    ds_read_b128 v[100:103], v12 offset:39424
    v_add_f32 v120, v120, v122
    v_fmac_f32 v121, v122, v122
    v_add_f32 v120, v120, v124
    v_fmac_f32 v121, v124, v124
    v_mfma_f32_32x32x16_bf16 v[64:79], a[156:159], v[104:107], v[64:79]
    buffer_load_dwordx4 v[32:35], v1, s[24:27], s62 offen offset:0 sc1
    v_lshlrev_b32 v123, 16, v113
    v_and_b32 v125, s69, v113
    v_add_f32 v120, v120, v123
    v_fmac_f32 v121, v123, v123
    s_waitcnt lgkmcnt(1)
    v_mfma_f32_32x32x16_bf16 v[48:63], a[160:163], v[96:99], v[48:63]
    ds_read_b128 v[104:107], v12 offset:39936
    v_add_f32 v120, v120, v125
    v_fmac_f32 v121, v125, v125
    v_lshlrev_b32 v122, 16, v114
    v_and_b32 v124, s69, v114
    v_mfma_f32_32x32x16_bf16 v[64:79], a[164:167], v[96:99], v[64:79]
    buffer_load_dwordx4 v[36:39], v1, s[24:27], s62 offen offset:1024 sc1
    v_add_f32 v120, v120, v122
    v_fmac_f32 v121, v122, v122
    v_add_f32 v120, v120, v124
    v_fmac_f32 v121, v124, v124
    s_waitcnt lgkmcnt(1)
    v_mfma_f32_32x32x16_bf16 v[48:63], a[168:171], v[100:103], v[48:63]
    ds_read_b128 v[96:99], v12 offset:40448
    v_lshlrev_b32 v123, 16, v115
    v_and_b32 v125, s69, v115
    v_add_f32 v120, v120, v123
    v_fmac_f32 v121, v123, v123
    v_mfma_f32_32x32x16_bf16 v[64:79], a[172:175], v[100:103], v[64:79]
    buffer_load_dwordx4 v[40:43], v1, s[24:27], s62 offen offset:2048 sc1
    v_add_f32 v120, v120, v125
    v_fmac_f32 v121, v125, v125
    s_nop 0
    v_add_f32_dpp v120, v120, v120 quad_perm:[1,0,3,2] row_mask:0xf bank_mask:0xf
    s_waitcnt lgkmcnt(1)
    v_mfma_f32_32x32x16_bf16 v[48:63], a[176:179], v[104:107], v[48:63]
    ds_read_b128 v[100:103], v12 offset:40960
    buffer_load_dwordx4 v[44:47], v1, s[24:27], s62 offen offset:3072 sc1
    v_add_f32_dpp v121, v121, v121 quad_perm:[1,0,3,2] row_mask:0xf bank_mask:0xf
    s_nop 0
    v_add_f32_dpp v120, v120, v120 quad_perm:[2,3,0,1] row_mask:0xf bank_mask:0xf
    v_mfma_f32_32x32x16_bf16 v[64:79], a[180:183], v[104:107], v[64:79]
    v_add_f32_dpp v121, v121, v121 quad_perm:[2,3,0,1] row_mask:0xf bank_mask:0xf
    s_nop 0
    v_add_f32_dpp v120, v120, v120 row_half_mirror row_mask:0xf bank_mask:0xf
    v_add_f32_dpp v121, v121, v121 row_half_mirror row_mask:0xf bank_mask:0xf
    v_mul_f32 v120, 0xbb124925, v120
    s_waitcnt lgkmcnt(1)
    v_mfma_f32_32x32x16_bf16 v[48:63], a[184:187], v[96:99], v[48:63]
    ds_read_b128 v[104:107], v12 offset:41472
    buffer_load_dwordx4 v[128:131], v1, s[24:27], s63 offen offset:0 sc1
    v_mul_f32 v122, v120, v120
    v_fmamk_f32 v121, v121, 0xbb124925, v122
    v_min_f32 v121, 0, v121
    v_mfma_f32_32x32x16_bf16 v[64:79], a[188:191], v[96:99], v[64:79]
    v_sub_f32 v121, 0x3727c5ac, v121
    v_rsq_f32 v121, v121
    s_waitcnt lgkmcnt(1)
    v_mfma_f32_32x32x16_bf16 v[48:63], a[192:195], v[100:103], v[48:63]
    ds_read_b128 v[96:99], v12 offset:41984
    buffer_load_dwordx4 v[132:135], v1, s[24:27], s63 offen offset:1024 sc1
    ds_write_b64 v15, v[120:121] offset:64768
    v_mfma_f32_32x32x16_bf16 v[64:79], a[196:199], v[100:103], v[64:79]
    s_waitcnt lgkmcnt(2)
    v_mfma_f32_32x32x16_bf16 v[48:63], a[200:203], v[104:107], v[48:63]
    ds_read_b128 v[100:103], v12 offset:42496
    buffer_load_dwordx4 v[136:139], v1, s[24:27], s63 offen offset:2048 sc1
    s_waitcnt lgkmcnt(1)
    s_barrier
    v_mfma_f32_32x32x16_bf16 v[64:79], a[204:207], v[104:107], v[64:79]
    ds_read_b32 v110, v14 offset:64768
    v_mfma_f32_32x32x16_bf16 v[48:63], a[208:211], v[96:99], v[48:63]
    buffer_load_dwordx4 v[140:143], v1, s[24:27], s63 offen offset:3072 sc1
    v_mfma_f32_32x32x16_bf16 v[64:79], a[212:215], v[96:99], v[64:79]
    s_waitcnt lgkmcnt(1)
    v_mfma_f32_32x32x16_bf16 v[48:63], a[216:219], v[100:103], v[48:63]
    s_waitcnt lgkmcnt(0)
    v_cndmask_b32 v110, 0, v110, s[52:53]
    v_cvt_pk_bf16_f32 v108, v110, v110
    v_and_b32 v111, s69, v108
    v_sub_f32 v110, v110, v111
    v_cvt_pk_bf16_f32 v109, v110, 0
    v_add_u32 v8, 114688, v1
    v_mfma_f32_32x32x16_bf16 v[64:79], a[220:223], v[100:103], v[64:79]
    v_mfma_f32_32x32x8_bf16 v[48:63], v[2:3], v[108:109], v[48:63]
    v_mfma_f32_32x32x8_bf16 v[64:79], v[4:5], v[108:109], v[64:79]
    s_nop 10
    v_cvt_pk_bf16_f32 v112, -v48, -v49
    v_cvt_pk_bf16_f32 v113, -v50, -v51
    v_cvt_pk_bf16_f32 v114, -v52, -v53
    v_cvt_pk_bf16_f32 v115, v54, v55
    v_pk_max_u16 v112, v112, s54
    v_pk_max_u16 v113, v113, s54
    v_pk_max_u16 v114, v114, s54
    v_pk_max_i16 v115, v115, 0
    buffer_store_dwordx4 v[112:115], v8, s[24:27], s60 offen offset:0 sc1
    v_cvt_pk_bf16_f32 v116, -v56, -v57
    v_cvt_pk_bf16_f32 v117, -v58, -v59
    v_cvt_pk_bf16_f32 v118, -v60, -v61
    v_cvt_pk_bf16_f32 v119, v62, v63
    v_pk_max_u16 v116, v116, s54
    v_pk_max_u16 v117, v117, s54
    v_pk_max_u16 v118, v118, s54
    v_pk_max_i16 v119, v119, 0
    buffer_store_dwordx4 v[116:119], v8, s[24:27], s60 offen offset:1024 sc1
    v_cvt_pk_bf16_f32 v120, -v64, -v65
    v_cvt_pk_bf16_f32 v121, -v66, -v67
    v_cvt_pk_bf16_f32 v122, -v68, -v69
    v_cvt_pk_bf16_f32 v123, v70, v71
    v_pk_max_u16 v120, v120, s54
    v_pk_max_u16 v121, v121, s54
    v_pk_max_u16 v122, v122, s54
    v_pk_max_i16 v123, v123, 0
    buffer_store_dwordx4 v[120:123], v8, s[24:27], s60 offen offset:2048 sc1
    v_cvt_pk_bf16_f32 v124, -v72, -v73
    v_cvt_pk_bf16_f32 v125, -v74, -v75
    v_cvt_pk_bf16_f32 v126, -v76, -v77
    v_cvt_pk_bf16_f32 v127, v78, v79
    v_pk_max_u16 v124, v124, s54
    v_pk_max_u16 v125, v125, s54
    v_pk_max_u16 v126, v126, s54
    v_pk_max_i16 v127, v127, 0
    buffer_store_dwordx4 v[124:127], v8, s[24:27], s60 offen offset:3072 sc1
    v_mfma_f32_32x32x16_bf16 v[48:63], a[224:227], v[80:83], 0
    v_lshrrev_b32 v96, 3, v0
    v_and_b32 v97, 7, v0
    s_lshl_b32 s42, s32, 3
    v_add_u32 v96, s42, v96
    v_mul_u32_u24 v13, 1088, v97
    v_mfma_f32_32x32x16_bf16 v[64:79], a[228:231], v[80:83], 0
    v_lshl_add_u32 v13, v96, 4, v13
    v_lshlrev_b32 v14, 3, v96
    v_mul_u32_u24 v15, 57344, v96
    v_lshl_add_u32 v15, v97, 4, v15
    s_mul_i32 s56, s34, 896
    v_mfma_f32_32x32x16_bf16 v[48:63], a[232:235], v[84:87], v[48:63]
    s_lshl_b32 s42, s33, 7
    s_add_u32 s56, s56, s42
    s_mul_i32 s57, s35, 896
    s_lshl_b32 s42, s33, 7
    s_add_u32 s57, s57, s42
    v_mfma_f32_32x32x16_bf16 v[64:79], a[236:239], v[84:87], v[64:79]
    s_mul_i32 s42, s32, 8704
    v_add_u32 v9, s42, v1
    s_barrier
    v_mfma_f32_32x32x16_bf16 v[48:63], a[240:243], v[88:91], v[48:63]
    v_mfma_f32_32x32x16_bf16 v[64:79], a[244:247], v[88:91], v[64:79]
    buffer_load_dwordx4 v[80:83], v1, s[24:27], s64 offen offset:0 sc1
    v_mfma_f32_32x32x16_bf16 v[48:63], a[248:251], v[92:95], v[48:63]
    s_waitcnt vmcnt(13)
    v_bitop3_b32 v12, v16, v20, v24 bitop3:0x80
    v_and_b32 v12, v12, v28
    v_cmp_le_i32 vcc, 0, v12
    v_mfma_f32_32x32x16_bf16 v[64:79], a[252:255], v[92:95], v[64:79]
    buffer_load_dwordx4 v[84:87], v1, s[24:27], s64 offen offset:1024 sc1
    s_cbranch_vccnz slow_h1_01_69
ok_h1_01_70:
    v_mfma_f32_32x32x16_bf16 v[48:63], v[152:155], v[16:19], v[48:63]
    v_mfma_f32_32x32x16_bf16 v[64:79], v[156:159], v[16:19], v[64:79]
    buffer_load_dwordx4 v[88:91], v1, s[24:27], s64 offen offset:2048 sc1
    v_mfma_f32_32x32x16_bf16 v[48:63], v[160:163], v[20:23], v[48:63]
    v_mfma_f32_32x32x16_bf16 v[64:79], v[164:167], v[20:23], v[64:79]
    buffer_load_dwordx4 v[92:95], v1, s[24:27], s64 offen offset:3072 sc1
    v_mfma_f32_32x32x16_bf16 v[48:63], v[168:171], v[24:27], v[48:63]
    v_mfma_f32_32x32x16_bf16 v[64:79], v[172:175], v[24:27], v[64:79]
    buffer_load_dwordx4 v[16:19], v1, s[24:27], s65 offen offset:0 sc1
    v_mfma_f32_32x32x16_bf16 v[48:63], v[176:179], v[28:31], v[48:63]
    s_waitcnt vmcnt(13)
    v_bitop3_b32 v12, v32, v36, v40 bitop3:0x80
    v_and_b32 v12, v12, v44
    v_cmp_le_i32 vcc, 0, v12
    v_mfma_f32_32x32x16_bf16 v[64:79], v[180:183], v[28:31], v[64:79]
    buffer_load_dwordx4 v[20:23], v1, s[24:27], s65 offen offset:1024 sc1
    s_cbranch_vccnz slow_h1_02_71
ok_h1_02_72:
    v_mfma_f32_32x32x16_bf16 v[48:63], v[184:187], v[32:35], v[48:63]
    v_mfma_f32_32x32x16_bf16 v[64:79], v[188:191], v[32:35], v[64:79]
    buffer_load_dwordx4 v[24:27], v1, s[24:27], s65 offen offset:2048 sc1
    v_mfma_f32_32x32x16_bf16 v[48:63], v[192:195], v[36:39], v[48:63]
    v_mfma_f32_32x32x16_bf16 v[64:79], v[196:199], v[36:39], v[64:79]
    buffer_load_dwordx4 v[28:31], v1, s[24:27], s65 offen offset:3072 sc1
    v_mfma_f32_32x32x16_bf16 v[48:63], v[200:203], v[40:43], v[48:63]
    v_mfma_f32_32x32x16_bf16 v[64:79], v[204:207], v[40:43], v[64:79]
    buffer_load_dwordx4 v[32:35], v1, s[24:27], s66 offen offset:0 sc1
    v_mfma_f32_32x32x16_bf16 v[48:63], v[208:211], v[44:47], v[48:63]
    s_waitcnt vmcnt(13)
    v_bitop3_b32 v12, v128, v132, v136 bitop3:0x80
    v_and_b32 v12, v12, v140
    v_cmp_le_i32 vcc, 0, v12
    v_mfma_f32_32x32x16_bf16 v[64:79], v[212:215], v[44:47], v[64:79]
    buffer_load_dwordx4 v[36:39], v1, s[24:27], s66 offen offset:1024 sc1
    s_cbranch_vccnz slow_h1_03_73
ok_h1_03_74:
    v_mfma_f32_32x32x16_bf16 v[48:63], v[216:219], v[128:131], v[48:63]
    v_mfma_f32_32x32x16_bf16 v[64:79], v[220:223], v[128:131], v[64:79]
    buffer_load_dwordx4 v[40:43], v1, s[24:27], s66 offen offset:2048 sc1
    v_mfma_f32_32x32x16_bf16 v[48:63], v[224:227], v[132:135], v[48:63]
    v_mfma_f32_32x32x16_bf16 v[64:79], v[228:231], v[132:135], v[64:79]
    buffer_load_dwordx4 v[44:47], v1, s[24:27], s66 offen offset:3072 sc1
    v_mfma_f32_32x32x16_bf16 v[48:63], v[232:235], v[136:139], v[48:63]
    v_mfma_f32_32x32x16_bf16 v[64:79], v[236:239], v[136:139], v[64:79]
    buffer_load_dwordx4 v[128:131], v8, s[24:27], s61 offen offset:0 sc1
    v_mfma_f32_32x32x16_bf16 v[48:63], v[240:243], v[140:143], v[48:63]
    ds_read_b128 v[104:107], v10 offset:0
    s_waitcnt vmcnt(9)
    v_bitop3_b32 v12, v80, v84, v88 bitop3:0x80
    v_and_b32 v12, v12, v92
    v_cmp_le_i32 vcc, 0, v12
    v_mfma_f32_32x32x16_bf16 v[64:79], v[244:247], v[140:143], v[64:79]
    ds_read_b128 v[108:111], v10 offset:1024
    buffer_load_dwordx4 v[132:135], v8, s[24:27], s61 offen offset:1024 sc1
    s_cbranch_vccnz slow_h1_04_75
ok_h1_04_76:
    v_mfma_f32_32x32x16_bf16 v[48:63], v[248:251], v[80:83], v[48:63]
    ds_read_b128 v[96:99], v10 offset:2048
    v_mfma_f32_32x32x16_bf16 v[64:79], v[252:255], v[80:83], v[64:79]
    ds_read_b128 v[100:103], v10 offset:3072
    buffer_load_dwordx4 v[136:139], v8, s[24:27], s61 offen offset:2048 sc1
    s_waitcnt lgkmcnt(3)
    v_mfma_f32_32x32x16_bf16 v[48:63], v[104:107], v[84:87], v[48:63]
    ds_read_b128 v[104:107], v10 offset:4096
    s_waitcnt lgkmcnt(3)
    v_mfma_f32_32x32x16_bf16 v[64:79], v[108:111], v[84:87], v[64:79]
    ds_read_b128 v[108:111], v10 offset:5120
    buffer_load_dwordx4 v[140:143], v8, s[24:27], s61 offen offset:3072 sc1
    s_waitcnt lgkmcnt(3)
    v_mfma_f32_32x32x16_bf16 v[48:63], v[96:99], v[88:91], v[48:63]
    ds_read_b128 v[96:99], v10 offset:6144
    s_waitcnt lgkmcnt(3)
    v_mfma_f32_32x32x16_bf16 v[64:79], v[100:103], v[88:91], v[64:79]
    ds_read_b128 v[100:103], v10 offset:7168
    buffer_load_dwordx4 v[80:83], v8, s[24:27], s62 offen offset:0 sc1
    s_waitcnt lgkmcnt(3)
    v_mfma_f32_32x32x16_bf16 v[48:63], v[104:107], v[92:95], v[48:63]
    ds_read_b128 v[104:107], v10 offset:8192
    s_waitcnt vmcnt(9)
    v_bitop3_b32 v12, v16, v20, v24 bitop3:0x80
    v_and_b32 v12, v12, v28
    v_cmp_le_i32 vcc, 0, v12
    s_waitcnt lgkmcnt(3)
    v_mfma_f32_32x32x16_bf16 v[64:79], v[108:111], v[92:95], v[64:79]
    ds_read_b128 v[108:111], v10 offset:9216
    buffer_load_dwordx4 v[84:87], v8, s[24:27], s62 offen offset:1024 sc1
    s_cbranch_vccnz slow_h1_05_77
ok_h1_05_78:
    s_waitcnt lgkmcnt(3)
    v_mfma_f32_32x32x16_bf16 v[48:63], v[96:99], v[16:19], v[48:63]
    ds_read_b128 v[96:99], v10 offset:10240
    buffer_load_dwordx4 v[88:91], v8, s[24:27], s62 offen offset:2048 sc1
    s_waitcnt lgkmcnt(3)
    v_mfma_f32_32x32x16_bf16 v[64:79], v[100:103], v[16:19], v[64:79]
    ds_read_b128 v[100:103], v10 offset:11264
    s_waitcnt lgkmcnt(3)
    v_mfma_f32_32x32x16_bf16 v[48:63], v[104:107], v[20:23], v[48:63]
    ds_read_b128 v[104:107], v10 offset:12288
    buffer_load_dwordx4 v[92:95], v8, s[24:27], s62 offen offset:3072 sc1
    s_waitcnt lgkmcnt(3)
    v_mfma_f32_32x32x16_bf16 v[64:79], v[108:111], v[20:23], v[64:79]
    ds_read_b128 v[108:111], v10 offset:13312
    s_waitcnt lgkmcnt(3)
    v_mfma_f32_32x32x16_bf16 v[48:63], v[96:99], v[24:27], v[48:63]
    ds_read_b128 v[96:99], v10 offset:14336
    s_waitcnt lgkmcnt(3)
    v_mfma_f32_32x32x16_bf16 v[64:79], v[100:103], v[24:27], v[64:79]
    ds_read_b128 v[100:103], v10 offset:15360
    s_waitcnt lgkmcnt(3)
    v_mfma_f32_32x32x16_bf16 v[48:63], v[104:107], v[28:31], v[48:63]
    ds_read_b128 v[104:107], v10 offset:16384
    s_waitcnt vmcnt(8)
    v_bitop3_b32 v12, v32, v36, v40 bitop3:0x80
    v_and_b32 v12, v12, v44
    v_cmp_le_i32 vcc, 0, v12
    s_waitcnt lgkmcnt(3)
    v_mfma_f32_32x32x16_bf16 v[64:79], v[108:111], v[28:31], v[64:79]
    ds_read_b128 v[108:111], v10 offset:17408
    s_cbranch_vccnz slow_h1_06_79
ok_h1_06_80:
    s_waitcnt lgkmcnt(3)
    v_mfma_f32_32x32x16_bf16 v[48:63], v[96:99], v[32:35], v[48:63]
    ds_read_b128 v[96:99], v10 offset:18432
    s_waitcnt lgkmcnt(3)
    v_mfma_f32_32x32x16_bf16 v[64:79], v[100:103], v[32:35], v[64:79]
    ds_read_b128 v[100:103], v10 offset:19456
    s_waitcnt lgkmcnt(3)
    v_mfma_f32_32x32x16_bf16 v[48:63], v[104:107], v[36:39], v[48:63]
    ds_read_b128 v[104:107], v10 offset:20480
    s_waitcnt lgkmcnt(3)
    v_mfma_f32_32x32x16_bf16 v[64:79], v[108:111], v[36:39], v[64:79]
    ds_read_b128 v[108:111], v10 offset:21504
    s_waitcnt lgkmcnt(3)
    v_mfma_f32_32x32x16_bf16 v[48:63], v[96:99], v[40:43], v[48:63]
    s_waitcnt lgkmcnt(2)
    v_mfma_f32_32x32x16_bf16 v[64:79], v[100:103], v[40:43], v[64:79]
    s_waitcnt lgkmcnt(1)
    v_mfma_f32_32x32x16_bf16 v[48:63], v[104:107], v[44:47], v[48:63]
    s_waitcnt lgkmcnt(0)
    v_mfma_f32_32x32x16_bf16 v[64:79], v[108:111], v[44:47], v[64:79]
    v_mfma_f32_32x32x16_bf16 v[16:31], a[224:227], v[112:115], 0
    v_mfma_f32_32x32x16_bf16 v[32:47], a[228:231], v[112:115], 0
    buffer_load_dwordx4 v[112:115], v8, s[24:27], s63 offen offset:0 sc1
    v_mfma_f32_32x32x16_bf16 v[16:31], a[232:235], v[116:119], v[16:31]
    ds_read_b32 v7, v14 offset:64516
    v_mfma_f32_32x32x16_bf16 v[32:47], a[236:239], v[116:119], v[32:47]
    buffer_load_dwordx4 v[116:119], v8, s[24:27], s63 offen offset:1024 sc1
    s_nop 2
    ds_write_b128 v9, v[48:51] offset:28672
    v_mfma_f32_32x32x16_bf16 v[16:31], a[240:243], v[120:123], v[16:31]
    v_mfma_f32_32x32x16_bf16 v[32:47], a[244:247], v[120:123], v[32:47]
    buffer_load_dwordx4 v[120:123], v8, s[24:27], s63 offen offset:2048 sc1
    ds_write_b128 v9, v[52:55] offset:29760
    v_mfma_f32_32x32x16_bf16 v[16:31], a[248:251], v[124:127], v[16:31]
    s_waitcnt vmcnt(7)
    v_bitop3_b32 v12, v128, v132, v136 bitop3:0x80
    v_and_b32 v12, v12, v140
    v_cmp_le_i32 vcc, 0, v12
    v_mfma_f32_32x32x16_bf16 v[32:47], a[252:255], v[124:127], v[32:47]
    buffer_load_dwordx4 v[124:127], v8, s[24:27], s63 offen offset:3072 sc1
    ds_write_b128 v9, v[56:59] offset:30848
    s_cbranch_vccnz slow_h1_11_81
ok_h1_11_82:
    v_mfma_f32_32x32x16_bf16 v[16:31], v[152:155], v[128:131], v[16:31]
    v_mfma_f32_32x32x16_bf16 v[32:47], v[156:159], v[128:131], v[32:47]
    buffer_load_dwordx4 v[128:131], v8, s[24:27], s64 offen offset:0 sc1
    ds_write_b128 v9, v[60:63] offset:31936
    v_mfma_f32_32x32x16_bf16 v[16:31], v[160:163], v[132:135], v[16:31]
    v_mfma_f32_32x32x16_bf16 v[32:47], v[164:167], v[132:135], v[32:47]
    buffer_load_dwordx4 v[132:135], v8, s[24:27], s64 offen offset:1024 sc1
    ds_write_b128 v9, v[64:67] offset:33024
    v_mfma_f32_32x32x16_bf16 v[16:31], v[168:171], v[136:139], v[16:31]
    v_mfma_f32_32x32x16_bf16 v[32:47], v[172:175], v[136:139], v[32:47]
    buffer_load_dwordx4 v[136:139], v8, s[24:27], s64 offen offset:2048 sc1
    ds_write_b128 v9, v[68:71] offset:34112
    v_mfma_f32_32x32x16_bf16 v[16:31], v[176:179], v[140:143], v[16:31]
    s_waitcnt vmcnt(7)
    v_bitop3_b32 v12, v80, v84, v88 bitop3:0x80
    v_and_b32 v12, v12, v92
    v_cmp_le_i32 vcc, 0, v12
    v_mfma_f32_32x32x16_bf16 v[32:47], v[180:183], v[140:143], v[32:47]
    buffer_load_dwordx4 v[140:143], v8, s[24:27], s64 offen offset:3072 sc1
    ds_write_b128 v9, v[72:75] offset:35200
    s_cbranch_vccnz slow_h1_12_83
ok_h1_12_84:
    v_mfma_f32_32x32x16_bf16 v[16:31], v[184:187], v[80:83], v[16:31]
    v_mfma_f32_32x32x16_bf16 v[32:47], v[188:191], v[80:83], v[32:47]
    buffer_load_dwordx4 v[80:83], v8, s[24:27], s65 offen offset:0 sc1
    ds_write_b128 v9, v[76:79] offset:36288
    v_mfma_f32_32x32x16_bf16 v[16:31], v[192:195], v[84:87], v[16:31]
    v_mfma_f32_32x32x16_bf16 v[32:47], v[196:199], v[84:87], v[32:47]
    buffer_load_dwordx4 v[84:87], v8, s[24:27], s65 offen offset:1024 sc1
    s_waitcnt lgkmcnt(0)
    s_barrier
    v_mfma_f32_32x32x16_bf16 v[16:31], v[200:203], v[88:91], v[16:31]
    ds_read_b128 v[48:51], v13 offset:28672
    ds_read_b128 v[52:55], v13 offset:29184
    v_mfma_f32_32x32x16_bf16 v[32:47], v[204:207], v[88:91], v[32:47]
    buffer_load_dwordx4 v[88:91], v8, s[24:27], s65 offen offset:2048 sc1
    ds_read_b128 v[56:59], v13 offset:37376
    ds_read_b128 v[60:63], v13 offset:37888
    v_mfma_f32_32x32x16_bf16 v[16:31], v[208:211], v[92:95], v[16:31]
    ds_read_b128 v[64:67], v13 offset:46080
    ds_read_b128 v[68:71], v13 offset:46592
    s_waitcnt vmcnt(7)
    v_bitop3_b32 v12, v112, v116, v120 bitop3:0x80
    v_and_b32 v12, v12, v124
    v_cmp_le_i32 vcc, 0, v12
    v_mfma_f32_32x32x16_bf16 v[32:47], v[212:215], v[92:95], v[32:47]
    buffer_load_dwordx4 v[92:95], v8, s[24:27], s65 offen offset:3072 sc1
    ds_read_b128 v[72:75], v13 offset:54784
    ds_read_b128 v[76:79], v13 offset:55296
    s_cbranch_vccnz slow_h1_13_85
ok_h1_13_86:
    v_mfma_f32_32x32x16_bf16 v[16:31], v[216:219], v[112:115], v[16:31]
    v_mfma_f32_32x32x16_bf16 v[32:47], v[220:223], v[112:115], v[32:47]
    buffer_load_dwordx4 v[112:115], v8, s[24:27], s66 offen offset:0 sc1
    s_waitcnt lgkmcnt(4)
    v_add_f32 v48, v48, v56
    v_add_f32 v49, v49, v57
    v_add_f32 v50, v50, v58
    v_mfma_f32_32x32x16_bf16 v[16:31], v[224:227], v[116:119], v[16:31]
    v_add_f32 v51, v51, v59
    v_add_f32 v52, v52, v60
    v_add_f32 v53, v53, v61
    v_add_f32 v54, v54, v62
    v_add_f32 v55, v55, v63
    s_waitcnt lgkmcnt(2)
    v_mfma_f32_32x32x16_bf16 v[32:47], v[228:231], v[116:119], v[32:47]
    buffer_load_dwordx4 v[116:119], v8, s[24:27], s66 offen offset:1024 sc1
    v_add_f32 v48, v48, v64
    v_add_f32 v49, v49, v65
    v_add_f32 v50, v50, v66
    v_add_f32 v51, v51, v67
    v_mfma_f32_32x32x16_bf16 v[16:31], v[232:235], v[120:123], v[16:31]
    v_add_f32 v52, v52, v68
    v_add_f32 v53, v53, v69
    v_add_f32 v54, v54, v70
    v_add_f32 v55, v55, v71
    s_waitcnt lgkmcnt(0)
    v_mfma_f32_32x32x16_bf16 v[32:47], v[236:239], v[120:123], v[32:47]
    buffer_load_dwordx4 v[120:123], v8, s[24:27], s66 offen offset:2048 sc1
    v_add_f32 v48, v48, v72
    v_add_f32 v49, v49, v73
    v_add_f32 v50, v50, v74
    v_add_f32 v51, v51, v75
    v_mfma_f32_32x32x16_bf16 v[16:31], v[240:243], v[124:127], v[16:31]
    ds_read_b128 v[104:107], v10 offset:0
    v_add_f32 v52, v52, v76
    v_add_f32 v53, v53, v77
    s_waitcnt vmcnt(7)
    v_bitop3_b32 v12, v128, v132, v136 bitop3:0x80
    v_and_b32 v12, v12, v140
    v_cmp_le_i32 vcc, 0, v12
    v_mfma_f32_32x32x16_bf16 v[32:47], v[244:247], v[124:127], v[32:47]
    ds_read_b128 v[108:111], v10 offset:1024
    buffer_load_dwordx4 v[124:127], v8, s[24:27], s66 offen offset:3072 sc1
    v_add_f32 v54, v54, v78
    v_add_f32 v55, v55, v79
    s_cbranch_vccnz slow_h1_14_87
ok_h1_14_88:
    v_mfma_f32_32x32x16_bf16 v[16:31], v[248:251], v[128:131], v[16:31]
    ds_read_b128 v[96:99], v10 offset:2048
    v_lshlrev_b32 v56, 16, v144
    v_and_b32 v57, s69, v144
    v_lshlrev_b32 v58, 16, v145
    v_and_b32 v59, s69, v145
    v_mfma_f32_32x32x16_bf16 v[32:47], v[252:255], v[128:131], v[32:47]
    ds_read_b128 v[100:103], v10 offset:3072
    v_lshlrev_b32 v60, 16, v146
    v_and_b32 v61, s69, v146
    v_lshlrev_b32 v62, 16, v147
    v_and_b32 v63, s69, v147
    s_waitcnt lgkmcnt(3)
    v_mfma_f32_32x32x16_bf16 v[16:31], v[104:107], v[132:135], v[16:31]
    ds_read_b128 v[104:107], v10 offset:4096
    v_fma_f32 v48, -v7, v48, v56
    v_fma_f32 v49, -v7, v49, v57
    v_fma_f32 v50, -v7, v50, v58
    v_fma_f32 v51, -v7, v51, v59
    s_waitcnt lgkmcnt(3)
    v_mfma_f32_32x32x16_bf16 v[32:47], v[108:111], v[132:135], v[32:47]
    ds_read_b128 v[108:111], v10 offset:5120
    v_fma_f32 v52, -v7, v52, v60
    v_fma_f32 v53, -v7, v53, v61
    v_fma_f32 v54, -v7, v54, v62
    v_fma_f32 v55, -v7, v55, v63
    s_waitcnt lgkmcnt(3)
    v_mfma_f32_32x32x16_bf16 v[16:31], v[96:99], v[136:139], v[16:31]
    ds_read_b128 v[96:99], v10 offset:6144
    v_cvt_pk_bf16_f32 v144, v48, v49
    v_cvt_pk_bf16_f32 v145, v50, v51
    v_cvt_pk_bf16_f32 v146, v52, v53
    v_cvt_pk_bf16_f32 v147, v54, v55
    s_waitcnt lgkmcnt(3)
    v_mfma_f32_32x32x16_bf16 v[32:47], v[100:103], v[136:139], v[32:47]
    ds_read_b128 v[100:103], v10 offset:8192
L_pad8:
    s_cbranch_execz L_ret1
    buffer_store_dwordx4 v[144:147], v15, s[20:23], s56 offen sc1
    s_waitcnt lgkmcnt(3)
    v_mfma_f32_32x32x16_bf16 v[16:31], v[104:107], v[140:143], v[16:31]
    ds_read_b128 v[104:107], v10 offset:10240
    s_waitcnt vmcnt(5)
    v_bitop3_b32 v12, v80, v84, v88 bitop3:0x80
    v_and_b32 v12, v12, v92
    v_cmp_le_i32 vcc, 0, v12
    s_waitcnt lgkmcnt(3)
    v_mfma_f32_32x32x16_bf16 v[32:47], v[108:111], v[140:143], v[32:47]
    ds_read_b128 v[108:111], v10 offset:12288
    s_cbranch_vccnz slow_h1_15_89
ok_h1_15_90:
    s_waitcnt lgkmcnt(3)
    v_mfma_f32_32x32x16_bf16 v[16:31], v[96:99], v[80:83], v[16:31]
    ds_read_b128 v[96:99], v10 offset:14336
    s_barrier
    ds_read_b32 v7, v14 offset:64772
    s_waitcnt lgkmcnt(4)
    v_mfma_f32_32x32x16_bf16 v[16:31], v[100:103], v[84:87], v[16:31]
    ds_read_b128 v[100:103], v10 offset:16384
    s_waitcnt lgkmcnt(4)
    v_mfma_f32_32x32x16_bf16 v[16:31], v[104:107], v[88:91], v[16:31]
    ds_read_b128 v[104:107], v10 offset:18432
    s_waitcnt vmcnt(1)
    v_bitop3_b32 v12, v112, v116, v120 bitop3:0x80
    v_and_b32 v12, v12, v124
    v_cmp_le_i32 vcc, 0, v12
    s_waitcnt lgkmcnt(4)
    v_mfma_f32_32x32x16_bf16 v[16:31], v[108:111], v[92:95], v[16:31]
    ds_read_b128 v[108:111], v10 offset:20480
    s_cbranch_vccnz slow_h1_16_91
ok_h1_16_92:
    s_waitcnt lgkmcnt(4)
    v_mfma_f32_32x32x16_bf16 v[16:31], v[96:99], v[112:115], v[16:31]
    ds_read_b128 v[96:99], v10 offset:7168
    s_waitcnt lgkmcnt(3)
    v_mfma_f32_32x32x16_bf16 v[16:31], v[100:103], v[116:119], v[16:31]
    ds_read_b128 v[100:103], v10 offset:9216
    s_waitcnt lgkmcnt(3)
    v_mfma_f32_32x32x16_bf16 v[16:31], v[104:107], v[120:123], v[16:31]
    ds_read_b128 v[104:107], v10 offset:11264
    s_waitcnt lgkmcnt(3)
    v_mfma_f32_32x32x16_bf16 v[16:31], v[108:111], v[124:127], v[16:31]
    ds_read_b128 v[108:111], v10 offset:13312
    v_lshlrev_b32 v128, 16, v148
    v_and_b32 v129, s69, v148
    v_lshlrev_b32 v130, 16, v149
    v_and_b32 v131, s69, v149
    s_waitcnt lgkmcnt(3)
    v_mfma_f32_32x32x16_bf16 v[32:47], v[96:99], v[80:83], v[32:47]
    ds_read_b128 v[96:99], v10 offset:15360
    v_lshlrev_b32 v132, 16, v150
    v_and_b32 v133, s69, v150
    v_lshlrev_b32 v134, 16, v151
    v_and_b32 v135, s69, v151
    s_waitcnt lgkmcnt(3)
    v_mfma_f32_32x32x16_bf16 v[32:47], v[100:103], v[84:87], v[32:47]
    ds_read_b128 v[100:103], v10 offset:17408
    ds_write_b128 v9, v[16:19] offset:28672
    s_waitcnt lgkmcnt(4)
    v_mfma_f32_32x32x16_bf16 v[32:47], v[104:107], v[88:91], v[32:47]
    ds_read_b128 v[104:107], v10 offset:19456
    s_waitcnt lgkmcnt(4)
    v_mfma_f32_32x32x16_bf16 v[32:47], v[108:111], v[92:95], v[32:47]
    ds_read_b128 v[108:111], v10 offset:21504
    ds_write_b128 v9, v[20:23] offset:29760
    s_waitcnt lgkmcnt(5)
    v_mfma_f32_32x32x16_bf16 v[32:47], v[96:99], v[112:115], v[32:47]
    s_waitcnt lgkmcnt(4)
    v_mfma_f32_32x32x16_bf16 v[32:47], v[100:103], v[116:119], v[32:47]
    ds_write_b128 v9, v[24:27] offset:30848
    s_waitcnt lgkmcnt(3)
    v_mfma_f32_32x32x16_bf16 v[32:47], v[104:107], v[120:123], v[32:47]
    s_waitcnt lgkmcnt(2)
    v_mfma_f32_32x32x16_bf16 v[32:47], v[108:111], v[124:127], v[32:47]
    ds_write_b128 v9, v[28:31] offset:31936
    s_nop 10
    ds_write_b128 v9, v[32:35] offset:33024
    ds_write_b128 v9, v[36:39] offset:34112
    ds_write_b128 v9, v[40:43] offset:35200
    ds_write_b128 v9, v[44:47] offset:36288
    s_waitcnt lgkmcnt(0)
    s_barrier
    ds_read_b128 v[48:51], v13 offset:28672
    ds_read_b128 v[52:55], v13 offset:29184
    ds_read_b128 v[56:59], v13 offset:37376
    ds_read_b128 v[60:63], v13 offset:37888
    ds_read_b128 v[64:67], v13 offset:46080
    ds_read_b128 v[68:71], v13 offset:46592
    ds_read_b128 v[72:75], v13 offset:54784
    ds_read_b128 v[76:79], v13 offset:55296
    s_waitcnt lgkmcnt(4)
    v_pk_add_f32 v[48:49], v[48:49], v[56:57]
    v_pk_add_f32 v[50:51], v[50:51], v[58:59]
    v_pk_add_f32 v[52:53], v[52:53], v[60:61]
    v_pk_add_f32 v[54:55], v[54:55], v[62:63]
    s_waitcnt lgkmcnt(0)
    v_pk_add_f32 v[64:65], v[64:65], v[72:73]
    v_pk_add_f32 v[66:67], v[66:67], v[74:75]
    v_pk_add_f32 v[68:69], v[68:69], v[76:77]
    v_pk_add_f32 v[70:71], v[70:71], v[78:79]
    v_pk_add_f32 v[48:49], v[48:49], v[64:65]
    v_pk_add_f32 v[50:51], v[50:51], v[66:67]
    v_pk_add_f32 v[52:53], v[52:53], v[68:69]
    v_pk_add_f32 v[54:55], v[54:55], v[70:71]
    v_pk_fma_f32 v[48:49], v[48:49], v[6:7], v[128:129] op_sel:[0,1,0] neg_lo:[1,0,0] neg_hi:[1,0,0]
    v_pk_fma_f32 v[50:51], v[50:51], v[6:7], v[130:131] op_sel:[0,1,0] neg_lo:[1,0,0] neg_hi:[1,0,0]
    v_pk_fma_f32 v[52:53], v[52:53], v[6:7], v[132:133] op_sel:[0,1,0] neg_lo:[1,0,0] neg_hi:[1,0,0]
    v_pk_fma_f32 v[54:55], v[54:55], v[6:7], v[134:135] op_sel:[0,1,0] neg_lo:[1,0,0] neg_hi:[1,0,0]
    v_cvt_pk_bf16_f32 v148, v48, v49
    v_cvt_pk_bf16_f32 v149, v50, v51
    v_cvt_pk_bf16_f32 v150, v52, v53
    v_cvt_pk_bf16_f32 v151, v54, v55
    buffer_store_dwordx4 v[148:151], v15, s[20:23], s57 offen sc1
    s_endpgm
L_hrest:
    s_sub_u32 s42, s2, 28
    s_lshl_b32 s42, s42, 2
    s_add_u32 s42, s42, s32
    s_mul_i32 s42, s42, 112
    v_min_u32 v2, 55, v0
    v_add_u32 v4, s42, v2
    v_add_u32 v4, 0, v4
    v_lshrrev_b32 v8, 8, v4
    v_add_u32 v8, 1, v8
    v_subrev_u32 v9, 7, v8
    v_min_u32 v8, v8, v9
    v_mul_u32_u24 v4, 896, v4
    v_lshl_add_u32 v4, v8, 7, v4
    buffer_load_dword v144, v4, s[16:19], 0 offen
    v_add_u32 v4, s42, v2
    v_add_u32 v4, 56, v4
    v_lshrrev_b32 v8, 8, v4
    v_add_u32 v8, 1, v8
    v_subrev_u32 v9, 7, v8
    v_min_u32 v8, v8, v9
    v_mul_u32_u24 v4, 896, v4
    v_lshl_add_u32 v4, v8, 7, v4
    buffer_load_dword v144, v4, s[16:19], 0 offen
    s_sub_u32 s42, s2, 28
    s_mul_i32 s42, s42, 229376
    s_add_u32 s42, s42, 1835008
    s_mov_b32 s43, 28
    s_waitcnt vmcnt(0)
    s_branch L_hfill2
L_helper2:
    v_lshrrev_b32 v6, 3, v0
    v_lshrrev_b32 v7, 2, v0
    v_and_b32 v7, 4, v7
    v_xor_b32 v7, v7, v0
    v_and_b32 v7, 7, v7
    v_mul_u32_u24 v6, 896, v6
    v_lshl_add_u32 v6, v7, 4, v6
    v_add_u32 v7, 6144, v6
    s_mov_b32 s37, s68
    v_bfe_u32 v12, v0, 2, 2
    v_bfe_u32 v13, v0, 3, 1
    v_bfe_u32 v14, v0, 4, 1
    v_and_b32 v15, 3, v0
    v_lshlrev_b32 v12, 7, v12
    v_lshl_add_u32 v12, v13, 6, v12
    v_lshl_add_u32 v12, v14, 5, v12
    v_lshl_add_u32 v12, v15, 3, v12
    v_add_u32 v12, s37, v12
    v_lshrrev_b32 v13, 5, v0
    v_lshl_add_u32 v8, v13, 10, v12
    v_xor_b32 v9, 64, v8
    s_mul_i32 s37, s32, 22528
    s_add_u32 s37, s37, 73728
    v_bfe_u32 v12, v0, 2, 2
    v_bfe_u32 v13, v0, 3, 1
    v_bfe_u32 v14, v0, 4, 1
    v_and_b32 v15, 3, v0
    v_lshlrev_b32 v12, 7, v12
    v_lshl_add_u32 v12, v13, 6, v12
    v_lshl_add_u32 v12, v14, 5, v12
    v_lshl_add_u32 v12, v15, 3, v12
    v_add_u32 v12, s37, v12
    v_lshrrev_b32 v13, 5, v0
    v_lshl_add_u32 v10, v13, 9, v12
    v_xor_b32 v11, 64, v10
    s_lshl_b32 s42, s2, 2
    s_add_u32 s42, s42, s32
    s_mul_i32 s42, s42, 14336
    s_lshr_b32 s43, s2, 2
    s_mov_b32 s67, s42
    s_mov_b32 s68, s43
    s_add_u32 m0, s37, 0
    s_lshl_b32 s44, s68, 7
    s_add_u32 s44, s44, s67
    buffer_load_dwordx4 v6, s[16:19], s44 offen lds
    buffer_load_dwordx4 v7, s[16:19], s44 offen offset:1024 lds
    s_sub_u32 s68, s68, 1
    s_min_u32 s68, s68, 6
    s_add_u32 m0, s37, 2048
    s_lshl_b32 s44, s68, 7
    s_add_u32 s44, s44, s67
    buffer_load_dwordx4 v6, s[16:19], s44 offen lds
    buffer_load_dwordx4 v7, s[16:19], s44 offen offset:1024 lds
    s_sub_u32 s68, s68, 1
    s_min_u32 s68, s68, 6
    s_add_u32 m0, s37, 4096
    s_lshl_b32 s44, s68, 7
    s_add_u32 s44, s44, s67
    buffer_load_dwordx4 v6, s[16:19], s44 offen lds
    buffer_load_dwordx4 v7, s[16:19], s44 offen offset:1024 lds
    s_waitcnt vmcnt(6)
    ds_read_b64_tr_b16 v[16:17], v8 offset:0
    ds_read_b64_tr_b16 v[18:19], v8 offset:512
    ds_read_b64_tr_b16 v[20:21], v9 offset:0
    ds_read_b64_tr_b16 v[22:23], v9 offset:512
    ds_read_b64_tr_b16 v[24:25], v8 offset:2048
    ds_read_b64_tr_b16 v[26:27], v8 offset:2560
    ds_read_b64_tr_b16 v[28:29], v9 offset:2048
    ds_read_b64_tr_b16 v[30:31], v9 offset:2560
    ds_read_b64_tr_b16 v[32:33], v8 offset:4096
    ds_read_b64_tr_b16 v[34:35], v8 offset:4608
    ds_read_b64_tr_b16 v[36:37], v9 offset:4096
    ds_read_b64_tr_b16 v[38:39], v9 offset:4608
    ds_read_b64_tr_b16 v[40:41], v8 offset:6144
    ds_read_b64_tr_b16 v[42:43], v8 offset:6656
    ds_read_b64_tr_b16 v[44:45], v9 offset:6144
    ds_read_b64_tr_b16 v[46:47], v9 offset:6656
    ds_read_b64_tr_b16 v[48:49], v8 offset:8192
    ds_read_b64_tr_b16 v[50:51], v8 offset:8704
    ds_read_b64_tr_b16 v[52:53], v9 offset:8192
    ds_read_b64_tr_b16 v[54:55], v9 offset:8704
    ds_read_b64_tr_b16 v[56:57], v8 offset:10240
    ds_read_b64_tr_b16 v[58:59], v8 offset:10752
    ds_read_b64_tr_b16 v[60:61], v9 offset:10240
    ds_read_b64_tr_b16 v[62:63], v9 offset:10752
    ds_read_b64_tr_b16 v[64:65], v8 offset:12288
    ds_read_b64_tr_b16 v[66:67], v8 offset:12800
    ds_read_b64_tr_b16 v[68:69], v9 offset:12288
    ds_read_b64_tr_b16 v[70:71], v9 offset:12800
    s_mul_i32 s42, s2, 73728
    s_lshl_b32 s43, s32, 11
    s_add_u32 s42, s42, s43
    s_add_u32 s42, s42, 12976128
    s_mov_b32 s46, 0x3f803f80
    v_mov_b32 v72, 0
    v_mov_b32 v73, 0
    s_waitcnt lgkmcnt(0)
    buffer_store_dwordx4 v[56:59], v1, s[24:27], s42 offen offset:0 sc1
    buffer_store_dwordx4 v[60:63], v1, s[24:27], s42 offen offset:1024 sc1
    s_add_u32 s42, s42, 8192
    buffer_store_dwordx4 v[64:67], v1, s[24:27], s42 offen offset:0 sc1
    buffer_store_dwordx4 v[68:71], v1, s[24:27], s42 offen offset:1024 sc1
    s_add_u32 s42, s42, 8192
    v_dot2c_f32_bf16 v72, s46, v16
    v_dot2c_f32_bf16 v73, s46, v20
    v_dot2c_f32_bf16 v72, s46, v17
    v_dot2c_f32_bf16 v73, s46, v21
    v_dot2c_f32_bf16 v72, s46, v18
    v_dot2c_f32_bf16 v73, s46, v22
    v_dot2c_f32_bf16 v72, s46, v19
    v_dot2c_f32_bf16 v73, s46, v23
    v_dot2c_f32_bf16 v72, s46, v24
    v_dot2c_f32_bf16 v73, s46, v28
    v_dot2c_f32_bf16 v72, s46, v25
    v_dot2c_f32_bf16 v73, s46, v29
    v_dot2c_f32_bf16 v72, s46, v26
    v_dot2c_f32_bf16 v73, s46, v30
    v_dot2c_f32_bf16 v72, s46, v27
    v_dot2c_f32_bf16 v73, s46, v31
    v_dot2c_f32_bf16 v72, s46, v32
    v_dot2c_f32_bf16 v73, s46, v36
    v_dot2c_f32_bf16 v72, s46, v33
    v_dot2c_f32_bf16 v73, s46, v37
    v_dot2c_f32_bf16 v72, s46, v34
    v_dot2c_f32_bf16 v73, s46, v38
    v_dot2c_f32_bf16 v72, s46, v35
    v_dot2c_f32_bf16 v73, s46, v39
    v_dot2c_f32_bf16 v72, s46, v40
    v_dot2c_f32_bf16 v73, s46, v44
    v_dot2c_f32_bf16 v72, s46, v41
    v_dot2c_f32_bf16 v73, s46, v45
    v_dot2c_f32_bf16 v72, s46, v42
    v_dot2c_f32_bf16 v73, s46, v46
    v_dot2c_f32_bf16 v72, s46, v43
    v_dot2c_f32_bf16 v73, s46, v47
    v_dot2c_f32_bf16 v72, s46, v48
    v_dot2c_f32_bf16 v73, s46, v52
    v_dot2c_f32_bf16 v72, s46, v49
    v_dot2c_f32_bf16 v73, s46, v53
    v_dot2c_f32_bf16 v72, s46, v50
    v_dot2c_f32_bf16 v73, s46, v54
    v_dot2c_f32_bf16 v72, s46, v51
    v_dot2c_f32_bf16 v73, s46, v55
    v_dot2c_f32_bf16 v72, s46, v56
    v_dot2c_f32_bf16 v73, s46, v60
    v_dot2c_f32_bf16 v72, s46, v57
    v_dot2c_f32_bf16 v73, s46, v61
    v_dot2c_f32_bf16 v72, s46, v58
    v_dot2c_f32_bf16 v73, s46, v62
    v_dot2c_f32_bf16 v72, s46, v59
    v_dot2c_f32_bf16 v73, s46, v63
    v_dot2c_f32_bf16 v72, s46, v64
    v_dot2c_f32_bf16 v73, s46, v68
    v_dot2c_f32_bf16 v72, s46, v65
    v_dot2c_f32_bf16 v73, s46, v69
    v_dot2c_f32_bf16 v72, s46, v66
    v_dot2c_f32_bf16 v73, s46, v70
    v_dot2c_f32_bf16 v72, s46, v67
    v_dot2c_f32_bf16 v73, s46, v71
    v_lshlrev_b32 v4, 2, v0
    v_add_u32 v4, 65536, v4
    s_lshl_b32 s42, s32, 8
    v_add_u32 v2, s42, v4
    v_permlane32_swap_b32 v72, v73
    v_add_f32 v72, v72, v73
    ds_write_b32 v2, v72
    s_waitcnt lgkmcnt(0)
    s_barrier
    ds_read2st64_b32 v[72:73], v4 offset0:0 offset1:1
    ds_read2st64_b32 v[74:75], v4 offset0:2 offset1:3
    v_and_b32 v76, 0x1f0, v1
    v_lshrrev_b32 v2, 5, v0
    v_lshl_add_u32 v76, v2, 3, v76
    s_lshl_b32 s42, s2, 9
    s_add_u32 s42, s42, 15040512
    s_waitcnt lgkmcnt(0)
    v_add_f32 v72, v72, v73
    v_add_f32 v74, v74, v75
    v_add_f32 v72, v72, v74
    v_cvt_pk_bf16_f32 v73, v72, v72
    v_and_b32 v74, 0xffff0000, v73
    v_sub_f32 v75, v72, v74
    v_cvt_pk_bf16_f32 v78, v74, v75
    v_and_b32 v79, 0xffff, v73
    s_cmp_lg_u32 s32, 0
    s_cbranch_scc1 L_hnocs
    buffer_store_dwordx2 v[78:79], v76, s[24:27], s42 offen sc1
L_hnocs:
    s_and_b32 s42, s2, 3
    s_mul_i32 s42, s42, 73728
    s_lshl_b32 s43, s32, 11
    s_add_u32 s42, s42, s43
    s_add_u32 s42, s42, 12992512
    s_lshr_b32 s43, s2, 2
    s_mov_b32 s46, 0x80008000
    s_lshl_b32 s47, s2, 7
    s_add_u32 s47, s47, 15056896
    v_not_b32 v5, v140
    s_waitcnt vmcnt(0)
    s_barrier
    s_cmp_lg_u32 s32, 0
    s_cbranch_scc1 L_hsig0
    v_lshlrev_b32 v145, 2, v0
    s_mov_b32 exec_hi, 0
    buffer_store_dword v5, v145, s[24:27], s47 offen sc1
    s_mov_b32 exec_hi, -1
L_hsig0:
    s_add_u32 s47, s47, 4096
    s_waitcnt vmcnt(32)
    ds_read_b64_tr_b16 v[80:81], v10 offset:0
    ds_read_b64_tr_b16 v[82:83], v10 offset:1024
    ds_read_b64_tr_b16 v[84:85], v11 offset:0
    ds_read_b64_tr_b16 v[86:87], v11 offset:1024
    s_waitcnt vmcnt(30)
    ds_read_b64_tr_b16 v[88:89], v10 offset:2048
    ds_read_b64_tr_b16 v[90:91], v10 offset:3072
    ds_read_b64_tr_b16 v[92:93], v11 offset:2048
    ds_read_b64_tr_b16 v[94:95], v11 offset:3072
    s_waitcnt vmcnt(28)
    ds_read_b64_tr_b16 v[96:97], v10 offset:4096
    ds_read_b64_tr_b16 v[98:99], v10 offset:5120
    ds_read_b64_tr_b16 v[100:101], v11 offset:4096
    ds_read_b64_tr_b16 v[102:103], v11 offset:5120
    s_waitcnt lgkmcnt(0)
    s_mul_i32 s44, s43, 294912
    s_add_u32 s44, s44, s42
    v_xor_b32 v83, s46, v83
    buffer_store_dwordx4 v[80:83], v1, s[24:27], s44 offen offset:0 sc1
    v_xor_b32 v87, s46, v87
    buffer_store_dwordx4 v[84:87], v1, s[24:27], s44 offen offset:1024 sc1
    s_sub_u32 s43, s43, 1
    s_min_u32 s43, s43, 6
    s_add_u32 s42, s42, 8192
    s_mul_i32 s44, s43, 294912
    s_add_u32 s44, s44, s42
    v_xor_b32 v91, s46, v91
    buffer_store_dwordx4 v[88:91], v1, s[24:27], s44 offen offset:0 sc1
    v_xor_b32 v95, s46, v95
    buffer_store_dwordx4 v[92:95], v1, s[24:27], s44 offen offset:1024 sc1
    s_sub_u32 s43, s43, 1
    s_min_u32 s43, s43, 6
    s_add_u32 s42, s42, 8192
    s_mul_i32 s44, s43, 294912
    s_add_u32 s44, s44, s42
    v_xor_b32 v99, s46, v99
    buffer_store_dwordx4 v[96:99], v1, s[24:27], s44 offen offset:0 sc1
    v_xor_b32 v103, s46, v103
    buffer_store_dwordx4 v[100:103], v1, s[24:27], s44 offen offset:1024 sc1
    s_sub_u32 s68, s68, 1
    s_min_u32 s68, s68, 6
    s_add_u32 m0, s37, 6144
    s_lshl_b32 s44, s68, 7
    s_add_u32 s44, s44, s67
    buffer_load_dwordx4 v6, s[16:19], s44 offen lds
    buffer_load_dwordx4 v7, s[16:19], s44 offen offset:1024 lds
    s_sub_u32 s68, s68, 1
    s_min_u32 s68, s68, 6
    s_add_u32 m0, s37, 8192
    s_lshl_b32 s44, s68, 7
    s_add_u32 s44, s44, s67
    buffer_load_dwordx4 v6, s[16:19], s44 offen lds
    buffer_load_dwordx4 v7, s[16:19], s44 offen offset:1024 lds
    s_sub_u32 s68, s68, 1
    s_min_u32 s68, s68, 6
    s_add_u32 m0, s37, 10240
    s_lshl_b32 s44, s68, 7
    s_add_u32 s44, s44, s67
    buffer_load_dwordx4 v6, s[16:19], s44 offen lds
    buffer_load_dwordx4 v7, s[16:19], s44 offen offset:1024 lds
    s_sub_u32 s68, s68, 1
    s_min_u32 s68, s68, 6
    s_add_u32 m0, s37, 12288
    s_lshl_b32 s44, s68, 7
    s_add_u32 s44, s44, s67
    buffer_load_dwordx4 v6, s[16:19], s44 offen lds
    buffer_load_dwordx4 v7, s[16:19], s44 offen offset:1024 lds
    s_waitcnt vmcnt(8)
    s_barrier
    s_cmp_lg_u32 s32, 0
    s_cbranch_scc1 L_hsig1
    v_lshlrev_b32 v145, 2, v0
    s_mov_b32 exec_hi, 0
    buffer_store_dword v5, v145, s[24:27], s47 offen sc1
    s_mov_b32 exec_hi, -1
L_hsig1:
    s_add_u32 s47, s47, 4096
    s_waitcnt vmcnt(6)
    ds_read_b64_tr_b16 v[104:105], v10 offset:6144
    ds_read_b64_tr_b16 v[106:107], v10 offset:7168
    ds_read_b64_tr_b16 v[108:109], v11 offset:6144
    ds_read_b64_tr_b16 v[110:111], v11 offset:7168
    s_waitcnt vmcnt(4)
    ds_read_b64_tr_b16 v[112:113], v10 offset:8192
    ds_read_b64_tr_b16 v[114:115], v10 offset:9216
    ds_read_b64_tr_b16 v[116:117], v11 offset:8192
    ds_read_b64_tr_b16 v[118:119], v11 offset:9216
    s_waitcnt vmcnt(2)
    ds_read_b64_tr_b16 v[120:121], v10 offset:10240
    ds_read_b64_tr_b16 v[122:123], v10 offset:11264
    ds_read_b64_tr_b16 v[124:125], v11 offset:10240
    ds_read_b64_tr_b16 v[126:127], v11 offset:11264
    s_waitcnt vmcnt(0)
    ds_read_b64_tr_b16 v[128:129], v10 offset:12288
    ds_read_b64_tr_b16 v[130:131], v10 offset:13312
    ds_read_b64_tr_b16 v[132:133], v11 offset:12288
    ds_read_b64_tr_b16 v[134:135], v11 offset:13312
    s_waitcnt lgkmcnt(0)
    s_sub_u32 s43, s43, 1
    s_min_u32 s43, s43, 6
    s_add_u32 s42, s42, 8192
    s_mul_i32 s44, s43, 294912
    s_add_u32 s44, s44, s42
    v_xor_b32 v107, s46, v107
    buffer_store_dwordx4 v[104:107], v1, s[24:27], s44 offen offset:0 sc1
    v_xor_b32 v111, s46, v111
    buffer_store_dwordx4 v[108:111], v1, s[24:27], s44 offen offset:1024 sc1
    s_sub_u32 s43, s43, 1
    s_min_u32 s43, s43, 6
    s_add_u32 s42, s42, 8192
    s_mul_i32 s44, s43, 294912
    s_add_u32 s44, s44, s42
    v_xor_b32 v115, s46, v115
    buffer_store_dwordx4 v[112:115], v1, s[24:27], s44 offen offset:0 sc1
    v_xor_b32 v119, s46, v119
    buffer_store_dwordx4 v[116:119], v1, s[24:27], s44 offen offset:1024 sc1
    s_sub_u32 s43, s43, 1
    s_min_u32 s43, s43, 6
    s_add_u32 s42, s42, 8192
    s_mul_i32 s44, s43, 294912
    s_add_u32 s44, s44, s42
    v_xor_b32 v123, s46, v123
    buffer_store_dwordx4 v[120:123], v1, s[24:27], s44 offen offset:0 sc1
    v_xor_b32 v127, s46, v127
    buffer_store_dwordx4 v[124:127], v1, s[24:27], s44 offen offset:1024 sc1
    s_sub_u32 s43, s43, 1
    s_min_u32 s43, s43, 6
    s_add_u32 s42, s42, 8192
    s_mul_i32 s44, s43, 294912
    s_add_u32 s44, s44, s42
    v_xor_b32 v131, s46, v131
    buffer_store_dwordx4 v[128:131], v1, s[24:27], s44 offen offset:0 sc1
    v_xor_b32 v135, s46, v135
    buffer_store_dwordx4 v[132:135], v1, s[24:27], s44 offen offset:1024 sc1
    s_waitcnt vmcnt(0)
    s_barrier
    s_cmp_lg_u32 s32, 0
    s_cbranch_scc1 L_hsig2
    v_lshlrev_b32 v145, 2, v0
    s_mov_b32 exec_hi, 0
    buffer_store_dword v5, v145, s[24:27], s47 offen sc1
    s_mov_b32 exec_hi, -1
L_hsig2:
    s_add_u32 s47, s47, 4096
    s_mul_i32 s42, s2, 98304
    s_add_u32 s42, s42, 2752512
    s_mov_b32 s43, 12
L_hfill2:
    v_mov_b32 v12, -1
    v_mov_b32 v13, -1
    v_mov_b32 v14, -1
    v_mov_b32 v15, -1
    s_lshl_b32 s44, s32, 10
    v_add_u32 v10, s44, v1
    s_lshl_b32 s44, s2, 12
    s_add_u32 s44, s44, 12845056
    buffer_store_dwordx4 v[12:15], v10, s[24:27], s44 offen sc1
L_fill:
    buffer_store_dwordx4 v[12:15], v10, s[24:27], s42 offen sc1
    s_add_u32 s42, s42, 4096
    buffer_store_dwordx4 v[12:15], v10, s[24:27], s42 offen sc1
    s_add_u32 s42, s42, 4096
    s_sub_u32 s43, s43, 1
    s_cmp_lg_u32 s43, 0
    s_cbranch_scc1 L_fill
    s_lshl_b32 s47, s2, 7
    s_add_u32 s47, s47, 15069184
    s_waitcnt vmcnt(0)
    v_not_b32 v5, v140
    s_waitcnt vmcnt(0)
    s_barrier
    s_cmp_lg_u32 s32, 0
    s_cbranch_scc1 L_hsig3
    v_lshlrev_b32 v145, 2, v0
    s_mov_b32 exec_hi, 0
    buffer_store_dword v5, v145, s[24:27], s47 offen sc1
    s_mov_b32 exec_hi, -1
L_hsig3:
    s_add_u32 s47, s47, 4096
L_exit:
    s_endpgm
slow_f0_x_1:
    s_cmp_eq_u32 s36, 0
    s_cbranch_scc1 ok_f0_x_2
    s_sub_u32 s36, s36, 1
    s_lshl_b32 s49, s32, 7
    v_lshlrev_b32 v2, 9, s33
    s_add_u32 s49, s49, 15056896
    s_mov_b64 exec, 1
    buffer_load_dword v3, v2, s[24:27], s49 offen sc1
    s_mov_b64 exec, -1
    s_waitcnt vmcnt(0) lgkmcnt(0)
    v_cmp_ne_u32 vcc, s28, v3
    s_nop 0
    s_and_b64 vcc, vcc, 1
    s_waitcnt vmcnt(0) lgkmcnt(0)
    s_cbranch_scc1 slow_f0_x_1
    s_nop 1
    s_branch ok_f0_x_2
slow_U0_0_3:
    s_cmp_eq_u32 s36, 0
    s_cbranch_scc1 ok_U0_0_4
    s_sub_u32 s36, s36, 1
    buffer_load_dwordx4 v[16:19], v12, s[24:27], s4 offen offset:0 sc1
    buffer_load_dwordx4 v[20:23], v12, s[24:27], s4 offen offset:3584 sc1
    buffer_load_dwordx4 v[24:27], v252, s[24:27], s4 offen offset:0 sc1
    buffer_load_dwordx4 v[28:31], v252, s[24:27], s4 offen offset:3584 sc1
    buffer_load_dwordx4 v[32:35], v12, s[24:27], s5 offen offset:0 sc1
    buffer_load_dwordx4 v[36:39], v12, s[24:27], s5 offen offset:3584 sc1
    buffer_load_dwordx4 v[40:43], v252, s[24:27], s5 offen offset:0 sc1
    buffer_load_dwordx4 v[44:47], v252, s[24:27], s5 offen offset:3584 sc1
    buffer_load_dwordx4 v[48:51], v12, s[24:27], s6 offen offset:0 sc1
    buffer_load_dwordx4 v[52:55], v12, s[24:27], s6 offen offset:3584 sc1
    buffer_load_dwordx4 v[56:59], v252, s[24:27], s6 offen offset:0 sc1
    buffer_load_dwordx4 v[60:63], v252, s[24:27], s6 offen offset:3584 sc1
    buffer_load_dwordx4 v[64:67], v12, s[24:27], s7 offen offset:0 sc1
    buffer_load_dwordx4 v[68:71], v12, s[24:27], s7 offen offset:3584 sc1
    buffer_load_dwordx4 v[72:75], v252, s[24:27], s7 offen offset:0 sc1
    buffer_load_dwordx4 v[76:79], v252, s[24:27], s7 offen offset:3584 sc1
    s_waitcnt vmcnt(0) lgkmcnt(0)
    v_xor_b32 v254, s28, v16
    v_bitop3_b32 v254, v254, v17, s29 bitop3:0xf6
    v_bitop3_b32 v254, v254, v18, s30 bitop3:0xf6
    v_bitop3_b32 v254, v254, v19, s31 bitop3:0xf6
    v_bitop3_b32 v254, v254, v20, s28 bitop3:0xf6
    v_bitop3_b32 v254, v254, v21, s29 bitop3:0xf6
    v_bitop3_b32 v254, v254, v22, s30 bitop3:0xf6
    v_bitop3_b32 v254, v254, v23, s31 bitop3:0xf6
    v_bitop3_b32 v254, v254, v24, s28 bitop3:0xf6
    v_bitop3_b32 v254, v254, v25, s29 bitop3:0xf6
    v_bitop3_b32 v254, v254, v26, s30 bitop3:0xf6
    v_bitop3_b32 v254, v254, v27, s31 bitop3:0xf6
    v_bitop3_b32 v254, v254, v28, s28 bitop3:0xf6
    v_bitop3_b32 v254, v254, v29, s29 bitop3:0xf6
    v_bitop3_b32 v254, v254, v30, s30 bitop3:0xf6
    v_bitop3_b32 v254, v254, v31, s31 bitop3:0xf6
    v_and_b32 v254, 0x10001, v254
    v_cmp_ne_u32 vcc, 0, v254
    s_waitcnt vmcnt(0) lgkmcnt(0)
    s_cbranch_vccnz slow_U0_0_3
    s_nop 1
    s_branch ok_U0_0_4
slow_U0_1_5:
    s_cmp_eq_u32 s36, 0
    s_cbranch_scc1 ok_U0_1_6
    s_sub_u32 s36, s36, 1
    buffer_load_dwordx4 v[32:35], v12, s[24:27], s5 offen offset:0 sc1
    buffer_load_dwordx4 v[36:39], v12, s[24:27], s5 offen offset:3584 sc1
    buffer_load_dwordx4 v[40:43], v252, s[24:27], s5 offen offset:0 sc1
    buffer_load_dwordx4 v[44:47], v252, s[24:27], s5 offen offset:3584 sc1
    buffer_load_dwordx4 v[48:51], v12, s[24:27], s6 offen offset:0 sc1
    buffer_load_dwordx4 v[52:55], v12, s[24:27], s6 offen offset:3584 sc1
    buffer_load_dwordx4 v[56:59], v252, s[24:27], s6 offen offset:0 sc1
    buffer_load_dwordx4 v[60:63], v252, s[24:27], s6 offen offset:3584 sc1
    buffer_load_dwordx4 v[64:67], v12, s[24:27], s7 offen offset:0 sc1
    buffer_load_dwordx4 v[68:71], v12, s[24:27], s7 offen offset:3584 sc1
    buffer_load_dwordx4 v[72:75], v252, s[24:27], s7 offen offset:0 sc1
    buffer_load_dwordx4 v[76:79], v252, s[24:27], s7 offen offset:3584 sc1
    s_waitcnt vmcnt(0) lgkmcnt(0)
    v_xor_b32 v254, s28, v32
    v_bitop3_b32 v254, v254, v33, s29 bitop3:0xf6
    v_bitop3_b32 v254, v254, v34, s30 bitop3:0xf6
    v_bitop3_b32 v254, v254, v35, s31 bitop3:0xf6
    v_bitop3_b32 v254, v254, v36, s28 bitop3:0xf6
    v_bitop3_b32 v254, v254, v37, s29 bitop3:0xf6
    v_bitop3_b32 v254, v254, v38, s30 bitop3:0xf6
    v_bitop3_b32 v254, v254, v39, s31 bitop3:0xf6
    v_bitop3_b32 v254, v254, v40, s28 bitop3:0xf6
    v_bitop3_b32 v254, v254, v41, s29 bitop3:0xf6
    v_bitop3_b32 v254, v254, v42, s30 bitop3:0xf6
    v_bitop3_b32 v254, v254, v43, s31 bitop3:0xf6
    v_bitop3_b32 v254, v254, v44, s28 bitop3:0xf6
    v_bitop3_b32 v254, v254, v45, s29 bitop3:0xf6
    v_bitop3_b32 v254, v254, v46, s30 bitop3:0xf6
    v_bitop3_b32 v254, v254, v47, s31 bitop3:0xf6
    v_and_b32 v254, 0x10001, v254
    v_cmp_ne_u32 vcc, 0, v254
    s_waitcnt vmcnt(0) lgkmcnt(0)
    s_cbranch_vccnz slow_U0_1_5
    s_nop 1
    s_branch ok_U0_1_6
slow_U0_2_7:
    s_cmp_eq_u32 s36, 0
    s_cbranch_scc1 ok_U0_2_8
    s_sub_u32 s36, s36, 1
    buffer_load_dwordx4 v[48:51], v12, s[24:27], s6 offen offset:0 sc1
    buffer_load_dwordx4 v[52:55], v12, s[24:27], s6 offen offset:3584 sc1
    buffer_load_dwordx4 v[56:59], v252, s[24:27], s6 offen offset:0 sc1
    buffer_load_dwordx4 v[60:63], v252, s[24:27], s6 offen offset:3584 sc1
    buffer_load_dwordx4 v[64:67], v12, s[24:27], s7 offen offset:0 sc1
    buffer_load_dwordx4 v[68:71], v12, s[24:27], s7 offen offset:3584 sc1
    buffer_load_dwordx4 v[72:75], v252, s[24:27], s7 offen offset:0 sc1
    buffer_load_dwordx4 v[76:79], v252, s[24:27], s7 offen offset:3584 sc1
    s_waitcnt vmcnt(0) lgkmcnt(0)
    v_xor_b32 v254, s28, v48
    v_bitop3_b32 v254, v254, v49, s29 bitop3:0xf6
    v_bitop3_b32 v254, v254, v50, s30 bitop3:0xf6
    v_bitop3_b32 v254, v254, v51, s31 bitop3:0xf6
    v_bitop3_b32 v254, v254, v52, s28 bitop3:0xf6
    v_bitop3_b32 v254, v254, v53, s29 bitop3:0xf6
    v_bitop3_b32 v254, v254, v54, s30 bitop3:0xf6
    v_bitop3_b32 v254, v254, v55, s31 bitop3:0xf6
    v_bitop3_b32 v254, v254, v56, s28 bitop3:0xf6
    v_bitop3_b32 v254, v254, v57, s29 bitop3:0xf6
    v_bitop3_b32 v254, v254, v58, s30 bitop3:0xf6
    v_bitop3_b32 v254, v254, v59, s31 bitop3:0xf6
    v_bitop3_b32 v254, v254, v60, s28 bitop3:0xf6
    v_bitop3_b32 v254, v254, v61, s29 bitop3:0xf6
    v_bitop3_b32 v254, v254, v62, s30 bitop3:0xf6
    v_bitop3_b32 v254, v254, v63, s31 bitop3:0xf6
    v_and_b32 v254, 0x10001, v254
    v_cmp_ne_u32 vcc, 0, v254
    s_waitcnt vmcnt(0) lgkmcnt(0)
    s_cbranch_vccnz slow_U0_2_7
    s_nop 1
    s_branch ok_U0_2_8
slow_U0_3_9:
    s_cmp_eq_u32 s36, 0
    s_cbranch_scc1 ok_U0_3_10
    s_sub_u32 s36, s36, 1
    buffer_load_dwordx4 v[64:67], v12, s[24:27], s7 offen offset:0 sc1
    buffer_load_dwordx4 v[68:71], v12, s[24:27], s7 offen offset:3584 sc1
    buffer_load_dwordx4 v[72:75], v252, s[24:27], s7 offen offset:0 sc1
    buffer_load_dwordx4 v[76:79], v252, s[24:27], s7 offen offset:3584 sc1
    s_waitcnt vmcnt(0) lgkmcnt(0)
    v_xor_b32 v254, s28, v64
    v_bitop3_b32 v254, v254, v65, s29 bitop3:0xf6
    v_bitop3_b32 v254, v254, v66, s30 bitop3:0xf6
    v_bitop3_b32 v254, v254, v67, s31 bitop3:0xf6
    v_bitop3_b32 v254, v254, v68, s28 bitop3:0xf6
    v_bitop3_b32 v254, v254, v69, s29 bitop3:0xf6
    v_bitop3_b32 v254, v254, v70, s30 bitop3:0xf6
    v_bitop3_b32 v254, v254, v71, s31 bitop3:0xf6
    v_bitop3_b32 v254, v254, v72, s28 bitop3:0xf6
    v_bitop3_b32 v254, v254, v73, s29 bitop3:0xf6
    v_bitop3_b32 v254, v254, v74, s30 bitop3:0xf6
L_pad9:
    s_cbranch_execz L_ret2
    v_bitop3_b32 v254, v254, v75, s31 bitop3:0xf6
    v_bitop3_b32 v254, v254, v76, s28 bitop3:0xf6
    v_bitop3_b32 v254, v254, v77, s29 bitop3:0xf6
    v_bitop3_b32 v254, v254, v78, s30 bitop3:0xf6
    v_bitop3_b32 v254, v254, v79, s31 bitop3:0xf6
    v_and_b32 v254, 0x10001, v254
    v_cmp_ne_u32 vcc, 0, v254
    s_waitcnt vmcnt(0) lgkmcnt(0)
    s_cbranch_vccnz slow_U0_3_9
    s_nop 1
    s_branch ok_U0_3_10
slow_f1_x_11:
    s_cmp_eq_u32 s36, 0
    s_cbranch_scc1 ok_f1_x_12
    s_sub_u32 s36, s36, 1
    s_lshl_b32 s49, s32, 7
    v_lshlrev_b32 v2, 9, v0
    s_add_u32 s49, s49, 15060992
    s_mov_b64 exec, 127
    buffer_load_dword v3, v2, s[24:27], s49 offen sc1
    s_mov_b64 exec, -1
    s_waitcnt vmcnt(0) lgkmcnt(0)
    v_cmp_ne_u32 vcc, s28, v3
    s_nop 0
    s_and_b64 vcc, vcc, 127
    s_waitcnt vmcnt(0) lgkmcnt(0)
    s_cbranch_scc1 slow_f1_x_11
    s_nop 1
    s_branch ok_f1_x_12
slow_f2_x_13:
    s_cmp_eq_u32 s36, 0
    s_cbranch_scc1 ok_f2_x_14
    s_sub_u32 s36, s36, 1
    s_lshl_b32 s49, s32, 7
    v_lshlrev_b32 v2, 9, v0
    s_add_u32 s49, s49, 15065088
    s_mov_b64 exec, 127
    buffer_load_dword v3, v2, s[24:27], s49 offen sc1
    s_mov_b64 exec, -1
    s_waitcnt vmcnt(0) lgkmcnt(0)
    v_cmp_ne_u32 vcc, s28, v3
    s_nop 0
    s_and_b64 vcc, vcc, 127
    s_waitcnt vmcnt(0) lgkmcnt(0)
    s_cbranch_scc1 slow_f2_x_13
    s_nop 1
    s_branch ok_f2_x_14
slow_h0_01_15:
    s_cmp_eq_u32 s36, 0
    s_cbranch_scc1 ok_h0_01_16
    s_sub_u32 s36, s36, 1
    buffer_load_dwordx4 v[16:19], v1, s[24:27], s61 offen offset:0 sc1
    buffer_load_dwordx4 v[20:23], v1, s[24:27], s61 offen offset:1024 sc1
    buffer_load_dwordx4 v[24:27], v1, s[24:27], s61 offen offset:2048 sc1
    buffer_load_dwordx4 v[28:31], v1, s[24:27], s61 offen offset:3072 sc1
    s_waitcnt vmcnt(0) lgkmcnt(0)
    v_or_b32 v12, v16, v17
    v_bitop3_b32 v12, v12, v18, v19 bitop3:0xfd
    v_or3_b32 v12, v20, v21, v12
    v_bitop3_b32 v12, v12, v22, v23 bitop3:0xfd
    v_or3_b32 v12, v24, v25, v12
    v_bitop3_b32 v12, v12, v26, v27 bitop3:0xfd
    v_or3_b32 v12, v28, v29, v12
    v_bitop3_b32 v12, v12, v30, v31 bitop3:0xfd
    v_and_b32 v12, s54, v12
    v_cmp_ne_u32 vcc, 0, v12
    s_waitcnt vmcnt(0) lgkmcnt(0)
    s_cbranch_vccnz slow_h0_01_15
    s_nop 1
    s_branch ok_h0_01_16
slow_h0_02_17:
    s_cmp_eq_u32 s36, 0
    s_cbranch_scc1 ok_h0_02_18
    s_sub_u32 s36, s36, 1
    buffer_load_dwordx4 v[32:35], v1, s[24:27], s62 offen offset:0 sc1
    buffer_load_dwordx4 v[36:39], v1, s[24:27], s62 offen offset:1024 sc1
    buffer_load_dwordx4 v[40:43], v1, s[24:27], s62 offen offset:2048 sc1
    buffer_load_dwordx4 v[44:47], v1, s[24:27], s62 offen offset:3072 sc1
    s_waitcnt vmcnt(0) lgkmcnt(0)
    v_or_b32 v12, v32, v33
    v_bitop3_b32 v12, v12, v34, v35 bitop3:0xfd
    v_or3_b32 v12, v36, v37, v12
    v_bitop3_b32 v12, v12, v38, v39 bitop3:0xfd
    v_or3_b32 v12, v40, v41, v12
    v_bitop3_b32 v12, v12, v42, v43 bitop3:0xfd
    v_or3_b32 v12, v44, v45, v12
    v_bitop3_b32 v12, v12, v46, v47 bitop3:0xfd
    v_and_b32 v12, s54, v12
    v_cmp_ne_u32 vcc, 0, v12
    s_waitcnt vmcnt(0) lgkmcnt(0)
    s_cbranch_vccnz slow_h0_02_17
    s_nop 1
    s_branch ok_h0_02_18
slow_h0_03_19:
    s_cmp_eq_u32 s36, 0
    s_cbranch_scc1 ok_h0_03_20
    s_sub_u32 s36, s36, 1
    buffer_load_dwordx4 v[128:131], v1, s[24:27], s63 offen offset:0 sc1
    buffer_load_dwordx4 v[132:135], v1, s[24:27], s63 offen offset:1024 sc1
    buffer_load_dwordx4 v[136:139], v1, s[24:27], s63 offen offset:2048 sc1
    buffer_load_dwordx4 v[140:143], v1, s[24:27], s63 offen offset:3072 sc1
    s_waitcnt vmcnt(0) lgkmcnt(0)
    v_or_b32 v12, v128, v129
    v_bitop3_b32 v12, v12, v130, v131 bitop3:0xfd
    v_or3_b32 v12, v132, v133, v12
    v_bitop3_b32 v12, v12, v134, v135 bitop3:0xfd
    v_or3_b32 v12, v136, v137, v12
    v_bitop3_b32 v12, v12, v138, v139 bitop3:0xfd
    v_or3_b32 v12, v140, v141, v12
    v_bitop3_b32 v12, v12, v142, v143 bitop3:0xfd
    v_and_b32 v12, s54, v12
    v_cmp_ne_u32 vcc, 0, v12
    s_waitcnt vmcnt(0) lgkmcnt(0)
    s_cbranch_vccnz slow_h0_03_19
    s_nop 1
    s_branch ok_h0_03_20
slow_h0_04_21:
    s_cmp_eq_u32 s36, 0
    s_cbranch_scc1 ok_h0_04_22
    s_sub_u32 s36, s36, 1
    buffer_load_dwordx4 v[80:83], v1, s[24:27], s64 offen offset:0 sc1
    buffer_load_dwordx4 v[84:87], v1, s[24:27], s64 offen offset:1024 sc1
    buffer_load_dwordx4 v[88:91], v1, s[24:27], s64 offen offset:2048 sc1
    buffer_load_dwordx4 v[92:95], v1, s[24:27], s64 offen offset:3072 sc1
    s_waitcnt vmcnt(0) lgkmcnt(0)
    v_or_b32 v12, v80, v81
    v_bitop3_b32 v12, v12, v82, v83 bitop3:0xfd
    v_or3_b32 v12, v84, v85, v12
    v_bitop3_b32 v12, v12, v86, v87 bitop3:0xfd
    v_or3_b32 v12, v88, v89, v12
    v_bitop3_b32 v12, v12, v90, v91 bitop3:0xfd
    v_or3_b32 v12, v92, v93, v12
    v_bitop3_b32 v12, v12, v94, v95 bitop3:0xfd
    v_and_b32 v12, s54, v12
    v_cmp_ne_u32 vcc, 0, v12
    s_waitcnt vmcnt(0) lgkmcnt(0)
    s_cbranch_vccnz slow_h0_04_21
    s_nop 1
    s_branch ok_h0_04_22
slow_h0_05_23:
    s_cmp_eq_u32 s36, 0
    s_cbranch_scc1 ok_h0_05_24
    s_sub_u32 s36, s36, 1
    buffer_load_dwordx4 v[16:19], v1, s[24:27], s65 offen offset:0 sc1
    buffer_load_dwordx4 v[20:23], v1, s[24:27], s65 offen offset:1024 sc1
    buffer_load_dwordx4 v[24:27], v1, s[24:27], s65 offen offset:2048 sc1
    buffer_load_dwordx4 v[28:31], v1, s[24:27], s65 offen offset:3072 sc1
    s_waitcnt vmcnt(0) lgkmcnt(0)
    v_or_b32 v12, v16, v17
    v_bitop3_b32 v12, v12, v18, v19 bitop3:0xfd
    v_or3_b32 v12, v20, v21, v12
    v_bitop3_b32 v12, v12, v22, v23 bitop3:0xfd
    v_or3_b32 v12, v24, v25, v12
    v_bitop3_b32 v12, v12, v26, v27 bitop3:0xfd
    v_or3_b32 v12, v28, v29, v12
    v_bitop3_b32 v12, v12, v30, v31 bitop3:0xfd
    v_and_b32 v12, s54, v12
    v_cmp_ne_u32 vcc, 0, v12
    s_waitcnt vmcnt(0) lgkmcnt(0)
    s_cbranch_vccnz slow_h0_05_23
    s_nop 1
    s_branch ok_h0_05_24
slow_h0_06_25:
    s_cmp_eq_u32 s36, 0
    s_cbranch_scc1 ok_h0_06_26
    s_sub_u32 s36, s36, 1
    buffer_load_dwordx4 v[32:35], v1, s[24:27], s66 offen offset:0 sc1
    buffer_load_dwordx4 v[36:39], v1, s[24:27], s66 offen offset:1024 sc1
    buffer_load_dwordx4 v[40:43], v1, s[24:27], s66 offen offset:2048 sc1
    buffer_load_dwordx4 v[44:47], v1, s[24:27], s66 offen offset:3072 sc1
    s_waitcnt vmcnt(0) lgkmcnt(0)
    v_or_b32 v12, v32, v33
    v_bitop3_b32 v12, v12, v34, v35 bitop3:0xfd
    v_or3_b32 v12, v36, v37, v12
    v_bitop3_b32 v12, v12, v38, v39 bitop3:0xfd
    v_or3_b32 v12, v40, v41, v12
    v_bitop3_b32 v12, v12, v42, v43 bitop3:0xfd
    v_or3_b32 v12, v44, v45, v12
    v_bitop3_b32 v12, v12, v46, v47 bitop3:0xfd
    v_and_b32 v12, s54, v12
    v_cmp_ne_u32 vcc, 0, v12
    s_waitcnt vmcnt(0) lgkmcnt(0)
    s_cbranch_vccnz slow_h0_06_25
    s_nop 1
    s_branch ok_h0_06_26
slow_h0_11_27:
    s_cmp_eq_u32 s36, 0
    s_cbranch_scc1 ok_h0_11_28
    s_sub_u32 s36, s36, 1
    buffer_load_dwordx4 v[128:131], v8, s[24:27], s61 offen offset:0 sc1
    buffer_load_dwordx4 v[132:135], v8, s[24:27], s61 offen offset:1024 sc1
    buffer_load_dwordx4 v[136:139], v8, s[24:27], s61 offen offset:2048 sc1
    buffer_load_dwordx4 v[140:143], v8, s[24:27], s61 offen offset:3072 sc1
    s_waitcnt vmcnt(0) lgkmcnt(0)
    v_or_b32 v12, v128, v129
    v_bitop3_b32 v12, v12, v130, v131 bitop3:0xfd
    v_or3_b32 v12, v132, v133, v12
    v_bitop3_b32 v12, v12, v134, v135 bitop3:0xfd
    v_or3_b32 v12, v136, v137, v12
    v_bitop3_b32 v12, v12, v138, v139 bitop3:0xfd
    v_or3_b32 v12, v140, v141, v12
    v_bitop3_b32 v12, v12, v142, v143 bitop3:0xfd
    v_and_b32 v12, s54, v12
    v_cmp_ne_u32 vcc, 0, v12
    s_waitcnt vmcnt(0) lgkmcnt(0)
    s_cbranch_vccnz slow_h0_11_27
    s_nop 1
    s_branch ok_h0_11_28
slow_cnt_1_29:
    s_cmp_eq_u32 s36, 0
    s_cbranch_scc1 ok_cnt_1_30
    s_sub_u32 s36, s36, 1
    v_lshlrev_b32 v6, 7, v0
    s_lshl_b32 s48, s32, 10
    s_add_u32 s48, s48, 15069184
    s_mov_b64 exec, 0xff
    buffer_load_dword v6, v6, s[24:27], s48 offen sc1
    s_mov_b64 exec, -1
    s_waitcnt vmcnt(0) lgkmcnt(0)
    v_cmp_ne_u32 s[46:47], s28, v6
    s_nop 0
    s_and_b32 s46, s46, 0xff
    s_waitcnt vmcnt(0) lgkmcnt(0)
    s_cbranch_scc1 slow_cnt_1_29
    s_nop 1
    s_branch ok_cnt_1_30
slow_h0_12_31:
    s_cmp_eq_u32 s36, 0
    s_cbranch_scc1 ok_h0_12_32
    s_sub_u32 s36, s36, 1
    buffer_load_dwordx4 v[80:83], v8, s[24:27], s62 offen offset:0 sc1
    buffer_load_dwordx4 v[84:87], v8, s[24:27], s62 offen offset:1024 sc1
    buffer_load_dwordx4 v[88:91], v8, s[24:27], s62 offen offset:2048 sc1
    buffer_load_dwordx4 v[92:95], v8, s[24:27], s62 offen offset:3072 sc1
    s_waitcnt vmcnt(0) lgkmcnt(0)
    v_or_b32 v12, v80, v81
    v_bitop3_b32 v12, v12, v82, v83 bitop3:0xfd
    v_or3_b32 v12, v84, v85, v12
    v_bitop3_b32 v12, v12, v86, v87 bitop3:0xfd
    v_or3_b32 v12, v88, v89, v12
    v_bitop3_b32 v12, v12, v90, v91 bitop3:0xfd
    v_or3_b32 v12, v92, v93, v12
    v_bitop3_b32 v12, v12, v94, v95 bitop3:0xfd
    v_and_b32 v12, s54, v12
    v_cmp_ne_u32 vcc, 0, v12
    s_waitcnt vmcnt(0) lgkmcnt(0)
    s_cbranch_vccnz slow_h0_12_31
    s_nop 1
    s_branch ok_h0_12_32
slow_h0_13_33:
    s_cmp_eq_u32 s36, 0
    s_cbranch_scc1 ok_h0_13_34
    s_sub_u32 s36, s36, 1
    buffer_load_dwordx4 v[112:115], v8, s[24:27], s63 offen offset:0 sc1
    buffer_load_dwordx4 v[116:119], v8, s[24:27], s63 offen offset:1024 sc1
    buffer_load_dwordx4 v[120:123], v8, s[24:27], s63 offen offset:2048 sc1
    buffer_load_dwordx4 v[124:127], v8, s[24:27], s63 offen offset:3072 sc1
    s_waitcnt vmcnt(0) lgkmcnt(0)
    v_or_b32 v12, v112, v113
    v_bitop3_b32 v12, v12, v114, v115 bitop3:0xfd
    v_or3_b32 v12, v116, v117, v12
    v_bitop3_b32 v12, v12, v118, v119 bitop3:0xfd
    v_or3_b32 v12, v120, v121, v12
    v_bitop3_b32 v12, v12, v122, v123 bitop3:0xfd
    v_or3_b32 v12, v124, v125, v12
    v_bitop3_b32 v12, v12, v126, v127 bitop3:0xfd
    v_and_b32 v12, s54, v12
    v_cmp_ne_u32 vcc, 0, v12
    s_waitcnt vmcnt(0) lgkmcnt(0)
    s_cbranch_vccnz slow_h0_13_33
    s_nop 1
    s_branch ok_h0_13_34
slow_h0_14_35:
    s_cmp_eq_u32 s36, 0
    s_cbranch_scc1 ok_h0_14_36
    s_sub_u32 s36, s36, 1
    buffer_load_dwordx4 v[128:131], v8, s[24:27], s64 offen offset:0 sc1
    buffer_load_dwordx4 v[132:135], v8, s[24:27], s64 offen offset:1024 sc1
    buffer_load_dwordx4 v[136:139], v8, s[24:27], s64 offen offset:2048 sc1
    buffer_load_dwordx4 v[140:143], v8, s[24:27], s64 offen offset:3072 sc1
    s_waitcnt vmcnt(0) lgkmcnt(0)
    v_or_b32 v12, v128, v129
    v_bitop3_b32 v12, v12, v130, v131 bitop3:0xfd
    v_or3_b32 v12, v132, v133, v12
    v_bitop3_b32 v12, v12, v134, v135 bitop3:0xfd
    v_or3_b32 v12, v136, v137, v12
    v_bitop3_b32 v12, v12, v138, v139 bitop3:0xfd
    v_or3_b32 v12, v140, v141, v12
    v_bitop3_b32 v12, v12, v142, v143 bitop3:0xfd
    v_and_b32 v12, s54, v12
    v_cmp_ne_u32 vcc, 0, v12
    s_waitcnt vmcnt(0) lgkmcnt(0)
    s_cbranch_vccnz slow_h0_14_35
    s_nop 1
    s_branch ok_h0_14_36
slow_h0_15_37:
    s_cmp_eq_u32 s36, 0
    s_cbranch_scc1 ok_h0_15_38
    s_sub_u32 s36, s36, 1
    buffer_load_dwordx4 v[80:83], v8, s[24:27], s65 offen offset:0 sc1
    buffer_load_dwordx4 v[84:87], v8, s[24:27], s65 offen offset:1024 sc1
    buffer_load_dwordx4 v[88:91], v8, s[24:27], s65 offen offset:2048 sc1
    buffer_load_dwordx4 v[92:95], v8, s[24:27], s65 offen offset:3072 sc1
    s_waitcnt vmcnt(0) lgkmcnt(0)
    v_or_b32 v12, v80, v81
    v_bitop3_b32 v12, v12, v82, v83 bitop3:0xfd
    v_or3_b32 v12, v84, v85, v12
    v_bitop3_b32 v12, v12, v86, v87 bitop3:0xfd
    v_or3_b32 v12, v88, v89, v12
    v_bitop3_b32 v12, v12, v90, v91 bitop3:0xfd
    v_or3_b32 v12, v92, v93, v12
    v_bitop3_b32 v12, v12, v94, v95 bitop3:0xfd
    v_and_b32 v12, s54, v12
    v_cmp_ne_u32 vcc, 0, v12
    s_waitcnt vmcnt(0) lgkmcnt(0)
    s_cbranch_vccnz slow_h0_15_37
    s_nop 1
    s_branch ok_h0_15_38
slow_h0_16_39:
    s_cmp_eq_u32 s36, 0
    s_cbranch_scc1 ok_h0_16_40
    s_sub_u32 s36, s36, 1
    buffer_load_dwordx4 v[112:115], v8, s[24:27], s66 offen offset:0 sc1
    buffer_load_dwordx4 v[116:119], v8, s[24:27], s66 offen offset:1024 sc1
    buffer_load_dwordx4 v[120:123], v8, s[24:27], s66 offen offset:2048 sc1
    buffer_load_dwordx4 v[124:127], v8, s[24:27], s66 offen offset:3072 sc1
    s_waitcnt vmcnt(0) lgkmcnt(0)
    v_or_b32 v12, v112, v113
    v_bitop3_b32 v12, v12, v114, v115 bitop3:0xfd
    v_or3_b32 v12, v116, v117, v12
    v_bitop3_b32 v12, v12, v118, v119 bitop3:0xfd
    v_or3_b32 v12, v120, v121, v12
    v_bitop3_b32 v12, v12, v122, v123 bitop3:0xfd
    v_or3_b32 v12, v124, v125, v12
    v_bitop3_b32 v12, v12, v126, v127 bitop3:0xfd
    v_and_b32 v12, s54, v12
    v_cmp_ne_u32 vcc, 0, v12
    s_waitcnt vmcnt(0) lgkmcnt(0)
    s_cbranch_vccnz slow_h0_16_39
    s_nop 1
    s_branch ok_h0_16_40
L_epoch:
    v_mov_b32 v96, s28
    v_mov_b32 v97, s29
    v_mov_b32 v98, s30
    v_mov_b32 v99, s31
    s_mov_b32 s46, 15073280
    s_mov_b64 exec, 1
    buffer_store_dwordx4 v[96:99], off, s[24:27], s46 sc1
    s_mov_b64 exec, -1
    s_branch L_epoch_ret
slow_x2_0_45:
    s_cmp_eq_u32 s36, 0
    s_cbranch_scc1 ok_x2_0_46
    s_sub_u32 s36, s36, 1
    buffer_load_dwordx4 v[16:19], v1, s[24:27], s0 offen offset:0 sc1
    buffer_load_dwordx4 v[44:47], v1, s[24:27], s4 offen offset:1024 sc1
    buffer_load_dwordx4 v[20:23], v1, s[24:27], s0 offen offset:1024 sc1
    buffer_load_dwordx4 v[48:51], v1, s[24:27], s5 offen offset:0 sc1
    buffer_load_dwordx4 v[24:27], v1, s[24:27], s1 offen offset:0 sc1
    buffer_load_dwordx4 v[52:55], v1, s[24:27], s5 offen offset:1024 sc1
    buffer_load_dwordx4 v[28:31], v1, s[24:27], s1 offen offset:1024 sc1
    buffer_load_dwordx4 v[56:59], v1, s[24:27], s6 offen offset:0 sc1
    buffer_load_dwordx4 v[32:35], v1, s[24:27], s3 offen offset:0 sc1
    buffer_load_dwordx4 v[60:63], v1, s[24:27], s6 offen offset:1024 sc1
    buffer_load_dwordx4 v[36:39], v1, s[24:27], s3 offen offset:1024 sc1
    buffer_load_dwordx4 v[64:67], v1, s[24:27], s7 offen offset:0 sc1
    buffer_load_dwordx4 v[40:43], v1, s[24:27], s4 offen offset:0 sc1
    buffer_load_dwordx4 v[68:71], v1, s[24:27], s7 offen offset:1024 sc1
    buffer_load_dwordx4 v[136:139], v1, s[24:27], s49 offen sc1
    s_waitcnt vmcnt(0) lgkmcnt(0)
    v_max_u32 v149, v16, v44
    v_max3_u32 v149, v149, v20, v48
    v_cmp_eq_u32 vcc, -1, v149
    s_waitcnt vmcnt(0) lgkmcnt(0)
    s_cbranch_vccnz slow_x2_0_45
    s_nop 1
    s_branch ok_x2_0_46
slow_x2_2_47:
    s_cmp_eq_u32 s36, 0
    s_cbranch_scc1 ok_x2_2_48
    s_sub_u32 s36, s36, 1
    buffer_load_dwordx4 v[24:27], v1, s[24:27], s1 offen offset:0 sc1
    buffer_load_dwordx4 v[52:55], v1, s[24:27], s5 offen offset:1024 sc1
    buffer_load_dwordx4 v[28:31], v1, s[24:27], s1 offen offset:1024 sc1
    buffer_load_dwordx4 v[56:59], v1, s[24:27], s6 offen offset:0 sc1
    buffer_load_dwordx4 v[32:35], v1, s[24:27], s3 offen offset:0 sc1
    buffer_load_dwordx4 v[60:63], v1, s[24:27], s6 offen offset:1024 sc1
    buffer_load_dwordx4 v[36:39], v1, s[24:27], s3 offen offset:1024 sc1
    buffer_load_dwordx4 v[64:67], v1, s[24:27], s7 offen offset:0 sc1
    buffer_load_dwordx4 v[40:43], v1, s[24:27], s4 offen offset:0 sc1
    buffer_load_dwordx4 v[68:71], v1, s[24:27], s7 offen offset:1024 sc1
    buffer_load_dwordx4 v[136:139], v1, s[24:27], s49 offen sc1
    s_waitcnt vmcnt(0) lgkmcnt(0)
    v_cndmask_b32 v138, 0, v138, s[52:53]
    v_cndmask_b32 v139, 0, v139, s[52:53]
    v_max_u32 v149, v24, v52
    v_max3_u32 v149, v149, v28, v56
    v_max3_u32 v149, v149, v136, v137
    v_max3_u32 v149, v149, v138, v139
    v_cmp_eq_u32 vcc, -1, v149
    s_waitcnt vmcnt(0) lgkmcnt(0)
    s_cbranch_vccnz slow_x2_2_47
    s_nop 1
    s_branch ok_x2_2_48
slow_x2_4_49:
    s_cmp_eq_u32 s36, 0
    s_cbranch_scc1 ok_x2_4_50
    s_sub_u32 s36, s36, 1
    buffer_load_dwordx4 v[32:35], v1, s[24:27], s3 offen offset:0 sc1
    buffer_load_dwordx4 v[60:63], v1, s[24:27], s6 offen offset:1024 sc1
    buffer_load_dwordx4 v[36:39], v1, s[24:27], s3 offen offset:1024 sc1
    buffer_load_dwordx4 v[64:67], v1, s[24:27], s7 offen offset:0 sc1
    buffer_load_dwordx4 v[40:43], v1, s[24:27], s4 offen offset:0 sc1
    buffer_load_dwordx4 v[68:71], v1, s[24:27], s7 offen offset:1024 sc1
    s_waitcnt vmcnt(0) lgkmcnt(0)
    v_max_u32 v149, v32, v60
    v_max3_u32 v149, v149, v36, v64
    v_cmp_eq_u32 vcc, -1, v149
    s_waitcnt vmcnt(0) lgkmcnt(0)
    s_cbranch_vccnz slow_x2_4_49
    s_nop 1
    s_branch ok_x2_4_50
slow_x2_6_51:
    s_cmp_eq_u32 s36, 0
    s_cbranch_scc1 ok_x2_6_52
    s_sub_u32 s36, s36, 1
    buffer_load_dwordx4 v[40:43], v1, s[24:27], s4 offen offset:0 sc1
    buffer_load_dwordx4 v[68:71], v1, s[24:27], s7 offen offset:1024 sc1
    s_waitcnt vmcnt(0) lgkmcnt(0)
    v_max_u32 v149, v40, v68
    v_cmp_eq_u32 vcc, -1, v149
    s_waitcnt vmcnt(0) lgkmcnt(0)
    s_cbranch_vccnz slow_x2_6_51
    s_nop 1
    s_branch ok_x2_6_52
slow_img_53:
    s_cmp_eq_u32 s36, 0
    s_cbranch_scc1 ok_img_54
    s_sub_u32 s36, s36, 1
    s_mul_i32 s68, s32, 7168
    s_add_u32 m0, s68, 28672
    s_mul_i32 s67, s35, 28672
    s_add_u32 s67, s67, s68
    s_add_u32 s67, s67, 3670016
    buffer_load_dwordx4 v1, s[24:27], s67 offen offset:0 sc1 lds
    buffer_load_dwordx4 v1, s[24:27], s67 offen offset:1024 sc1 lds
    buffer_load_dwordx4 v1, s[24:27], s67 offen offset:2048 sc1 lds
    buffer_load_dwordx4 v1, s[24:27], s67 offen offset:3072 sc1 lds
    s_add_u32 m0, m0, 4096
    s_add_u32 s67, s67, 4096
    buffer_load_dwordx4 v1, s[24:27], s67 offen offset:0 sc1 lds
    buffer_load_dwordx4 v1, s[24:27], s67 offen offset:1024 sc1 lds
    buffer_load_dwordx4 v1, s[24:27], s67 offen offset:2048 sc1 lds
    s_waitcnt vmcnt(0) lgkmcnt(0)
    s_mul_i32 s42, s32, 7168
    v_add_u32 v88, s42, v1
    ds_read_b32 v90, v88 offset:28672
    ds_read_b32 v91, v88 offset:29696
    ds_read_b32 v92, v88 offset:30720
    ds_read_b32 v93, v88 offset:31744
    ds_read_b32 v94, v88 offset:32768
    ds_read_b32 v95, v88 offset:33792
    ds_read_b32 v96, v88 offset:34816
    s_waitcnt lgkmcnt(0)
    v_max3_u32 v90, v90, v91, v92
    v_max3_u32 v90, v90, v93, v94
    v_max3_u32 v90, v90, v95, v96
    v_cmp_eq_u32 vcc, -1, v90
    s_waitcnt vmcnt(0) lgkmcnt(0)
    s_cbranch_vccnz slow_img_53
    s_nop 1
    s_branch ok_img_54
slow_U1_0_55:
    s_cmp_eq_u32 s36, 0
    s_cbranch_scc1 ok_U1_0_56
    s_sub_u32 s36, s36, 1
    buffer_load_dwordx4 v[16:19], v12, s[24:27], s4 offen offset:0 sc1
    buffer_load_dwordx4 v[20:23], v12, s[24:27], s4 offen offset:3584 sc1
    buffer_load_dwordx4 v[24:27], v6, s[24:27], s4 offen offset:0 sc1
    buffer_load_dwordx4 v[28:31], v6, s[24:27], s4 offen offset:3584 sc1
    s_waitcnt vmcnt(4)
    v_max3_u32 v8, v32, v36, v40
    v_max_u32 v8, v8, v44
    v_cmp_eq_u32 vcc, -1, v8
    s_cbranch_vccz have_57
    buffer_load_dwordx4 v[32:35], v12, s[24:27], s5 offen offset:0 sc1
    buffer_load_dwordx4 v[36:39], v12, s[24:27], s5 offen offset:3584 sc1
    buffer_load_dwordx4 v[40:43], v6, s[24:27], s5 offen offset:0 sc1
    buffer_load_dwordx4 v[44:47], v6, s[24:27], s5 offen offset:3584 sc1
have_57:
    v_max3_u32 v8, v48, v52, v56
    v_max_u32 v8, v8, v60
    v_cmp_eq_u32 vcc, -1, v8
    s_cbranch_vccz have_58
    buffer_load_dwordx4 v[48:51], v12, s[24:27], s6 offen offset:0 sc1
    buffer_load_dwordx4 v[52:55], v12, s[24:27], s6 offen offset:3584 sc1
    buffer_load_dwordx4 v[56:59], v6, s[24:27], s6 offen offset:0 sc1
    buffer_load_dwordx4 v[60:63], v6, s[24:27], s6 offen offset:3584 sc1
have_58:
    v_max3_u32 v8, v64, v68, v72
    v_max_u32 v8, v8, v76
    v_cmp_eq_u32 vcc, -1, v8
    s_cbranch_vccz have_59
    buffer_load_dwordx4 v[64:67], v12, s[24:27], s7 offen offset:0 sc1
    buffer_load_dwordx4 v[68:71], v12, s[24:27], s7 offen offset:3584 sc1
    buffer_load_dwordx4 v[72:75], v6, s[24:27], s7 offen offset:0 sc1
    buffer_load_dwordx4 v[76:79], v6, s[24:27], s7 offen offset:3584 sc1
have_59:
    s_waitcnt vmcnt(0) lgkmcnt(0)
    v_max3_u32 v8, v16, v20, v24
    v_max_u32 v8, v8, v28
    v_cmp_eq_u32 vcc, -1, v8
    s_waitcnt vmcnt(0) lgkmcnt(0)
    s_cbranch_vccnz slow_U1_0_55
    v_swap_b32 v17, v20
    v_swap_b32 v18, v24
    v_swap_b32 v22, v25
    v_swap_b32 v19, v28
    s_nop 1
    s_branch ok_U1_0_56
slow_U1_1_60:
    s_cmp_eq_u32 s36, 0
    s_cbranch_scc1 ok_U1_1_61
    s_sub_u32 s36, s36, 1
    buffer_load_dwordx4 v[32:35], v12, s[24:27], s5 offen offset:0 sc1
    buffer_load_dwordx4 v[36:39], v12, s[24:27], s5 offen offset:3584 sc1
    buffer_load_dwordx4 v[40:43], v6, s[24:27], s5 offen offset:0 sc1
    buffer_load_dwordx4 v[44:47], v6, s[24:27], s5 offen offset:3584 sc1
    s_waitcnt vmcnt(4)
    v_max3_u32 v8, v48, v52, v56
    v_max_u32 v8, v8, v60
    v_cmp_eq_u32 vcc, -1, v8
    s_cbranch_vccz have_62
    buffer_load_dwordx4 v[48:51], v12, s[24:27], s6 offen offset:0 sc1
    buffer_load_dwordx4 v[52:55], v12, s[24:27], s6 offen offset:3584 sc1
    buffer_load_dwordx4 v[56:59], v6, s[24:27], s6 offen offset:0 sc1
    buffer_load_dwordx4 v[60:63], v6, s[24:27], s6 offen offset:3584 sc1
have_62:
    v_max3_u32 v8, v64, v68, v72
    v_max_u32 v8, v8, v76
    v_cmp_eq_u32 vcc, -1, v8
    s_cbranch_vccz have_63
    buffer_load_dwordx4 v[64:67], v12, s[24:27], s7 offen offset:0 sc1
    buffer_load_dwordx4 v[68:71], v12, s[24:27], s7 offen offset:3584 sc1
    buffer_load_dwordx4 v[72:75], v6, s[24:27], s7 offen offset:0 sc1
    buffer_load_dwordx4 v[76:79], v6, s[24:27], s7 offen offset:3584 sc1
have_63:
    s_waitcnt vmcnt(0) lgkmcnt(0)
    v_max3_u32 v8, v32, v36, v40
    v_max_u32 v8, v8, v44
    v_cmp_eq_u32 vcc, -1, v8
    s_waitcnt vmcnt(0) lgkmcnt(0)
    s_cbranch_vccnz slow_U1_1_60
    v_swap_b32 v33, v36
    v_swap_b32 v34, v40
    v_swap_b32 v38, v41
    v_swap_b32 v35, v44
    s_nop 1
    s_branch ok_U1_1_61
slow_U1_2_64:
    s_cmp_eq_u32 s36, 0
    s_cbranch_scc1 ok_U1_2_65
    s_sub_u32 s36, s36, 1
    buffer_load_dwordx4 v[48:51], v12, s[24:27], s6 offen offset:0 sc1
    buffer_load_dwordx4 v[52:55], v12, s[24:27], s6 offen offset:3584 sc1
    buffer_load_dwordx4 v[56:59], v6, s[24:27], s6 offen offset:0 sc1
    buffer_load_dwordx4 v[60:63], v6, s[24:27], s6 offen offset:3584 sc1
    s_waitcnt vmcnt(4)
    v_max3_u32 v8, v64, v68, v72
    v_max_u32 v8, v8, v76
    v_cmp_eq_u32 vcc, -1, v8
    s_cbranch_vccz have_66
    buffer_load_dwordx4 v[64:67], v12, s[24:27], s7 offen offset:0 sc1
    buffer_load_dwordx4 v[68:71], v12, s[24:27], s7 offen offset:3584 sc1
    buffer_load_dwordx4 v[72:75], v6, s[24:27], s7 offen offset:0 sc1
    buffer_load_dwordx4 v[76:79], v6, s[24:27], s7 offen offset:3584 sc1
have_66:
    s_waitcnt vmcnt(0) lgkmcnt(0)
    v_max3_u32 v8, v48, v52, v56
    v_max_u32 v8, v8, v60
    v_cmp_eq_u32 vcc, -1, v8
    s_waitcnt vmcnt(0) lgkmcnt(0)
    s_cbranch_vccnz slow_U1_2_64
    v_swap_b32 v49, v52
    v_swap_b32 v50, v56
    v_swap_b32 v54, v57
    v_swap_b32 v51, v60
    s_nop 1
    s_branch ok_U1_2_65
slow_U1_3_67:
    s_cmp_eq_u32 s36, 0
    s_cbranch_scc1 ok_U1_3_68
    s_sub_u32 s36, s36, 1
    buffer_load_dwordx4 v[64:67], v12, s[24:27], s7 offen offset:0 sc1
    buffer_load_dwordx4 v[68:71], v12, s[24:27], s7 offen offset:3584 sc1
    buffer_load_dwordx4 v[72:75], v6, s[24:27], s7 offen offset:0 sc1
    buffer_load_dwordx4 v[76:79], v6, s[24:27], s7 offen offset:3584 sc1
    s_waitcnt vmcnt(0) lgkmcnt(0)
    v_max3_u32 v8, v64, v68, v72
    v_max_u32 v8, v8, v76
    v_cmp_eq_u32 vcc, -1, v8
    s_waitcnt vmcnt(0) lgkmcnt(0)
    s_cbranch_vccnz slow_U1_3_67
    v_swap_b32 v65, v68
    v_swap_b32 v66, v72
    v_swap_b32 v70, v73
    v_swap_b32 v67, v76
    s_nop 1
    s_branch ok_U1_3_68
slow_h1_01_69:
    s_cmp_eq_u32 s36, 0
    s_cbranch_scc1 ok_h1_01_70
    s_sub_u32 s36, s36, 1
    buffer_load_dwordx4 v[16:19], v1, s[24:27], s61 offen offset:0 sc1
    buffer_load_dwordx4 v[20:23], v1, s[24:27], s61 offen offset:1024 sc1
    buffer_load_dwordx4 v[24:27], v1, s[24:27], s61 offen offset:2048 sc1
    buffer_load_dwordx4 v[28:31], v1, s[24:27], s61 offen offset:3072 sc1
    s_waitcnt vmcnt(0) lgkmcnt(0)
    v_bitop3_b32 v12, v16, v20, v24 bitop3:0x80
    v_and_b32 v12, v12, v28
    v_cmp_le_i32 vcc, 0, v12
    s_waitcnt vmcnt(0) lgkmcnt(0)
    s_cbranch_vccnz slow_h1_01_69
    s_nop 1
    s_branch ok_h1_01_70
slow_h1_02_71:
    s_cmp_eq_u32 s36, 0
    s_cbranch_scc1 ok_h1_02_72
    s_sub_u32 s36, s36, 1
    buffer_load_dwordx4 v[32:35], v1, s[24:27], s62 offen offset:0 sc1
    buffer_load_dwordx4 v[36:39], v1, s[24:27], s62 offen offset:1024 sc1
    buffer_load_dwordx4 v[40:43], v1, s[24:27], s62 offen offset:2048 sc1
    buffer_load_dwordx4 v[44:47], v1, s[24:27], s62 offen offset:3072 sc1
    s_waitcnt vmcnt(0) lgkmcnt(0)
    v_bitop3_b32 v12, v32, v36, v40 bitop3:0x80
    v_and_b32 v12, v12, v44
    v_cmp_le_i32 vcc, 0, v12
    s_waitcnt vmcnt(0) lgkmcnt(0)
    s_cbranch_vccnz slow_h1_02_71
    s_nop 1
    s_branch ok_h1_02_72
slow_h1_03_73:
    s_cmp_eq_u32 s36, 0
    s_cbranch_scc1 ok_h1_03_74
    s_sub_u32 s36, s36, 1
    buffer_load_dwordx4 v[128:131], v1, s[24:27], s63 offen offset:0 sc1
    buffer_load_dwordx4 v[132:135], v1, s[24:27], s63 offen offset:1024 sc1
    buffer_load_dwordx4 v[136:139], v1, s[24:27], s63 offen offset:2048 sc1
    buffer_load_dwordx4 v[140:143], v1, s[24:27], s63 offen offset:3072 sc1
    s_waitcnt vmcnt(0) lgkmcnt(0)
    v_bitop3_b32 v12, v128, v132, v136 bitop3:0x80
    v_and_b32 v12, v12, v140
    v_cmp_le_i32 vcc, 0, v12
    s_waitcnt vmcnt(0) lgkmcnt(0)
    s_cbranch_vccnz slow_h1_03_73
    s_nop 1
    s_branch ok_h1_03_74
slow_h1_04_75:
    s_cmp_eq_u32 s36, 0
    s_cbranch_scc1 ok_h1_04_76
    s_sub_u32 s36, s36, 1
    buffer_load_dwordx4 v[80:83], v1, s[24:27], s64 offen offset:0 sc1
    buffer_load_dwordx4 v[84:87], v1, s[24:27], s64 offen offset:1024 sc1
    buffer_load_dwordx4 v[88:91], v1, s[24:27], s64 offen offset:2048 sc1
    buffer_load_dwordx4 v[92:95], v1, s[24:27], s64 offen offset:3072 sc1
    s_waitcnt vmcnt(0) lgkmcnt(0)
    v_bitop3_b32 v12, v80, v84, v88 bitop3:0x80
    v_and_b32 v12, v12, v92
    v_cmp_le_i32 vcc, 0, v12
    s_waitcnt vmcnt(0) lgkmcnt(0)
    s_cbranch_vccnz slow_h1_04_75
    s_nop 1
    s_branch ok_h1_04_76
slow_h1_05_77:
    s_cmp_eq_u32 s36, 0
    s_cbranch_scc1 ok_h1_05_78
    s_sub_u32 s36, s36, 1
    buffer_load_dwordx4 v[16:19], v1, s[24:27], s65 offen offset:0 sc1
    buffer_load_dwordx4 v[20:23], v1, s[24:27], s65 offen offset:1024 sc1
    buffer_load_dwordx4 v[24:27], v1, s[24:27], s65 offen offset:2048 sc1
    buffer_load_dwordx4 v[28:31], v1, s[24:27], s65 offen offset:3072 sc1
    s_waitcnt vmcnt(0) lgkmcnt(0)
    v_bitop3_b32 v12, v16, v20, v24 bitop3:0x80
    v_and_b32 v12, v12, v28
    v_cmp_le_i32 vcc, 0, v12
    s_waitcnt vmcnt(0) lgkmcnt(0)
    s_cbranch_vccnz slow_h1_05_77
    s_nop 1
    s_branch ok_h1_05_78
slow_h1_06_79:
    s_cmp_eq_u32 s36, 0
    s_cbranch_scc1 ok_h1_06_80
    s_sub_u32 s36, s36, 1
    buffer_load_dwordx4 v[32:35], v1, s[24:27], s66 offen offset:0 sc1
    buffer_load_dwordx4 v[36:39], v1, s[24:27], s66 offen offset:1024 sc1
    buffer_load_dwordx4 v[40:43], v1, s[24:27], s66 offen offset:2048 sc1
    buffer_load_dwordx4 v[44:47], v1, s[24:27], s66 offen offset:3072 sc1
    s_waitcnt vmcnt(0) lgkmcnt(0)
    v_bitop3_b32 v12, v32, v36, v40 bitop3:0x80
    v_and_b32 v12, v12, v44
    v_cmp_le_i32 vcc, 0, v12
    s_waitcnt vmcnt(0) lgkmcnt(0)
    s_cbranch_vccnz slow_h1_06_79
    s_nop 1
    s_branch ok_h1_06_80
slow_h1_11_81:
    s_cmp_eq_u32 s36, 0
    s_cbranch_scc1 ok_h1_11_82
    s_sub_u32 s36, s36, 1
    buffer_load_dwordx4 v[128:131], v8, s[24:27], s61 offen offset:0 sc1
    buffer_load_dwordx4 v[132:135], v8, s[24:27], s61 offen offset:1024 sc1
    buffer_load_dwordx4 v[136:139], v8, s[24:27], s61 offen offset:2048 sc1
    buffer_load_dwordx4 v[140:143], v8, s[24:27], s61 offen offset:3072 sc1
    s_waitcnt vmcnt(0) lgkmcnt(0)
    v_bitop3_b32 v12, v128, v132, v136 bitop3:0x80
    v_and_b32 v12, v12, v140
    v_cmp_le_i32 vcc, 0, v12
    s_waitcnt vmcnt(0) lgkmcnt(0)
    s_cbranch_vccnz slow_h1_11_81
    s_nop 1
    s_branch ok_h1_11_82
slow_h1_12_83:
    s_cmp_eq_u32 s36, 0
    s_cbranch_scc1 ok_h1_12_84
    s_sub_u32 s36, s36, 1
    buffer_load_dwordx4 v[80:83], v8, s[24:27], s62 offen offset:0 sc1
    buffer_load_dwordx4 v[84:87], v8, s[24:27], s62 offen offset:1024 sc1
    buffer_load_dwordx4 v[88:91], v8, s[24:27], s62 offen offset:2048 sc1
    buffer_load_dwordx4 v[92:95], v8, s[24:27], s62 offen offset:3072 sc1
    s_waitcnt vmcnt(0) lgkmcnt(0)
    v_bitop3_b32 v12, v80, v84, v88 bitop3:0x80
    v_and_b32 v12, v12, v92
    v_cmp_le_i32 vcc, 0, v12
    s_waitcnt vmcnt(0) lgkmcnt(0)
    s_cbranch_vccnz slow_h1_12_83
    s_nop 1
    s_branch ok_h1_12_84
slow_h1_13_85:
    s_cmp_eq_u32 s36, 0
    s_cbranch_scc1 ok_h1_13_86
    s_sub_u32 s36, s36, 1
    buffer_load_dwordx4 v[112:115], v8, s[24:27], s63 offen offset:0 sc1
    buffer_load_dwordx4 v[116:119], v8, s[24:27], s63 offen offset:1024 sc1
    buffer_load_dwordx4 v[120:123], v8, s[24:27], s63 offen offset:2048 sc1
    buffer_load_dwordx4 v[124:127], v8, s[24:27], s63 offen offset:3072 sc1
    s_waitcnt vmcnt(0) lgkmcnt(0)
    v_bitop3_b32 v12, v112, v116, v120 bitop3:0x80
    v_and_b32 v12, v12, v124
L_pad10:
    s_cbranch_execz L_ret2
    v_cmp_le_i32 vcc, 0, v12
    s_waitcnt vmcnt(0) lgkmcnt(0)
    s_cbranch_vccnz slow_h1_13_85
    s_nop 1
    s_branch ok_h1_13_86
slow_h1_14_87:
    s_cmp_eq_u32 s36, 0
    s_cbranch_scc1 ok_h1_14_88
    s_sub_u32 s36, s36, 1
    buffer_load_dwordx4 v[128:131], v8, s[24:27], s64 offen offset:0 sc1
    buffer_load_dwordx4 v[132:135], v8, s[24:27], s64 offen offset:1024 sc1
    buffer_load_dwordx4 v[136:139], v8, s[24:27], s64 offen offset:2048 sc1
    buffer_load_dwordx4 v[140:143], v8, s[24:27], s64 offen offset:3072 sc1
    s_waitcnt vmcnt(0) lgkmcnt(0)
    v_bitop3_b32 v12, v128, v132, v136 bitop3:0x80
    v_and_b32 v12, v12, v140
    v_cmp_le_i32 vcc, 0, v12
    s_waitcnt vmcnt(0) lgkmcnt(0)
    s_cbranch_vccnz slow_h1_14_87
    s_nop 1
    s_branch ok_h1_14_88
slow_h1_15_89:
    s_cmp_eq_u32 s36, 0
    s_cbranch_scc1 ok_h1_15_90
    s_sub_u32 s36, s36, 1
    buffer_load_dwordx4 v[80:83], v8, s[24:27], s65 offen offset:0 sc1
    buffer_load_dwordx4 v[84:87], v8, s[24:27], s65 offen offset:1024 sc1
    buffer_load_dwordx4 v[88:91], v8, s[24:27], s65 offen offset:2048 sc1
    buffer_load_dwordx4 v[92:95], v8, s[24:27], s65 offen offset:3072 sc1
    s_waitcnt vmcnt(0) lgkmcnt(0)
    v_bitop3_b32 v12, v80, v84, v88 bitop3:0x80
    v_and_b32 v12, v12, v92
    v_cmp_le_i32 vcc, 0, v12
    s_waitcnt vmcnt(0) lgkmcnt(0)
    s_cbranch_vccnz slow_h1_15_89
    s_nop 1
    s_branch ok_h1_15_90
slow_h1_16_91:
    s_cmp_eq_u32 s36, 0
    s_cbranch_scc1 ok_h1_16_92
    s_sub_u32 s36, s36, 1
    buffer_load_dwordx4 v[112:115], v8, s[24:27], s66 offen offset:0 sc1
    buffer_load_dwordx4 v[116:119], v8, s[24:27], s66 offen offset:1024 sc1
    buffer_load_dwordx4 v[120:123], v8, s[24:27], s66 offen offset:2048 sc1
    buffer_load_dwordx4 v[124:127], v8, s[24:27], s66 offen offset:3072 sc1
    s_waitcnt vmcnt(0) lgkmcnt(0)
    v_bitop3_b32 v12, v112, v116, v120 bitop3:0x80
    v_and_b32 v12, v12, v124
    v_cmp_le_i32 vcc, 0, v12
    s_waitcnt vmcnt(0) lgkmcnt(0)
    s_cbranch_vccnz slow_h1_16_91
    s_nop 1
    s_branch ok_h1_16_92
L_end:
    s_endpgm
.section .rodata,"a"
.p2align 6
.amdhsa_kernel interleave_layers__spectral_fnet__dense_activation_relu__prompt_kernel
  .amdhsa_next_free_vgpr 512
  .amdhsa_next_free_sgpr 102
  .amdhsa_accum_offset 256
  .amdhsa_group_segment_fixed_size 0
  .amdhsa_kernarg_size 88
  .amdhsa_user_sgpr_count 2
  .amdhsa_user_sgpr_kernarg_segment_ptr 1
  .amdhsa_system_sgpr_workgroup_id_x 1
  .amdhsa_float_denorm_mode_32 3
.end_amdhsa_kernel
```
